```python
import torch

def _softmax(x, axis=-1):
    return torch.softmax(x, dim=axis)
def _gelu(x):
    return torch.nn.functional.gelu(x, approximate="tanh")
def _silu(x):
    return torch.nn.functional.silu(x)
def _sigmoid(x):
    return torch.sigmoid(x)
def _layernorm(x, axis=-1, eps=1e-5):
    m = x.mean(dim=axis, keepdim=True)
    v = x.var(dim=axis, keepdim=True, unbiased=False)
    return (x - m) / torch.sqrt(v + eps)
def _scatter_add(tgt, idx, src, axis=0):
    return tgt.clone().index_add_(axis, idx, src)
def _segment_sum(src, seg, n):
    out = torch.zeros((n,) + src.shape[1:], dtype=src.dtype)
    return out.index_add_(0, seg, src)
def _pad(x, pw):
    flat = tuple(v for pair in reversed(pw) for v in pair)
    return torch.nn.functional.pad(x, flat)

kernel_name = 'interleave_layers__spectral_gfnet__mixer_token_mlp__prompt'

def setup_inputs():

    _w = (lambda a: (lambda t: t.to(torch.bfloat16) if t.is_floating_point() else t)(torch.as_tensor(a)))
    def _A_setup():
        B, S, D = 1, 2048, 448
        Df = D // 2 + 1
        return {
            "x": _w((lambda *s: torch.randn(*s, dtype=torch.bfloat16) * 0.05)(B, S, D)),
            "w_r": _w((lambda *s: torch.randn(*s, dtype=torch.bfloat16) * 1.6)(S, Df) * 0.02),
            "w_i": _w((lambda *s: torch.randn(*s, dtype=torch.bfloat16) * 1.6)(S, Df) * 0.02),
        }
    _A_in = _A_setup()

    def _B_setup():
        B, S, D, F = 1, 2048, 448, 1792
        return {
            "x": _w((lambda *s: torch.randn(*s, dtype=torch.bfloat16) * 0.05)(B, S, D)),
            "w1": _w((lambda *s: torch.randn(*s, dtype=torch.bfloat16) * 0.4)(S, F) * (S ** -0.5)),
            "b1": _w((lambda *s: torch.randn(*s, dtype=torch.bfloat16) * 3.2)(F) * 0.02),
            "w2": _w((lambda *s: torch.randn(*s, dtype=torch.bfloat16) * 0.8)(F, S) * (F ** -0.5)),
            "b2": _w((lambda *s: torch.randn(*s, dtype=torch.bfloat16) * 3.2)(S) * 0.02),
        }
    _B_in = _B_setup()

    return {
        "A_x": _A_in["x"],
        "A_w_r": _A_in["w_r"],
        "A_w_i": _A_in["w_i"],
        "B_x": _B_in["x"],
        "B_w1": _B_in["w1"],
        "B_b1": _B_in["b1"],
        "B_w2": _B_in["w2"],
        "B_b2": _B_in["b2"],
    }

def reference(A_x, A_w_r, A_w_i, B_x, B_w1, B_b1, B_w2, B_b2):
    def _A_ref(x, w_r, w_i):
        B, S, D = x.shape
        X = (lambda x, axes=(-2,-1): torch.fft.rfft2(x.float(), dim=axes))(x, axes=(-2, -1))
        W = w_r + 1j * w_i
        X = X * W
        y = (lambda x, s, axes=(-2,-1): torch.fft.irfft2(x, s=s, dim=axes).to(torch.bfloat16))(X, (S, D), axes=(-2, -1))
        return y

    def _B_ref(x, w1, b1, w2, b2):
        B, S, D = x.shape
        h = _layernorm(x, axis=-1)
        u = torch.einsum("bsd,sf->bdf", h, w1) + b1
        u = _gelu(u)
        y = torch.einsum("bdf,fs->bds", u, w2) + b2
        return (lambda x, *d: x.permute(*d))(y, 0, 2, 1)

    x = A_x
    x = x + _A_ref(_layernorm(x, axis=-1), A_w_r, A_w_i)
    x = x + _B_ref(_layernorm(x, axis=-1), B_w1, B_b1, B_w2, B_b2)
    x = x + _A_ref(_layernorm(x, axis=-1), A_w_r, A_w_i)
    x = x + _B_ref(_layernorm(x, axis=-1), B_w1, B_b1, B_w2, B_b2)
    return x
```

```asm
; @launch grid=(256,1,1) block=(256,1,1) lds=163840
.amdgcn_target "amdgcn-amd-amdhsa--gfx950"
.text
.globl interleave_layers__spectral_gfnet__mixer_token_mlp__prompt_kernel
.p2align 8
.type interleave_layers__spectral_gfnet__mixer_token_mlp__prompt_kernel,@function
interleave_layers__spectral_gfnet__mixer_token_mlp__prompt_kernel:
    s_cmp_ge_u32 s2, 256
    s_cbranch_scc1 L_exit
    s_load_dwordx2 s[4:5], s[0:1], 0
    s_getpc_b64 s[36:37]
L_pc:
    v_lshlrev_b32 v150, 5, v0
    global_load_dword v151, v150, s[36:37]
    s_load_dwordx2 s[6:7], s[0:1], 80
    s_load_dwordx8 s[12:19], s[0:1], 32
    s_load_dwordx4 s[8:11], s[0:1], 8
    s_load_dwordx4 s[20:23], s[0:1], 64
    s_and_b32 s56, s2, 7
    s_lshr_b32 s57, s2, 3
    s_lshl_b32 s48, s56, 5
    s_add_u32 s48, s48, s57
    s_lshr_b32 s56, s48, 3
    s_and_b32 s57, s48, 7
    s_lshl_b32 s57, s57, 3
    v_lshrrev_b32 v1, 5, v0
    v_add_u32 v1, s57, v1
    v_lshlrev_b32 v1, 5, v1
    v_add_u32 v1, s56, v1
    v_mul_u32_u24 v1, 896, v1
    v_and_b32 v2, 31, v0
    v_lshl_add_u32 v1, v2, 2, v1
    v_lshrrev_b32 v3, 6, v0
    s_nop 0
    v_readfirstlane_b32 s49, v3
    s_and_b32 s37, s37, 0xffff
    s_mov_b32 s38, L_code_end-L_pc
    s_mov_b32 s39, 0x20000
    s_lshl_b32 s40, s2, 9
    s_and_b32 s40, s40, 0x1f000
    v_lshlrev_b32 v179, 4, v0
    s_mov_b32 s34, 0x2000000
    s_mov_b32 s35, 0x20000
    s_mov_b32 s26, 0x700000
    s_mov_b32 s27, 0x20000
    s_and_b32 s56, s2, 7
    s_lshr_b32 s57, s2, 3
    s_lshl_b32 s58, s57, 2
    s_add_u32 s58, s58, s49
    v_bfe_u32 v152, v0, 5, 1
    v_and_b32 v153, 31, v0
    v_lshlrev_b32 v153, 4, v153
    s_lshl_b32 s59, s56, 9
    v_add_u32 v153, s59, v153
    v_lshl_add_u32 v254, v152, 12, v153
    v_mul_u32_u24 v152, 3584, v152
    v_add_u32 v152, v152, v153
    s_mul_i32 s41, s58, 57344
    s_cmp_eq_u32 s56, 7
    s_cselect_b32 s41, 0x80000000, s41
    v_add_u32 v152, s41, v152
    s_mul_i32 s59, s58, 57344
    v_add_u32 v254, s59, v254
    s_and_b32 s42, s2, 63
    s_lshr_b32 s43, s2, 6
    v_and_b32 v146, 63, v0
    v_mul_u32_u24 v140, 14, v146
    v_sub_u32 v141, 890, v140
    v_cmp_lt_u32 s[62:63], 31, v146
    s_lshl_b32 s44, s43, 2
    s_add_u32 s44, s44, s49
    v_cndmask_b32 v140, v140, v141, s[62:63]
    s_lshl_b32 s44, s44, 7
    s_add_u32 s44, s44, s42
    v_mov_b32 v142, 1
    v_cndmask_b32 v141, v142, -1, s[62:63]
    s_movk_i32 s45, 450
    v_mul_i32_i24 v147, s44, v141
    s_mul_i32 s3, s44, 450
    v_and_b32 v147, 0x7ff, v147
    s_add_u32 s3, s3, 448
    v_mad_u32_u24 v147, v147, s45, v140
    v_mov_b32 v149, s3
    s_add_u32 s44, s44, 64
    v_mul_i32_i24 v148, s44, v141
    s_mul_i32 s3, s44, 450
    v_and_b32 v148, 0x7ff, v148
    s_add_u32 s3, s3, 448
    v_mad_u32_u24 v148, v148, s45, v140
    v_mov_b32 v150, s3
    v_mov_b32 v140, 0x05040100
    v_mov_b32 v141, 0x07060302
    v_cndmask_b32 v142, v140, v141, s[62:63]
    v_cndmask_b32 v143, v141, v140, s[62:63]
    v_mov_b32 v140, 0x80000000
    v_cndmask_b32 v144, 0, v140, s[62:63]
    s_lshl_b32 s42, s42, 2
    s_add_u32 s42, s42, s43
    s_lshl_b32 s42, s42, 2
    s_add_u32 s42, s42, s49
    s_lshl_b32 s42, s42, 11
    s_add_u32 s3, s42, 0x800000
    v_lshlrev_b32 v145, 4, v146
    s_waitcnt lgkmcnt(0)
    s_mov_b32 s32, s6
    s_and_b32 s33, s7, 0xffff
    s_lshl_b32 s62, s2, 2
    s_or_b32 s62, s62, s49
    s_cmp_lg_u32 s62, 0
    s_cbranch_scc1 nz_1
    v_lshlrev_b32 v12, 7, v0
    v_mov_b32 v13, 0
    s_mov_b32 s62, 0x1800000
    buffer_store_dword v13, v12, s[32:35], s62 offen sc1
nz_1:
    global_load_dword v4, v1, s[4:5] offset:0
    global_load_dword v5, v1, s[4:5] offset:128
    global_load_dword v6, v1, s[4:5] offset:256
    global_load_dword v7, v1, s[4:5] offset:384
    global_load_dword v8, v1, s[4:5] offset:512
    global_load_dword v9, v1, s[4:5] offset:640
    global_load_dword v10, v1, s[4:5] offset:768
    global_load_dwordx2 v[128:129], v147, s[8:9]
    global_load_dwordx2 v[130:131], v147, s[10:11]
    global_load_ushort v136, v149, s[8:9]
    global_load_ushort v137, v149, s[10:11]
    global_load_dwordx2 v[132:133], v148, s[8:9]
    global_load_dwordx2 v[134:135], v148, s[10:11]
    global_load_ushort v138, v150, s[8:9]
    global_load_ushort v139, v150, s[10:11]
    buffer_load_dword v151, v179, s[36:39], s40 offen
    s_mov_b32 s24, s12
    s_and_b32 s25, s13, 0xffff
    s_mov_b32 s41, 0
    s_mov_b32 s28, s16
    s_and_b32 s29, s17, 0xffff
    s_mov_b32 s30, 0x700000
    s_mov_b32 s31, 0x20000
    v_mov_b32 v255, v152
    s_mov_b32 s41, 0
    buffer_load_dwordx4 v[160:163], v255, s[24:27], s41 offen
    s_mov_b32 s41, 7168
    buffer_load_dwordx4 v[160:163], v255, s[24:27], s41 offen
    s_mov_b32 s41, 28672
    buffer_load_dwordx4 v[160:163], v255, s[24:27], s41 offen
    s_mov_b32 s41, 35840
    buffer_load_dwordx4 v[160:163], v255, s[24:27], s41 offen
    v_lshlrev_b32 v154, 4, v0
    v_mov_b32 v156, -1
    v_mov_b32 v157, -1
    v_mov_b32 v158, -1
    v_mov_b32 v159, -1
    s_lshl_b32 s59, s2, 13
    s_add_u32 s59, s59, 0x400000
    buffer_store_dwordx4 v[156:159], v154, s[32:35], s59 offen sc1
    s_add_u32 s59, s59, 4096
    buffer_store_dwordx4 v[156:159], v154, s[32:35], s59 offen sc1
    s_lshl_b32 s62, s2, 2
    s_or_b32 s62, s62, s49
    s_cmp_lg_u32 s62, 0
    s_cbranch_scc1 nz_2
    v_mov_b32 v62, 0
    v_mov_b32 v63, 1
    s_waitcnt vmcnt(22)
    global_store_dword v62, v63, s[22:23] sc1
nz_2:
    s_mul_i32 s58, s57, 37
    s_lshr_b32 s58, s58, 8
    s_mul_i32 s64, s58, 7
    s_sub_u32 s64, s57, s64
    s_cmp_lt_u32 s57, 28
    s_cselect_b32 s54, 0, 0x80000000
    s_lshl_b32 s52, s56, 2
    s_add_u32 s52, s52, s58
    s_mov_b32 s51, s52
    s_mov_b32 s50, s64
    s_mov_b32 s65, s64
    s_cmp_lt_u32 s56, 7
    s_cselect_b32 s53, s54, 0x80000000
    s_lshl_b32 s99, s50, 1
    s_mov_b32 s100, s99
    s_mov_b32 s99, 0
    s_mov_b32 s100, 0
    s_mov_b32 s55, 200000
    s_lshl_b32 s60, s49, 15
    s_mul_i32 s12, s49, 28672
    s_add_u32 s13, s12, 3670016
    s_mul_i32 s16, s49, 14
    s_sub_u32 s17, s16, 14
    s_mov_b32 s36, 0x3f1f9d07
    s_mov_b32 s37, 0x3f1f9d07
    s_mov_b32 s42, 0x3f48261c
    s_mov_b32 s43, 0x3f48261c
    s_mov_b32 s38, 0xbe63dc87
    s_mov_b32 s39, 0xbe63dc87
    s_mov_b32 s44, 0x3f7994e0
    s_mov_b32 s45, 0x3f7994e0
    s_mov_b32 s40, 0xbf66a5e5
    s_mov_b32 s41, 0xbf66a5e5
    s_mov_b32 s46, 0x3ede2602
    s_mov_b32 s47, 0x3ede2602
    s_lshl_b32 s56, s49, 3
    s_add_u32 s56, s56, 0x24000
    v_lshl_add_u32 v177, v146, 5, s56
    s_lshl_b32 s56, s49, 11
    s_add_u32 s56, s56, 0x24000
    v_add_u32 v178, s56, v145
    v_bfe_u32 v164, v0, 3, 3
    s_mov_b32 s98, 114688
    v_mul_lo_u32 v240, v164, s98
    v_bfe_u32 v164, v0, 4, 1
    v_lshlrev_b32 v164, 2, v164
    v_and_b32 v165, 7, v0
    v_xor_b32 v164, v164, v165
    v_lshl_add_u32 v240, v164, 4, v240
    s_lshl_b32 s98, s51, 7
    s_or_b32 s98, s98, s53
    v_add_u32 v240, s98, v240
    v_add_u32 v241, 0xdfc00, v240
    v_add_u32 v242, 0x1bf800, v240
    v_add_u32 v243, 0x29f400, v240
    v_cvt_f32_u32 v14, v2
    v_mul_f32 v14, 0x3b924925, v14
    v_add_f32 v15, 0x3b124925, v14
    v_cos_f32 v20, v14
    v_cos_f32 v21, v15
    v_sin_f32 v26, v14
    v_sin_f32 v27, v15
    v_mul_f32 v16, 0x40000000, v14
    v_mul_f32 v17, 0x40000000, v15
    v_cos_f32 v22, v16
    v_cos_f32 v23, v17
    v_sin_f32 v28, v16
    v_sin_f32 v29, v17
    v_mul_f32 v16, 0x40400000, v14
    v_mul_f32 v17, 0x40400000, v15
    v_cos_f32 v24, v16
    v_cos_f32 v25, v17
    v_sin_f32 v30, v16
    v_sin_f32 v31, v17
    v_lshrrev_b32 v3, 5, v0
    v_mul_u32_u24 v3, 272, v3
    v_lshl_add_u32 v3, v2, 3, v3
    v_add_u32 v3, 0x20000, v3
    v_bfe_u32 v13, v0, 4, 2
    v_and_b32 v12, 15, v0
    v_mul_u32_u24 v18, 272, v12
    v_lshl_add_u32 v18, v13, 4, v18
    v_add_u32 v18, 0x20000, v18
    v_lshrrev_b32 v19, 1, v13
    v_lshl_add_u32 v19, v19, 6, v12
    v_lshrrev_b32 v14, 6, v0
    v_lshl_add_u32 v19, v14, 4, v19
    v_lshlrev_b32 v19, 5, v19
    v_and_b32 v14, 1, v13
    v_lshl_add_u32 v19, v14, 4, v19
    v_lshrrev_b32 v55, 6, v0
    v_and_b32 v56, 15, v0
    v_lshl_add_u32 v55, v55, 4, v56
    v_bfe_u32 v56, v0, 4, 2
    v_cvt_f32_u32 v48, v55
    v_cvt_f32_u32 v49, v56
    v_mul_f32 v48, 0x3c800000, v48
    v_mul_f32 v49, 4.0, v49
    v_mul_f32 v50, 0x41500000, v48
    v_mul_f32 v49, v49, v48
    v_cos_f32 v51, v49
    v_sin_f32 v52, v49
    v_add_f32 v49, v49, v48
    v_cos_f32 v53, v49
    v_sin_f32 v54, v49
    v_add_f32 v49, v49, v48
    v_cvt_pk_bf16_f32 v96, v51, v52
    v_cvt_pk_bf16_f32 v112, -v52, v51
    v_cos_f32 v51, v49
    v_sin_f32 v52, v49
    v_add_f32 v49, v49, v48
    v_cvt_pk_bf16_f32 v97, v53, v54
    v_cvt_pk_bf16_f32 v113, -v54, v53
    v_cos_f32 v53, v49
    v_sin_f32 v54, v49
    v_add_f32 v49, v49, v50
    v_cvt_pk_bf16_f32 v98, v51, v52
    v_cvt_pk_bf16_f32 v114, -v52, v51
    v_cos_f32 v51, v49
    v_sin_f32 v52, v49
    v_add_f32 v49, v49, v48
    v_cvt_pk_bf16_f32 v99, v53, v54
    v_cvt_pk_bf16_f32 v115, -v54, v53
    v_cos_f32 v53, v49
    v_sin_f32 v54, v49
    v_add_f32 v49, v49, v48
    v_cvt_pk_bf16_f32 v100, v51, v52
    v_cvt_pk_bf16_f32 v116, -v52, v51
    v_cos_f32 v51, v49
    v_sin_f32 v52, v49
    v_add_f32 v49, v49, v48
    v_cvt_pk_bf16_f32 v101, v53, v54
    v_cvt_pk_bf16_f32 v117, -v54, v53
    v_cos_f32 v53, v49
    v_sin_f32 v54, v49
    v_add_f32 v49, v49, v50
    v_cvt_pk_bf16_f32 v102, v51, v52
    v_cvt_pk_bf16_f32 v118, -v52, v51
    v_cos_f32 v51, v49
    v_sin_f32 v52, v49
    v_add_f32 v49, v49, v48
    v_cvt_pk_bf16_f32 v103, v53, v54
    v_cvt_pk_bf16_f32 v119, -v54, v53
    v_cos_f32 v53, v49
    v_sin_f32 v54, v49
    v_add_f32 v49, v49, v48
    v_cvt_pk_bf16_f32 v104, v51, v52
    v_cvt_pk_bf16_f32 v120, -v52, v51
    v_cos_f32 v51, v49
    v_sin_f32 v52, v49
    v_add_f32 v49, v49, v48
    v_cvt_pk_bf16_f32 v105, v53, v54
    v_cvt_pk_bf16_f32 v121, -v54, v53
    v_cos_f32 v53, v49
    v_sin_f32 v54, v49
    v_add_f32 v49, v49, v50
    v_cvt_pk_bf16_f32 v106, v51, v52
    v_cvt_pk_bf16_f32 v122, -v52, v51
    v_cos_f32 v51, v49
    v_sin_f32 v52, v49
    v_add_f32 v49, v49, v48
    v_cvt_pk_bf16_f32 v107, v53, v54
    v_cvt_pk_bf16_f32 v123, -v54, v53
    v_cos_f32 v53, v49
    v_sin_f32 v54, v49
    v_add_f32 v49, v49, v48
    v_cvt_pk_bf16_f32 v108, v51, v52
    v_cvt_pk_bf16_f32 v124, -v52, v51
    v_cos_f32 v51, v49
    v_sin_f32 v52, v49
    v_add_f32 v49, v49, v48
    v_cvt_pk_bf16_f32 v109, v53, v54
    v_cvt_pk_bf16_f32 v125, -v54, v53
    v_cos_f32 v53, v49
    v_sin_f32 v54, v49
    v_cvt_pk_bf16_f32 v110, v51, v52
    v_cvt_pk_bf16_f32 v126, -v52, v51
    v_cvt_pk_bf16_f32 v111, v53, v54
    v_cvt_pk_bf16_f32 v127, -v54, v53
    s_waitcnt vmcnt(15)
    v_lshlrev_b32 v32, 16, v4
    v_and_b32 v33, 0xffff0000, v4
    v_lshlrev_b32 v34, 16, v5
    v_and_b32 v35, 0xffff0000, v5
    v_lshlrev_b32 v36, 16, v6
    v_and_b32 v37, 0xffff0000, v6
    v_lshlrev_b32 v38, 16, v7
    v_and_b32 v39, 0xffff0000, v7
    v_lshlrev_b32 v40, 16, v8
    v_and_b32 v41, 0xffff0000, v8
    v_lshlrev_b32 v42, 16, v9
    v_and_b32 v43, 0xffff0000, v9
    v_lshlrev_b32 v44, 16, v10
    v_and_b32 v45, 0xffff0000, v10
    v_pk_add_f32 v[48:49], v[34:35], v[44:45]
    v_pk_add_f32 v[46:47], v[32:33], v[34:35]
    v_pk_mul_f32 v[60:61], v[32:33], v[32:33]
    v_pk_add_f32 v[54:55], v[34:35], v[44:45] neg_lo:[0,1] neg_hi:[0,1]
    v_pk_add_f32 v[50:51], v[36:37], v[42:43]
    v_pk_add_f32 v[46:47], v[46:47], v[36:37]
    v_pk_fma_f32 v[60:61], v[34:35], v[34:35], v[60:61]
    v_pk_add_f32 v[56:57], v[36:37], v[42:43] neg_lo:[0,1] neg_hi:[0,1]
    v_pk_add_f32 v[52:53], v[38:39], v[40:41]
    v_pk_add_f32 v[58:59], v[38:39], v[40:41] neg_lo:[0,1] neg_hi:[0,1]
    v_pk_add_f32 v[46:47], v[46:47], v[38:39]
    v_pk_fma_f32 v[60:61], v[36:37], v[36:37], v[60:61]
    v_pk_fma_f32 v[80:81], v[48:49], s[36:37], v[32:33]
    v_pk_fma_f32 v[80:81], v[50:51], s[38:39], v[80:81]
    v_pk_fma_f32 v[60:61], v[38:39], v[38:39], v[60:61]
    v_pk_fma_f32 v[80:81], v[52:53], s[40:41], v[80:81]
    v_pk_add_f32 v[46:47], v[46:47], v[40:41]
    v_pk_mul_f32 v[82:83], v[54:55], s[42:43]
    v_pk_fma_f32 v[82:83], v[56:57], s[44:45], v[82:83]
    v_pk_fma_f32 v[60:61], v[40:41], v[40:41], v[60:61]
    v_pk_fma_f32 v[82:83], v[58:59], s[46:47], v[82:83]
    v_pk_add_f32 v[46:47], v[46:47], v[42:43]
    v_pk_mul_f32 v[64:65], v[82:83], v[26:27]
    v_pk_mul_f32 v[70:71], v[82:83], v[20:21]
    v_pk_add_f32 v[46:47], v[46:47], v[44:45]
    v_pk_fma_f32 v[60:61], v[42:43], v[42:43], v[60:61]
    v_pk_fma_f32 v[64:65], v[80:81], v[20:21], v[64:65] neg_lo:[0,0,1] neg_hi:[0,0,1]
    v_pk_fma_f32 v[70:71], v[80:81], v[26:27], v[70:71]
    v_pk_fma_f32 v[60:61], v[44:45], v[44:45], v[60:61]
    v_pk_fma_f32 v[76:77], v[48:49], s[38:39], v[32:33]
    v_add_f32 v46, v46, v47
    v_pk_fma_f32 v[76:77], v[50:51], s[40:41], v[76:77]
    v_pk_fma_f32 v[76:77], v[52:53], s[36:37], v[76:77]
    v_add_f32 v60, v60, v61
    v_pk_mul_f32 v[78:79], v[54:55], s[44:45]
    v_add_f32_dpp v46, v46, v46 quad_perm:[1,0,3,2] row_mask:0xf bank_mask:0xf
    v_pk_fma_f32 v[78:79], v[56:57], s[46:47], v[78:79] neg_lo:[1,0,0] neg_hi:[1,0,0]
    v_add_f32_dpp v60, v60, v60 quad_perm:[1,0,3,2] row_mask:0xf bank_mask:0xf
    v_pk_fma_f32 v[78:79], v[58:59], s[42:43], v[78:79] neg_lo:[1,0,0] neg_hi:[1,0,0]
    v_pk_mul_f32 v[66:67], v[78:79], v[28:29]
    v_add_f32_dpp v46, v46, v46 quad_perm:[2,3,0,1] row_mask:0xf bank_mask:0xf
    v_pk_mul_f32 v[72:73], v[78:79], v[22:23]
    v_add_f32_dpp v60, v60, v60 quad_perm:[2,3,0,1] row_mask:0xf bank_mask:0xf
    v_pk_fma_f32 v[66:67], v[76:77], v[22:23], v[66:67] neg_lo:[0,0,1] neg_hi:[0,0,1]
    v_pk_fma_f32 v[72:73], v[76:77], v[28:29], v[72:73]
    v_add_f32_dpp v46, v46, v46 row_half_mirror row_mask:0xf bank_mask:0xf
    v_pk_fma_f32 v[80:81], v[48:49], s[40:41], v[32:33]
    v_add_f32_dpp v60, v60, v60 row_half_mirror row_mask:0xf bank_mask:0xf
    v_pk_fma_f32 v[80:81], v[50:51], s[36:37], v[80:81]
    v_add_f32_dpp v46, v46, v46 row_mirror row_mask:0xf bank_mask:0xf
    v_pk_fma_f32 v[80:81], v[52:53], s[38:39], v[80:81]
    v_add_f32_dpp v60, v60, v60 row_mirror row_mask:0xf bank_mask:0xf
    v_pk_mul_f32 v[82:83], v[54:55], s[46:47]
    v_pk_fma_f32 v[82:83], v[56:57], s[42:43], v[82:83] neg_lo:[1,0,0] neg_hi:[1,0,0]
    v_mov_b32 v4, v46
    v_pk_fma_f32 v[82:83], v[58:59], s[44:45], v[82:83]
    v_mov_b32 v5, v60
    v_pk_mul_f32 v[68:69], v[82:83], v[30:31]
    v_pk_mul_f32 v[74:75], v[82:83], v[24:25]
    v_permlane16_swap_b32 v46, v4
    v_permlane16_swap_b32 v60, v5
    v_pk_fma_f32 v[68:69], v[80:81], v[24:25], v[68:69] neg_lo:[0,0,1] neg_hi:[0,0,1]
    v_pk_fma_f32 v[74:75], v[80:81], v[30:31], v[74:75]
    v_pk_add_f32 v[6:7], v[32:33], v[48:49]
    v_add_f32 v46, v46, v4
    v_add_f32 v60, v60, v5
    v_pk_add_f32 v[8:9], v[50:51], v[52:53]
    v_pk_add_f32 v[6:7], v[6:7], v[8:9]
    v_mul_f32 v46, 0x3b124925, v46
    v_mul_f32 v60, 0x3b124925, v60
    v_fma_f32 v60, -v46, v46, v60
    v_max_f32 v60, 0, v60
    v_add_f32 v60, 0x3727c5ac, v60
    v_rsq_f32 v60, v60
    v_mul_f32 v46, 0xc0e00000, v46
    v_mul_f32 v60, 0x35924925, v60
    v_pk_add_f32 v[6:7], v[6:7], v[46:47] op_sel_hi:[1,0]
    v_pk_mul_f32 v[64:65], v[64:65], v[60:61] op_sel_hi:[1,0]
    v_pk_mul_f32 v[66:67], v[66:67], v[60:61] op_sel_hi:[1,0]
    v_pk_mul_f32 v[68:69], v[68:69], v[60:61] op_sel_hi:[1,0]
    v_pk_mul_f32 v[70:71], v[70:71], v[60:61] op_sel_hi:[1,0]
    v_pk_mul_f32 v[72:73], v[72:73], v[60:61] op_sel_hi:[1,0]
    v_pk_mul_f32 v[74:75], v[74:75], v[60:61] op_sel_hi:[1,0]
    v_pk_mul_f32 v[6:7], v[6:7], v[60:61] op_sel_hi:[1,0]
    v_cvt_pk_bf16_f32 v34, v64, -v70
    v_cvt_pk_bf16_f32 v35, v65, -v71
    ds_write_b64 v3, v[34:35] offset:2176
    v_cvt_pk_bf16_f32 v36, v66, -v72
    v_cvt_pk_bf16_f32 v37, v67, -v73
    ds_write_b64 v3, v[36:37] offset:4352
    v_cvt_pk_bf16_f32 v38, v68, -v74
    v_cvt_pk_bf16_f32 v39, v69, -v75
    ds_write_b64 v3, v[38:39] offset:6528
    v_cvt_pk_bf16_f32 v32, v6, 0
    v_cvt_pk_bf16_f32 v33, v7, 0
    ds_write_b64 v3, v[32:33]
    v_cmp_lt_u32 s[62:63], 31, v146
    v_cmp_eq_u32 vcc, 32, v146
    s_waitcnt vmcnt(7)
    v_cndmask_b32 v172, v128, v129, s[62:63]
    v_cndmask_b32 v173, v129, v128, s[62:63]
    v_cndmask_b32 v174, v130, v131, s[62:63]
    v_cndmask_b32 v175, v131, v130, s[62:63]
    v_perm_b32 v164, v174, v172, v142
    v_xor_b32 v164, v164, v144
    v_perm_b32 v166, v174, v172, v143
    v_xor_b32 v166, v166, v144
    v_perm_b32 v168, v175, v173, v142
    v_xor_b32 v168, v168, v144
    v_perm_b32 v170, v175, v173, v143
    v_xor_b32 v170, v170, v144
    v_lshl_or_b32 v176, v137, 16, v136
    v_cndmask_b32 v164, v164, v176, vcc
    v_cndmask_b32 v172, v132, v133, s[62:63]
    v_cndmask_b32 v173, v133, v132, s[62:63]
    v_cndmask_b32 v174, v134, v135, s[62:63]
    v_cndmask_b32 v175, v135, v134, s[62:63]
    v_perm_b32 v165, v174, v172, v142
    v_xor_b32 v165, v165, v144
    v_perm_b32 v167, v174, v172, v143
    v_xor_b32 v167, v167, v144
    v_perm_b32 v169, v175, v173, v142
    v_xor_b32 v169, v169, v144
    v_perm_b32 v171, v175, v173, v143
    v_xor_b32 v171, v171, v144
    v_lshl_or_b32 v176, v139, 16, v138
    v_cndmask_b32 v165, v165, v176, vcc
    ds_write_b64 v177, v[164:165] offset:0
    ds_write_b64 v177, v[166:167] offset:2048
    ds_write_b64 v177, v[168:169] offset:4096
    ds_write_b64 v177, v[170:171] offset:6144
    s_lshl_b32 s56, s48, 13
    s_add_u32 s56, s56, 0x0
    s_add_u32 s57, s56, 4096
    s_waitcnt lgkmcnt(0)
    s_barrier
    ds_read_b128 v[64:67], v18 offset:0
    ds_read_b128 v[68:71], v18 offset:64
    ds_read_b128 v[72:75], v18 offset:128
    ds_read_b128 v[76:79], v18 offset:192
    ds_read_b128 v[80:83], v18 offset:4352
    ds_read_b128 v[84:87], v18 offset:4416
    ds_read_b128 v[88:91], v18 offset:4480
    ds_read_b128 v[92:95], v18 offset:4544
    ds_read_b128 v[164:167], v178
    ds_read_b128 v[168:171], v178 offset:1024
    s_waitcnt lgkmcnt(9)
    v_mfma_f32_16x16x32_bf16 v[32:35], v[64:67], v[96:99], 0
    v_mfma_f32_16x16x32_bf16 v[40:43], v[64:67], v[112:115], 0
    s_waitcnt lgkmcnt(8)
    v_mfma_f32_16x16x32_bf16 v[32:35], v[68:71], v[100:103], v[32:35]
    v_mfma_f32_16x16x32_bf16 v[40:43], v[68:71], v[116:119], v[40:43]
    s_waitcnt lgkmcnt(7)
    v_mfma_f32_16x16x32_bf16 v[32:35], v[72:75], v[104:107], v[32:35]
    v_mfma_f32_16x16x32_bf16 v[40:43], v[72:75], v[120:123], v[40:43]
    s_waitcnt lgkmcnt(6)
    v_mfma_f32_16x16x32_bf16 v[32:35], v[76:79], v[108:111], v[32:35]
    v_mfma_f32_16x16x32_bf16 v[40:43], v[76:79], v[124:127], v[40:43]
    s_waitcnt lgkmcnt(5)
    v_mfma_f32_16x16x32_bf16 v[36:39], v[80:83], v[96:99], 0
    v_mfma_f32_16x16x32_bf16 v[44:47], v[80:83], v[112:115], 0
    s_waitcnt lgkmcnt(4)
    v_mfma_f32_16x16x32_bf16 v[36:39], v[84:87], v[100:103], v[36:39]
    v_mfma_f32_16x16x32_bf16 v[44:47], v[84:87], v[116:119], v[44:47]
    s_waitcnt lgkmcnt(3)
    v_mfma_f32_16x16x32_bf16 v[36:39], v[88:91], v[104:107], v[36:39]
    v_mfma_f32_16x16x32_bf16 v[44:47], v[88:91], v[120:123], v[44:47]
    v_cvt_pk_bf16_f32 v48, v32, v40
    v_cvt_pk_bf16_f32 v49, v33, v41
    v_cvt_pk_bf16_f32 v50, v34, v42
    v_cvt_pk_bf16_f32 v51, v35, v43
    buffer_store_dwordx4 v[48:51], v19, s[32:35], s56 offen sc1
    s_waitcnt lgkmcnt(2)
    v_mfma_f32_16x16x32_bf16 v[36:39], v[92:95], v[108:111], v[36:39]
    v_mfma_f32_16x16x32_bf16 v[44:47], v[92:95], v[124:127], v[44:47]
    s_waitcnt lgkmcnt(0)
    buffer_store_dwordx4 v[164:167], v145, s[32:35], s3 offen sc1
    buffer_store_dwordx4 v[168:171], v145, s[32:35], s3 offen offset:1024 sc1
    s_nop 4
    v_cvt_pk_bf16_f32 v52, v36, v44
    v_cvt_pk_bf16_f32 v53, v37, v45
    v_cvt_pk_bf16_f32 v54, v38, v46
    v_cvt_pk_bf16_f32 v55, v39, v47
    buffer_store_dwordx4 v[52:55], v19, s[32:35], s57 offen sc1
    v_mov_b32 v11, 0
    global_load_dword v12, v11, s[22:23] sc1
    s_waitcnt vmcnt(0)
    s_barrier
    s_cmp_lg_u32 s49, 0
    s_cbranch_scc1 nb_3
rdy_4:
    v_cmp_ne_u32 vcc, 0, v12
    s_cbranch_vccnz rdyok_5
    s_cmp_eq_u32 s55, 0
    s_cbranch_scc1 rdyok_5
    s_sub_u32 s55, s55, 1
    s_sleep 4
    global_load_dword v12, v11, s[22:23] sc1
    s_waitcnt vmcnt(0)
    s_branch rdy_4
rdyok_5:
    s_and_b32 s56, s2, 31
    s_lshl_b32 s56, s56, 7
    s_add_u32 s56, s56, 0x1800000
    v_mov_b32 v12, 1
    s_mov_b64 exec, 1
    buffer_atomic_add v12, v11, s[32:35], s56 offen sc1
    s_mov_b64 exec, -1
nb_3:
    s_min_u32 s56, s51, 27
    s_lshl_b32 s56, s56, 7
    v_mov_b32 v164, s56
    global_load_dword v172, v164, s[14:15]
    s_min_u32 s56, s52, 31
    s_lshl_b32 s56, s56, 7
    v_mov_b32 v164, s56
    global_load_dword v172, v164, s[18:19]
    s_mov_b32 s56, 14336
    buffer_load_dwordx4 v[160:163], v255, s[24:27], s56 offen
    s_mov_b32 s56, 21504
    buffer_load_dwordx4 v[160:163], v255, s[24:27], s56 offen
    s_mov_b32 s56, 43008
    buffer_load_dwordx4 v[160:163], v255, s[24:27], s56 offen
    s_mov_b32 s56, 50176
    buffer_load_dwordx4 v[160:163], v255, s[24:27], s56 offen
    v_lshlrev_b32 v173, 4, v0
    v_mov_b32 v168, -1
    v_mov_b32 v169, -1
    v_mov_b32 v170, -1
    v_mov_b32 v171, -1
    v_and_b32 v2, 15, v0
    v_bfe_u32 v3, v0, 4, 2
    v_lshrrev_b32 v4, 6, v0
    v_lshrrev_b32 v5, 1, v4
    v_lshl_add_u32 v5, v5, 4, v2
    s_mov_b32 s63, s65
    s_lshl_b32 s61, s63, 12
    s_add_u32 s61, s61, s60
    s_add_u32 m0, s61, 0
    s_add_u32 s61, s63, 0
    s_bfe_u32 s62, s61, 0x30001
    s_bitcmp1_b32 s61, 0
    s_cselect_b32 s61, s13, s12
    s_mul_i32 s62, s62, 3584
    s_add_u32 s62, s62, s61
    buffer_load_dwordx4 v240, s[24:27], s62 offen offset:0 lds
    v_lshlrev_b32 v5, 3, v5
    v_and_b32 v6, 1, v4
    v_lshl_add_u32 v5, v6, 2, v5
    v_lshrrev_b32 v6, 1, v3
    v_add_u32 v5, v5, v6
    buffer_load_dwordx4 v241, s[24:27], s62 offen offset:1024 lds
    v_lshlrev_b32 v5, 13, v5
    v_and_b32 v7, 1, v3
    v_lshl_add_u32 v5, v7, 4, v5
    v_lshl_add_u32 v56, v4, 4, v2
    v_lshl_add_u32 v6, v56, 2, v6
    buffer_load_dwordx4 v242, s[24:27], s62 offen offset:2048 lds
    v_lshlrev_b32 v6, 13, v6
    v_lshl_add_u32 v7, v7, 4, v6
    v_lshlrev_b32 v6, 8, v2
    v_lshl_add_u32 v6, v4, 6, v6
    v_lshl_add_u32 v6, v3, 4, v6
    buffer_load_dwordx4 v243, s[24:27], s62 offen offset:3072 lds
    v_cvt_f32_u32 v57, v56
    v_cvt_f32_u32 v58, v3
    v_mul_f32 v57, 0x3a000000, v57
    v_mul_f32 v58, 4.0, v58
    v_mul_f32 v59, 0x41500000, v57
    s_add_u32 s63, s63, 1
    s_cmp_eq_u32 s63, 8
    s_cselect_b32 s63, 0, s63
    s_lshl_b32 s61, s63, 12
    s_add_u32 s61, s61, s60
    s_add_u32 m0, s61, 0
    s_add_u32 s61, s63, 0
    s_bfe_u32 s62, s61, 0x30001
    s_bitcmp1_b32 s61, 0
    s_cselect_b32 s61, s13, s12
    s_mul_i32 s62, s62, 3584
    s_add_u32 s62, s62, s61
    buffer_load_dwordx4 v240, s[24:27], s62 offen offset:0 lds
    v_mul_f32 v58, v58, v57
    v_cos_f32 v60, v58
    v_sin_f32 v61, v58
    v_add_f32 v58, v58, v57
    v_cvt_pk_f16_f32 v16, v60, -v61
    buffer_load_dwordx4 v241, s[24:27], s62 offen offset:1024 lds
    v_cos_f32 v60, v58
    v_sin_f32 v61, v58
    v_add_f32 v58, v58, v57
    v_cvt_pk_f16_f32 v17, v60, -v61
    v_cos_f32 v60, v58
    buffer_load_dwordx4 v242, s[24:27], s62 offen offset:2048 lds
    v_sin_f32 v61, v58
    v_add_f32 v58, v58, v57
    v_cvt_pk_f16_f32 v18, v60, -v61
    v_cos_f32 v60, v58
    v_sin_f32 v61, v58
    buffer_load_dwordx4 v243, s[24:27], s62 offen offset:3072 lds
    v_add_f32 v58, v58, v59
    v_cvt_pk_f16_f32 v19, v60, -v61
    v_cos_f32 v60, v58
    v_sin_f32 v61, v58
    v_add_f32 v58, v58, v57
    s_add_u32 s63, s63, 1
    s_cmp_eq_u32 s63, 8
    s_cselect_b32 s63, 0, s63
    s_lshl_b32 s61, s63, 12
    s_add_u32 s61, s61, s60
    s_add_u32 m0, s61, 0
    s_add_u32 s61, s63, 0
    s_bfe_u32 s62, s61, 0x30001
    s_bitcmp1_b32 s61, 0
    s_cselect_b32 s61, s13, s12
    s_mul_i32 s62, s62, 3584
    s_add_u32 s62, s62, s61
    buffer_load_dwordx4 v240, s[24:27], s62 offen offset:0 lds
    v_cvt_pk_f16_f32 v20, v60, -v61
    v_cos_f32 v60, v58
    v_sin_f32 v61, v58
    v_add_f32 v58, v58, v57
    v_cvt_pk_f16_f32 v21, v60, -v61
    buffer_load_dwordx4 v241, s[24:27], s62 offen offset:1024 lds
    v_cos_f32 v60, v58
    v_sin_f32 v61, v58
    v_add_f32 v58, v58, v57
    v_cvt_pk_f16_f32 v22, v60, -v61
    v_cos_f32 v60, v58
    buffer_load_dwordx4 v242, s[24:27], s62 offen offset:2048 lds
    v_sin_f32 v61, v58
    s_nop 0
    v_cvt_pk_f16_f32 v23, v60, -v61
    v_lshlrev_b32 v56, 4, v4
    v_lshl_add_u32 v56, v3, 2, v56
    v_cvt_f32_u32 v56, v56
    buffer_load_dwordx4 v243, s[24:27], s62 offen offset:3072 lds
    v_add_u32 v47, 16, v2
    v_cvt_f32_u32 v57, v2
    v_mul_f32 v57, 0x3a000000, v57
    v_mul_f32 v58, v56, v57
    v_cos_f32 v60, v58
    s_add_u32 s63, s63, 1
    s_cmp_eq_u32 s63, 8
    s_cselect_b32 s63, 0, s63
    s_lshl_b32 s61, s63, 12
    s_add_u32 s61, s61, s60
    s_add_u32 m0, s61, 0
    s_add_u32 s61, s63, 0
    s_bfe_u32 s62, s61, 0x30001
    s_bitcmp1_b32 s61, 0
    s_cselect_b32 s61, s13, s12
    s_mul_i32 s62, s62, 3584
    s_add_u32 s62, s62, s61
    buffer_load_dwordx4 v240, s[24:27], s62 offen offset:0 lds
    v_sin_f32 v61, v58
    v_add_f32 v58, v58, v57
    v_cvt_pk_f16_f32 v24, v60, v61
    v_cos_f32 v60, v58
    v_sin_f32 v61, v58
    buffer_load_dwordx4 v241, s[24:27], s62 offen offset:1024 lds
    v_add_f32 v58, v58, v57
    v_cvt_pk_f16_f32 v25, v60, v61
    v_cos_f32 v60, v58
    v_sin_f32 v61, v58
    v_add_f32 v58, v58, v57
    buffer_load_dwordx4 v242, s[24:27], s62 offen offset:2048 lds
    v_cvt_pk_f16_f32 v26, v60, v61
    v_cos_f32 v60, v58
    v_sin_f32 v61, v58
    s_nop 0
    v_cvt_pk_f16_f32 v27, v60, v61
    v_cvt_f32_u32 v57, v47
    buffer_load_dwordx4 v243, s[24:27], s62 offen offset:3072 lds
    v_mul_f32 v57, 0x3a000000, v57
    v_mul_f32 v58, v56, v57
    v_cos_f32 v60, v58
    v_sin_f32 v61, v58
    v_add_f32 v58, v58, v57
    s_add_u32 s63, s63, 1
    s_cmp_eq_u32 s63, 8
    s_cselect_b32 s63, 0, s63
    s_lshl_b32 s61, s63, 12
    s_add_u32 s61, s61, s60
    s_add_u32 m0, s61, 0
    s_add_u32 s61, s63, 0
    s_bfe_u32 s62, s61, 0x30001
    s_bitcmp1_b32 s61, 0
    s_cselect_b32 s61, s13, s12
    s_mul_i32 s62, s62, 3584
    s_add_u32 s62, s62, s61
    buffer_load_dwordx4 v240, s[24:27], s62 offen offset:0 lds
    v_cvt_pk_f16_f32 v28, v60, v61
    v_cos_f32 v60, v58
    v_sin_f32 v61, v58
    v_add_f32 v58, v58, v57
    v_cvt_pk_f16_f32 v29, v60, v61
    buffer_load_dwordx4 v241, s[24:27], s62 offen offset:1024 lds
    v_cos_f32 v60, v58
    v_sin_f32 v61, v58
    v_add_f32 v58, v58, v57
    v_cvt_pk_f16_f32 v30, v60, v61
    v_cos_f32 v60, v58
    buffer_load_dwordx4 v242, s[24:27], s62 offen offset:2048 lds
    v_sin_f32 v61, v58
    s_nop 0
    v_cvt_pk_f16_f32 v31, v60, v61
    v_and_b32 v55, 15, v0
    v_bfe_u32 v56, v0, 4, 2
    v_add_u32 v57, 16, v55
    buffer_load_dwordx4 v243, s[24:27], s62 offen offset:3072 lds
    v_cvt_f32_u32 v48, v55
    v_cvt_f32_u32 v49, v56
    v_mul_f32 v48, 0x3d000000, v48
    v_mul_f32 v49, 4.0, v49
    v_mul_f32 v50, 0x41500000, v48
    s_add_u32 s63, s63, 1
    s_cmp_eq_u32 s63, 8
    s_cselect_b32 s63, 0, s63
    s_lshl_b32 s61, s63, 12
    s_add_u32 s61, s61, s60
    s_add_u32 m0, s61, 0
    s_add_u32 s61, s63, 0
    s_bfe_u32 s62, s61, 0x30001
    s_bitcmp1_b32 s61, 0
    s_cselect_b32 s61, s13, s12
    s_mul_i32 s62, s62, 3584
    s_add_u32 s62, s62, s61
    buffer_load_dwordx4 v240, s[24:27], s62 offen offset:0 lds
    v_mul_f32 v49, v49, v48
    v_cos_f32 v51, v49
    v_sin_f32 v52, v49
    v_add_f32 v49, v49, v48
    v_cos_f32 v53, v49
    buffer_load_dwordx4 v241, s[24:27], s62 offen offset:1024 lds
    v_sin_f32 v54, v49
    v_add_f32 v49, v49, v48
    v_cvt_pk_bf16_f32 v128, v51, v52
    v_cvt_pk_bf16_f32 v144, -v52, v51
    v_cos_f32 v51, v49
    buffer_load_dwordx4 v242, s[24:27], s62 offen offset:2048 lds
    v_sin_f32 v52, v49
    v_add_f32 v49, v49, v48
    v_cvt_pk_bf16_f32 v129, v53, v54
    v_cvt_pk_bf16_f32 v145, -v54, v53
    v_cos_f32 v53, v49
    buffer_load_dwordx4 v243, s[24:27], s62 offen offset:3072 lds
    v_sin_f32 v54, v49
    v_add_f32 v49, v49, v50
    v_cvt_pk_bf16_f32 v130, v51, v52
    v_cvt_pk_bf16_f32 v146, -v52, v51
    v_cos_f32 v51, v49
    s_add_u32 s63, s63, 1
    s_cmp_eq_u32 s63, 8
    s_cselect_b32 s63, 0, s63
    s_lshl_b32 s61, s63, 12
    s_add_u32 s61, s61, s60
    s_add_u32 m0, s61, 0
    s_add_u32 s61, s63, 0
    s_bfe_u32 s62, s61, 0x30001
    s_bitcmp1_b32 s61, 0
    s_cselect_b32 s61, s13, s12
    s_mul_i32 s62, s62, 3584
    s_add_u32 s62, s62, s61
    buffer_load_dwordx4 v240, s[24:27], s62 offen offset:0 lds
    v_sin_f32 v52, v49
    v_add_f32 v49, v49, v48
    v_cvt_pk_bf16_f32 v131, v53, v54
    v_cvt_pk_bf16_f32 v147, -v54, v53
    v_cos_f32 v53, v49
    buffer_load_dwordx4 v241, s[24:27], s62 offen offset:1024 lds
    v_sin_f32 v54, v49
    v_add_f32 v49, v49, v48
    v_cvt_pk_bf16_f32 v132, v51, v52
    v_cvt_pk_bf16_f32 v148, -v52, v51
    v_cos_f32 v51, v49
    buffer_load_dwordx4 v242, s[24:27], s62 offen offset:2048 lds
    v_sin_f32 v52, v49
    v_add_f32 v49, v49, v48
    v_cvt_pk_bf16_f32 v133, v53, v54
    v_cvt_pk_bf16_f32 v149, -v54, v53
    v_cos_f32 v53, v49
    buffer_load_dwordx4 v243, s[24:27], s62 offen offset:3072 lds
    v_sin_f32 v54, v49
    v_cvt_pk_bf16_f32 v134, v51, v52
    v_cvt_pk_bf16_f32 v150, -v52, v51
    v_cvt_pk_bf16_f32 v135, v53, v54
    v_cvt_pk_bf16_f32 v151, -v54, v53
    s_add_u32 s63, s63, 1
    s_cmp_eq_u32 s63, 8
    s_cselect_b32 s63, 0, s63
    s_lshl_b32 s61, s63, 12
    s_add_u32 s61, s61, s60
    s_add_u32 m0, s61, 0
    s_add_u32 s61, s63, 0
    s_bfe_u32 s62, s61, 0x30001
    s_bitcmp1_b32 s61, 0
    s_cselect_b32 s61, s13, s12
    s_mul_i32 s62, s62, 3584
    s_add_u32 s62, s62, s61
    buffer_load_dwordx4 v240, s[24:27], s62 offen offset:0 lds
    v_cvt_f32_u32 v48, v57
    v_cvt_f32_u32 v49, v56
    v_mul_f32 v48, 0x3d000000, v48
    v_mul_f32 v49, 4.0, v49
    v_mul_f32 v50, 0x41500000, v48
    buffer_load_dwordx4 v241, s[24:27], s62 offen offset:1024 lds
    v_mul_f32 v49, v49, v48
    v_cos_f32 v51, v49
    v_sin_f32 v52, v49
    v_add_f32 v49, v49, v48
    v_cos_f32 v53, v49
    buffer_load_dwordx4 v242, s[24:27], s62 offen offset:2048 lds
    v_sin_f32 v54, v49
    v_add_f32 v49, v49, v48
    v_cvt_pk_bf16_f32 v136, v51, v52
    v_cvt_pk_bf16_f32 v152, -v52, v51
    v_cos_f32 v51, v49
    buffer_load_dwordx4 v243, s[24:27], s62 offen offset:3072 lds
    v_sin_f32 v52, v49
    v_add_f32 v49, v49, v48
    v_cvt_pk_bf16_f32 v137, v53, v54
    v_cvt_pk_bf16_f32 v153, -v54, v53
    v_cos_f32 v53, v49
    v_sin_f32 v54, v49
    v_add_f32 v49, v49, v50
    v_cvt_pk_bf16_f32 v138, v51, v52
    v_cvt_pk_bf16_f32 v154, -v52, v51
    v_cos_f32 v51, v49
    v_sin_f32 v52, v49
    v_add_f32 v49, v49, v48
    v_cvt_pk_bf16_f32 v139, v53, v54
    v_cvt_pk_bf16_f32 v155, -v54, v53
    v_cos_f32 v53, v49
    v_sin_f32 v54, v49
    v_add_f32 v49, v49, v48
    v_cvt_pk_bf16_f32 v140, v51, v52
    v_cvt_pk_bf16_f32 v156, -v52, v51
    v_cos_f32 v51, v49
    v_sin_f32 v52, v49
    v_add_f32 v49, v49, v48
    v_cvt_pk_bf16_f32 v141, v53, v54
    v_cvt_pk_bf16_f32 v157, -v54, v53
    v_cos_f32 v53, v49
    v_sin_f32 v54, v49
    v_cvt_pk_bf16_f32 v142, v51, v52
    v_cvt_pk_bf16_f32 v158, -v52, v51
    v_cvt_pk_bf16_f32 v143, v53, v54
    v_cvt_pk_bf16_f32 v159, -v54, v53
    v_bfe_u32 v164, v0, 2, 2
    v_bfe_u32 v165, v0, 5, 1
    v_mul_u32_u24 v165, 8, v165
    v_add_u32 v165, v165, v164
    v_lshlrev_b32 v248, 7, v165
    v_lshrrev_b32 v164, 4, v0
    v_xor_b32 v164, v164, v0
    v_bfe_u32 v164, v164, 3, 1
    v_lshl_add_u32 v248, v164, 6, v248
    v_lshrrev_b32 v164, 2, v0
    v_xor_b32 v164, v164, v0
    v_bfe_u32 v164, v164, 4, 1
    v_lshl_add_u32 v248, v164, 5, v248
    v_and_b32 v164, 3, v0
    v_lshl_add_u32 v248, v164, 3, v248
    v_add_u32 v248, s60, v248
    v_xor_b32 v249, 64, v248
    v_bfe_u32 v164, v0, 3, 3
    s_mov_b32 s98, 4096
    v_mul_lo_u32 v250, v164, s98
    v_bfe_u32 v164, v0, 4, 1
    v_lshlrev_b32 v164, 2, v164
    v_and_b32 v165, 7, v0
    v_xor_b32 v164, v164, v165
    v_lshl_add_u32 v250, v164, 4, v250
    s_lshl_b32 s98, s52, 7
    s_or_b32 s98, s98, s54
    v_add_u32 v250, s98, v250
    v_add_u32 v251, 0x7c00, v250
    v_add_u32 v252, 0xf800, v250
    v_add_u32 v253, 0x17400, v250
    s_cmp_lg_u32 s49, 0
    s_cbranch_scc1 nb_6
    v_and_b32 v56, 31, v0
    v_lshlrev_b32 v56, 7, v56
    s_mov_b32 s56, 0x1800000
    v_and_b32 v59, 1, v0
    v_lshlrev_b32 v59, 7, v59
bar_7:
    buffer_load_dword v57, v56, s[32:35], s56 offen sc1
    s_waitcnt vmcnt(0)
    v_cmp_gt_u32 vcc, 8, v57
    s_cbranch_vccz barok_8
    s_cmp_eq_u32 s55, 0
    s_cbranch_scc1 barok_8
    s_sub_u32 s55, s55, 1
    s_sleep 2
    s_branch bar_7
barok_8:
nb_6:
    s_barrier
    s_lshl_b32 s56, s48, 5
    s_add_u32 s56, s56, 0x0
    s_add_u32 s57, s56, 16384
    v_lshlrev_b32 v62, 4, v0
    v_lshl_add_u32 v62, v4, 10, v62
    v_add_u32 v62, 0x20000, v62
    v_and_b32 v63, 63, v0
    v_lshlrev_b32 v63, 4, v63
    v_add_u32 v63, 0x20000, v63
    buffer_load_dwordx4 v[32:35], v5, s[32:35], s56 offen sc1
    buffer_load_dwordx4 v[36:39], v5, s[32:35], s57 offen sc1
    s_lshr_b32 s58, s48, 6
    s_lshl_b32 s58, s58, 11
    s_and_b32 s59, s48, 63
    s_lshl_b32 s59, s59, 5
    s_add_u32 s58, s58, s59
    s_add_u32 s58, s58, 0x800000
    s_add_u32 s59, s58, 16384
    buffer_load_dwordx4 v[8:11], v7, s[32:35], s58 offen sc1
    buffer_load_dwordx4 v[12:15], v7, s[32:35], s59 offen sc1
    s_waitcnt vmcnt(2)
    ds_write_b128 v62, v[32:35]
    ds_write_b128 v62, v[36:39] offset:1024
    s_lshl_b32 s98, s2, 13
    s_add_u32 s98, s98, 0x1000000
    buffer_store_dwordx4 v[168:171], v173, s[32:35], s98 offen sc1
    s_lshl_b32 s98, s2, 13
    s_add_u32 s98, s98, 0x1001000
    buffer_store_dwordx4 v[168:171], v173, s[32:35], s98 offen sc1
    s_lshl_b32 s98, s2, 13
    s_add_u32 s98, s98, 0xa00000
    buffer_store_dwordx4 v[168:171], v173, s[32:35], s98 offen sc1
    s_lshl_b32 s98, s2, 13
    s_add_u32 s98, s98, 0xa01000
    buffer_store_dwordx4 v[168:171], v173, s[32:35], s98 offen sc1
    s_waitcnt lgkmcnt(0)
    s_barrier
    ds_read_b128 v[64:67], v63 offset:0
    ds_read_b128 v[68:71], v63 offset:1024
    ds_read_b128 v[72:75], v63 offset:2048
    ds_read_b128 v[76:79], v63 offset:3072
    ds_read_b128 v[80:83], v63 offset:4096
    ds_read_b128 v[84:87], v63 offset:5120
    ds_read_b128 v[88:91], v63 offset:6144
    ds_read_b128 v[92:95], v63 offset:7168
    s_waitcnt lgkmcnt(7)
    v_mfma_f32_16x16x32_bf16 v[32:35], v[64:67], v[96:99], 0
    v_mfma_f32_16x16x32_bf16 v[40:43], v[64:67], v[112:115], 0
    ds_read_b64_tr_b16 a[0:1], v248 offset:0
    ds_read_b64_tr_b16 a[2:3], v248 offset:512
    ds_read_b64_tr_b16 a[4:5], v249 offset:0
    ds_read_b64_tr_b16 a[6:7], v249 offset:512
    s_waitcnt lgkmcnt(10)
    v_mfma_f32_16x16x32_bf16 v[32:35], v[68:71], v[100:103], v[32:35]
    v_mfma_f32_16x16x32_bf16 v[40:43], v[68:71], v[116:119], v[40:43]
    ds_read_b64_tr_b16 a[8:9], v248 offset:2048
    ds_read_b64_tr_b16 a[10:11], v248 offset:2560
    ds_read_b64_tr_b16 a[12:13], v249 offset:2048
    ds_read_b64_tr_b16 a[14:15], v249 offset:2560
    s_waitcnt lgkmcnt(13)
    v_mfma_f32_16x16x32_bf16 v[32:35], v[72:75], v[104:107], v[32:35]
    v_mfma_f32_16x16x32_bf16 v[40:43], v[72:75], v[120:123], v[40:43]
    ds_read_b64_tr_b16 a[16:17], v248 offset:4096
    ds_read_b64_tr_b16 a[18:19], v248 offset:4608
    ds_read_b64_tr_b16 a[20:21], v249 offset:4096
    ds_read_b64_tr_b16 a[22:23], v249 offset:4608
    s_waitcnt lgkmcnt(15)
    v_mfma_f32_16x16x32_bf16 v[32:35], v[76:79], v[108:111], v[32:35]
    v_mfma_f32_16x16x32_bf16 v[40:43], v[76:79], v[124:127], v[40:43]
    ds_read_b64_tr_b16 a[24:25], v248 offset:6144
    ds_read_b64_tr_b16 a[26:27], v248 offset:6656
    ds_read_b64_tr_b16 a[28:29], v249 offset:6144
    ds_read_b64_tr_b16 a[30:31], v249 offset:6656
    s_waitcnt lgkmcnt(15)
    v_mfma_f32_16x16x32_bf16 v[36:39], v[80:83], v[96:99], 0
    v_mfma_f32_16x16x32_bf16 v[44:47], v[80:83], v[112:115], 0
    ds_read_b64_tr_b16 a[32:33], v248 offset:8192
    ds_read_b64_tr_b16 a[34:35], v248 offset:8704
    ds_read_b64_tr_b16 a[36:37], v249 offset:8192
    ds_read_b64_tr_b16 a[38:39], v249 offset:8704
    s_waitcnt lgkmcnt(15)
    v_mfma_f32_16x16x32_bf16 v[36:39], v[84:87], v[100:103], v[36:39]
    v_fma_mix_f32 v56, v40, v16, 0 op_sel:[0,1,0] op_sel_hi:[0,1,0]
    v_fma_mix_f32 v57, v40, v16, 0 op_sel:[0,0,0] op_sel_hi:[0,1,0]
    s_nop 0
    v_fma_mix_f32 v40, v32, v16, v57 op_sel:[0,1,0] op_sel_hi:[0,1,0]
    v_mfma_f32_16x16x32_bf16 v[44:47], v[84:87], v[116:119], v[44:47]
    v_fma_mix_f32 v32, v32, v16, -v56 op_sel:[0,0,0] op_sel_hi:[0,1,0]
    s_nop 0
    v_cvt_pk_bf16_f32 v48, v32, v40
    v_fma_mix_f32 v58, v41, v17, 0 op_sel:[0,1,0] op_sel_hi:[0,1,0]
    ds_read_b64_tr_b16 a[40:41], v248 offset:10240
    ds_read_b64_tr_b16 a[42:43], v248 offset:10752
    ds_read_b64_tr_b16 a[44:45], v249 offset:10240
    ds_read_b64_tr_b16 a[46:47], v249 offset:10752
    s_waitcnt lgkmcnt(15)
    v_mfma_f32_16x16x32_bf16 v[36:39], v[88:91], v[104:107], v[36:39]
    v_fma_mix_f32 v59, v41, v17, 0 op_sel:[0,0,0] op_sel_hi:[0,1,0]
    s_nop 0
    v_fma_mix_f32 v41, v33, v17, v59 op_sel:[0,1,0] op_sel_hi:[0,1,0]
    v_fma_mix_f32 v33, v33, v17, -v58 op_sel:[0,0,0] op_sel_hi:[0,1,0]
    s_nop 0
    v_cvt_pk_bf16_f32 v49, v33, v41
    v_mfma_f32_16x16x32_bf16 v[44:47], v[88:91], v[120:123], v[44:47]
    v_fma_mix_f32 v56, v42, v18, 0 op_sel:[0,1,0] op_sel_hi:[0,1,0]
    v_fma_mix_f32 v57, v42, v18, 0 op_sel:[0,0,0] op_sel_hi:[0,1,0]
    s_nop 0
    v_fma_mix_f32 v42, v34, v18, v57 op_sel:[0,1,0] op_sel_hi:[0,1,0]
    ds_read_b64_tr_b16 a[48:49], v248 offset:12288
    ds_read_b64_tr_b16 a[50:51], v248 offset:12800
    ds_read_b64_tr_b16 a[52:53], v249 offset:12288
    ds_read_b64_tr_b16 a[54:55], v249 offset:12800
    s_waitcnt lgkmcnt(15)
    v_mfma_f32_16x16x32_bf16 v[36:39], v[92:95], v[108:111], v[36:39]
    v_fma_mix_f32 v34, v34, v18, -v56 op_sel:[0,0,0] op_sel_hi:[0,1,0]
    s_nop 0
    v_cvt_pk_bf16_f32 v50, v34, v42
    v_fma_mix_f32 v58, v43, v19, 0 op_sel:[0,1,0] op_sel_hi:[0,1,0]
    v_mfma_f32_16x16x32_bf16 v[44:47], v[92:95], v[124:127], v[44:47]
    v_fma_mix_f32 v59, v43, v19, 0 op_sel:[0,0,0] op_sel_hi:[0,1,0]
    s_nop 0
    v_fma_mix_f32 v43, v35, v19, v59 op_sel:[0,1,0] op_sel_hi:[0,1,0]
    v_fma_mix_f32 v35, v35, v19, -v58 op_sel:[0,0,0] op_sel_hi:[0,1,0]
    s_nop 0
    v_cvt_pk_bf16_f32 v51, v35, v43
    ds_read_b64_tr_b16 a[56:57], v248 offset:14336
    ds_read_b64_tr_b16 a[58:59], v248 offset:14848
    ds_read_b64_tr_b16 a[60:61], v249 offset:14336
    ds_read_b64_tr_b16 a[62:63], v249 offset:14848
    v_mfma_f32_16x16x32_bf16 v[64:67], v[128:131], v[48:51], 0
    v_fma_mix_f32 v56, v44, v20, 0 op_sel:[0,1,0] op_sel_hi:[0,1,0]
    v_fma_mix_f32 v57, v44, v20, 0 op_sel:[0,0,0] op_sel_hi:[0,1,0]
    s_nop 0
    v_fma_mix_f32 v44, v36, v20, v57 op_sel:[0,1,0] op_sel_hi:[0,1,0]
    v_fma_mix_f32 v36, v36, v20, -v56 op_sel:[0,0,0] op_sel_hi:[0,1,0]
    s_nop 0
    v_cvt_pk_bf16_f32 v52, v36, v44
    v_mfma_f32_16x16x32_bf16 v[72:75], v[144:147], v[48:51], 0
    v_fma_mix_f32 v58, v45, v21, 0 op_sel:[0,1,0] op_sel_hi:[0,1,0]
    v_fma_mix_f32 v59, v45, v21, 0 op_sel:[0,0,0] op_sel_hi:[0,1,0]
    s_nop 0
    v_fma_mix_f32 v45, v37, v21, v59 op_sel:[0,1,0] op_sel_hi:[0,1,0]
    v_fma_mix_f32 v37, v37, v21, -v58 op_sel:[0,0,0] op_sel_hi:[0,1,0]
    s_nop 0
    v_cvt_pk_bf16_f32 v53, v37, v45
    ds_read_b64_tr_b16 a[64:65], v248 offset:16384
    ds_read_b64_tr_b16 a[66:67], v248 offset:16896
    ds_read_b64_tr_b16 a[68:69], v249 offset:16384
    ds_read_b64_tr_b16 a[70:71], v249 offset:16896
    v_mfma_f32_16x16x32_bf16 v[68:71], v[136:139], v[48:51], 0
    v_fma_mix_f32 v56, v46, v22, 0 op_sel:[0,1,0] op_sel_hi:[0,1,0]
    v_fma_mix_f32 v57, v46, v22, 0 op_sel:[0,0,0] op_sel_hi:[0,1,0]
    s_nop 0
    v_fma_mix_f32 v46, v38, v22, v57 op_sel:[0,1,0] op_sel_hi:[0,1,0]
    v_fma_mix_f32 v38, v38, v22, -v56 op_sel:[0,0,0] op_sel_hi:[0,1,0]
    s_nop 0
    v_cvt_pk_bf16_f32 v54, v38, v46
    v_mfma_f32_16x16x32_bf16 v[76:79], v[152:155], v[48:51], 0
    v_fma_mix_f32 v58, v47, v23, 0 op_sel:[0,1,0] op_sel_hi:[0,1,0]
    v_fma_mix_f32 v59, v47, v23, 0 op_sel:[0,0,0] op_sel_hi:[0,1,0]
    s_nop 0
    v_fma_mix_f32 v47, v39, v23, v59 op_sel:[0,1,0] op_sel_hi:[0,1,0]
    v_fma_mix_f32 v39, v39, v23, -v58 op_sel:[0,0,0] op_sel_hi:[0,1,0]
    s_nop 0
    v_cvt_pk_bf16_f32 v55, v39, v47
    ds_read_b64_tr_b16 a[72:73], v248 offset:18432
    ds_read_b64_tr_b16 a[74:75], v248 offset:18944
    ds_read_b64_tr_b16 a[76:77], v249 offset:18432
    ds_read_b64_tr_b16 a[78:79], v249 offset:18944
    s_waitcnt vmcnt(4)
    v_mfma_f32_16x16x32_bf16 v[64:67], v[132:135], v[52:55], v[64:67]
    v_lshlrev_b32 v80, 16, v8
    v_and_b32 v88, 0xffff0000, v8
    v_lshlrev_b32 v81, 16, v9
    v_and_b32 v89, 0xffff0000, v9
    v_mfma_f32_16x16x32_bf16 v[72:75], v[148:151], v[52:55], v[72:75]
    v_lshlrev_b32 v82, 16, v10
    v_and_b32 v90, 0xffff0000, v10
    v_lshlrev_b32 v83, 16, v11
    v_and_b32 v91, 0xffff0000, v11
    ds_read_b64_tr_b16 a[80:81], v248 offset:20480
    ds_read_b64_tr_b16 a[82:83], v248 offset:20992
    ds_read_b64_tr_b16 a[84:85], v249 offset:20480
    ds_read_b64_tr_b16 a[86:87], v249 offset:20992
    v_mfma_f32_16x16x32_bf16 v[68:71], v[140:143], v[52:55], v[68:71]
    v_lshlrev_b32 v84, 16, v12
    v_and_b32 v92, 0xffff0000, v12
    v_lshlrev_b32 v85, 16, v13
    v_and_b32 v93, 0xffff0000, v13
    v_mfma_f32_16x16x32_bf16 v[76:79], v[156:159], v[52:55], v[76:79]
    v_lshlrev_b32 v86, 16, v14
    v_and_b32 v94, 0xffff0000, v14
    v_lshlrev_b32 v87, 16, v15
    v_and_b32 v95, 0xffff0000, v15
    ds_read_b64_tr_b16 a[88:89], v248 offset:22528
    ds_read_b64_tr_b16 a[90:91], v248 offset:23040
    ds_read_b64_tr_b16 a[92:93], v249 offset:22528
    ds_read_b64_tr_b16 a[94:95], v249 offset:23040
    v_pk_mul_f32 v[56:57], v[72:73], v[88:89]
    v_pk_mul_f32 v[58:59], v[72:73], v[80:81]
    v_pk_fma_f32 v[56:57], v[64:65], v[80:81], v[56:57] neg_lo:[0,0,1] neg_hi:[0,0,1]
    v_pk_fma_f32 v[58:59], v[64:65], v[88:89], v[58:59]
    v_cvt_pk_bf16_f32 v48, v58, v56
    v_cvt_pk_bf16_f32 v49, v59, v57
    v_pk_mul_f32 v[56:57], v[74:75], v[90:91]
    v_pk_mul_f32 v[58:59], v[74:75], v[82:83]
    v_pk_fma_f32 v[56:57], v[66:67], v[82:83], v[56:57] neg_lo:[0,0,1] neg_hi:[0,0,1]
    v_pk_fma_f32 v[58:59], v[66:67], v[90:91], v[58:59]
    v_cvt_pk_bf16_f32 v50, v58, v56
    v_cvt_pk_bf16_f32 v51, v59, v57
    s_nop 1
    v_mfma_f32_16x16x32_bf16 v[40:43], v[48:51], v[128:131], 0
    v_pk_mul_f32 v[56:57], v[76:77], v[92:93]
    v_pk_mul_f32 v[58:59], v[76:77], v[84:85]
    v_pk_fma_f32 v[56:57], v[68:69], v[84:85], v[56:57] neg_lo:[0,0,1] neg_hi:[0,0,1]
    v_mfma_f32_16x16x32_bf16 v[32:35], v[48:51], v[144:147], 0
    v_pk_fma_f32 v[58:59], v[68:69], v[92:93], v[58:59]
    v_cvt_pk_bf16_f32 v52, v58, v56
    v_cvt_pk_bf16_f32 v53, v59, v57
    ds_read_b64_tr_b16 a[96:97], v248 offset:24576
    ds_read_b64_tr_b16 a[98:99], v248 offset:25088
    ds_read_b64_tr_b16 a[100:101], v249 offset:24576
    ds_read_b64_tr_b16 a[102:103], v249 offset:25088
    v_mfma_f32_16x16x32_bf16 v[44:47], v[48:51], v[136:139], 0
    v_pk_mul_f32 v[56:57], v[78:79], v[94:95]
    v_pk_mul_f32 v[58:59], v[78:79], v[86:87]
    v_pk_fma_f32 v[56:57], v[70:71], v[86:87], v[56:57] neg_lo:[0,0,1] neg_hi:[0,0,1]
    v_mfma_f32_16x16x32_bf16 v[36:39], v[48:51], v[152:155], 0
    v_pk_fma_f32 v[58:59], v[70:71], v[94:95], v[58:59]
    v_cvt_pk_bf16_f32 v54, v58, v56
    v_cvt_pk_bf16_f32 v55, v59, v57
    ds_read_b64_tr_b16 a[104:105], v248 offset:26624
    ds_read_b64_tr_b16 a[106:107], v248 offset:27136
    ds_read_b64_tr_b16 a[108:109], v249 offset:26624
    ds_read_b64_tr_b16 a[110:111], v249 offset:27136
    v_mfma_f32_16x16x32_bf16 v[40:43], v[52:55], v[132:135], v[40:43]
    v_lshlrev_b32 v62, 4, v0
    v_mfma_f32_16x16x32_bf16 v[32:35], v[52:55], v[148:151], v[32:35]
    v_add_u32 v62, 0x22000, v62
    ds_read_b64_tr_b16 a[112:113], v248 offset:28672
    ds_read_b64_tr_b16 a[114:115], v248 offset:29184
    ds_read_b64_tr_b16 a[116:117], v249 offset:28672
    ds_read_b64_tr_b16 a[118:119], v249 offset:29184
    v_mfma_f32_16x16x32_bf16 v[44:47], v[52:55], v[140:143], v[44:47]
    s_lshl_b32 s56, s48, 13
    v_mfma_f32_16x16x32_bf16 v[36:39], v[52:55], v[156:159], v[36:39]
    s_add_u32 s56, s56, 0x400000
    s_add_u32 s57, s56, 4096
    ds_read_b64_tr_b16 a[120:121], v248 offset:30720
    ds_read_b64_tr_b16 a[122:123], v248 offset:31232
    ds_read_b64_tr_b16 a[124:125], v249 offset:30720
    ds_read_b64_tr_b16 a[126:127], v249 offset:31232
    v_fma_mix_f32 v64, v40, v24, 0 op_sel:[0,1,0] op_sel_hi:[0,1,0]
    v_fma_mix_f32 v65, v40, v24, 0 op_sel:[0,0,0] op_sel_hi:[0,1,0]
    s_nop 0
    v_fma_mix_f32 v40, v32, v24, v65 op_sel:[0,1,0] op_sel_hi:[0,1,0]
    v_fma_mix_f32 v32, v32, v24, -v64 op_sel:[0,0,0] op_sel_hi:[0,1,0]
    s_nop 0
    v_cvt_pk_bf16_f32 v48, v40, v32
    s_lshl_b32 s98, s2, 13
    s_add_u32 s98, s98, 0x1400000
    buffer_store_dwordx4 v[168:171], v173, s[32:35], s98 offen sc1
    v_fma_mix_f32 v66, v41, v25, 0 op_sel:[0,1,0] op_sel_hi:[0,1,0]
    v_fma_mix_f32 v67, v41, v25, 0 op_sel:[0,0,0] op_sel_hi:[0,1,0]
    s_nop 0
    v_fma_mix_f32 v41, v33, v25, v67 op_sel:[0,1,0] op_sel_hi:[0,1,0]
    v_fma_mix_f32 v33, v33, v25, -v66 op_sel:[0,0,0] op_sel_hi:[0,1,0]
    s_nop 0
    v_cvt_pk_bf16_f32 v49, v41, v33
    s_lshl_b32 s98, s2, 13
    s_add_u32 s98, s98, 0x1401000
    buffer_store_dwordx4 v[168:171], v173, s[32:35], s98 offen sc1
    v_fma_mix_f32 v64, v42, v26, 0 op_sel:[0,1,0] op_sel_hi:[0,1,0]
    v_fma_mix_f32 v65, v42, v26, 0 op_sel:[0,0,0] op_sel_hi:[0,1,0]
    s_nop 0
    v_fma_mix_f32 v42, v34, v26, v65 op_sel:[0,1,0] op_sel_hi:[0,1,0]
    v_fma_mix_f32 v34, v34, v26, -v64 op_sel:[0,0,0] op_sel_hi:[0,1,0]
    s_nop 0
    v_cvt_pk_bf16_f32 v50, v42, v34
    s_lshl_b32 s98, s2, 13
    s_add_u32 s98, s98, 0xc00000
    buffer_store_dwordx4 v[168:171], v173, s[32:35], s98 offen sc1
    v_fma_mix_f32 v66, v43, v27, 0 op_sel:[0,1,0] op_sel_hi:[0,1,0]
    v_fma_mix_f32 v67, v43, v27, 0 op_sel:[0,0,0] op_sel_hi:[0,1,0]
    s_nop 0
    v_fma_mix_f32 v43, v35, v27, v67 op_sel:[0,1,0] op_sel_hi:[0,1,0]
    v_fma_mix_f32 v35, v35, v27, -v66 op_sel:[0,0,0] op_sel_hi:[0,1,0]
    s_nop 0
    v_cvt_pk_bf16_f32 v51, v43, v35
    s_lshl_b32 s98, s2, 13
    s_add_u32 s98, s98, 0xc01000
    buffer_store_dwordx4 v[168:171], v173, s[32:35], s98 offen sc1
    ds_write_b128 v62, v[48:51] offset:0
    v_fma_mix_f32 v64, v44, v28, 0 op_sel:[0,1,0] op_sel_hi:[0,1,0]
    v_fma_mix_f32 v65, v44, v28, 0 op_sel:[0,0,0] op_sel_hi:[0,1,0]
    s_nop 0
    v_fma_mix_f32 v44, v36, v28, v65 op_sel:[0,1,0] op_sel_hi:[0,1,0]
    v_fma_mix_f32 v36, v36, v28, -v64 op_sel:[0,0,0] op_sel_hi:[0,1,0]
    s_nop 0
    v_cvt_pk_bf16_f32 v52, v44, v36
    s_lshl_b32 s98, s2, 13
    s_add_u32 s98, s98, 0x200000
    buffer_store_dwordx4 v[168:171], v173, s[32:35], s98 offen sc1
    v_fma_mix_f32 v66, v45, v29, 0 op_sel:[0,1,0] op_sel_hi:[0,1,0]
    v_fma_mix_f32 v67, v45, v29, 0 op_sel:[0,0,0] op_sel_hi:[0,1,0]
    s_nop 0
    v_fma_mix_f32 v45, v37, v29, v67 op_sel:[0,1,0] op_sel_hi:[0,1,0]
    v_fma_mix_f32 v37, v37, v29, -v66 op_sel:[0,0,0] op_sel_hi:[0,1,0]
    s_nop 0
    v_cvt_pk_bf16_f32 v53, v45, v37
    s_lshl_b32 s98, s2, 13
    s_add_u32 s98, s98, 0x201000
    buffer_store_dwordx4 v[168:171], v173, s[32:35], s98 offen sc1
    v_fma_mix_f32 v64, v46, v30, 0 op_sel:[0,1,0] op_sel_hi:[0,1,0]
    v_fma_mix_f32 v65, v46, v30, 0 op_sel:[0,0,0] op_sel_hi:[0,1,0]
    s_nop 0
    v_fma_mix_f32 v46, v38, v30, v65 op_sel:[0,1,0] op_sel_hi:[0,1,0]
    v_fma_mix_f32 v38, v38, v30, -v64 op_sel:[0,0,0] op_sel_hi:[0,1,0]
    s_nop 0
    v_cvt_pk_bf16_f32 v54, v46, v38
    v_fma_mix_f32 v66, v47, v31, 0 op_sel:[0,1,0] op_sel_hi:[0,1,0]
    v_fma_mix_f32 v67, v47, v31, 0 op_sel:[0,0,0] op_sel_hi:[0,1,0]
    s_nop 0
    v_fma_mix_f32 v47, v39, v31, v67 op_sel:[0,1,0] op_sel_hi:[0,1,0]
    v_fma_mix_f32 v39, v39, v31, -v66 op_sel:[0,0,0] op_sel_hi:[0,1,0]
    s_nop 0
    v_cvt_pk_bf16_f32 v55, v47, v39
    ds_write_b128 v62, v[52:55] offset:4096
    s_waitcnt vmcnt(6)
    s_waitcnt lgkmcnt(0)
    s_barrier
    ds_read_b128 v[64:67], v63 offset:8192
    ds_read_b128 v[68:71], v63 offset:9216
    ds_read_b128 v[72:75], v63 offset:10240
    ds_read_b128 v[76:79], v63 offset:11264
    ds_read_b128 v[80:83], v63 offset:12288
    ds_read_b128 v[84:87], v63 offset:13312
    ds_read_b128 v[88:91], v63 offset:14336
    ds_read_b128 v[92:95], v63 offset:15360
    s_waitcnt lgkmcnt(7)
    v_mfma_f32_16x16x32_bf16 v[40:43], v[96:99], v[64:67], 0
    v_mfma_f32_16x16x32_bf16 v[32:35], v[112:115], v[64:67], 0
    s_waitcnt lgkmcnt(6)
    v_mfma_f32_16x16x32_bf16 v[40:43], v[100:103], v[68:71], v[40:43]
    v_mfma_f32_16x16x32_bf16 v[32:35], v[116:119], v[68:71], v[32:35]
    s_waitcnt lgkmcnt(5)
    v_mfma_f32_16x16x32_bf16 v[40:43], v[104:107], v[72:75], v[40:43]
    v_mfma_f32_16x16x32_bf16 v[32:35], v[120:123], v[72:75], v[32:35]
    s_waitcnt lgkmcnt(4)
    v_mfma_f32_16x16x32_bf16 v[40:43], v[108:111], v[76:79], v[40:43]
    v_mfma_f32_16x16x32_bf16 v[32:35], v[124:127], v[76:79], v[32:35]
    s_waitcnt lgkmcnt(3)
    v_mfma_f32_16x16x32_bf16 v[44:47], v[96:99], v[80:83], 0
    v_mfma_f32_16x16x32_bf16 v[36:39], v[112:115], v[80:83], 0
    s_waitcnt lgkmcnt(2)
    v_mfma_f32_16x16x32_bf16 v[44:47], v[100:103], v[84:87], v[44:47]
    v_mfma_f32_16x16x32_bf16 v[36:39], v[116:119], v[84:87], v[36:39]
    s_waitcnt lgkmcnt(1)
    v_mfma_f32_16x16x32_bf16 v[44:47], v[104:107], v[88:91], v[44:47]
    v_cvt_pk_bf16_f32 v48, v40, v32
    v_mfma_f32_16x16x32_bf16 v[36:39], v[120:123], v[88:91], v[36:39]
    v_cvt_pk_bf16_f32 v49, v41, v33
    s_waitcnt lgkmcnt(0)
    v_mfma_f32_16x16x32_bf16 v[44:47], v[108:111], v[92:95], v[44:47]
    v_cvt_pk_bf16_f32 v50, v42, v34
    v_mfma_f32_16x16x32_bf16 v[36:39], v[124:127], v[92:95], v[36:39]
    v_cvt_pk_bf16_f32 v51, v43, v35
    buffer_store_dwordx4 v[48:51], v6, s[32:35], s56 offen sc1
    s_nop 5
    v_cvt_pk_bf16_f32 v52, v44, v36
    v_cvt_pk_bf16_f32 v53, v45, v37
    v_cvt_pk_bf16_f32 v54, v46, v38
    v_cvt_pk_bf16_f32 v55, v47, v39
    buffer_store_dwordx4 v[52:55], v6, s[32:35], s57 offen sc1
    s_waitcnt lgkmcnt(0)
    s_lshr_b32 s56, s48, 3
    s_and_b32 s57, s48, 7
    s_mov_b32 s63, s65
    s_lshl_b32 s61, s63, 12
    s_add_u32 s61, s61, s60
    s_add_u32 m0, s61, 0
    s_add_u32 s61, s63, 8
    s_bfe_u32 s62, s61, 0x30001
    s_bitcmp1_b32 s61, 0
    s_cselect_b32 s61, s13, s12
    s_mul_i32 s62, s62, 3584
    s_add_u32 s62, s62, s61
    buffer_load_dwordx4 v240, s[24:27], s62 offen offset:0 lds
    s_lshl_b32 s57, s57, 3
    v_lshrrev_b32 v1, 5, v0
    buffer_load_dwordx4 v241, s[24:27], s62 offen offset:1024 lds
    v_add_u32 v1, s57, v1
    v_lshlrev_b32 v1, 5, v1
    buffer_load_dwordx4 v242, s[24:27], s62 offen offset:2048 lds
    v_add_u32 v1, s56, v1
    v_mul_u32_u24 v1, 896, v1
    buffer_load_dwordx4 v243, s[24:27], s62 offen offset:3072 lds
    v_and_b32 v2, 31, v0
    v_lshl_add_u32 v1, v2, 2, v1
    s_add_u32 s63, s63, 1
    s_cmp_eq_u32 s63, 8
    s_cselect_b32 s63, 0, s63
    s_lshl_b32 s61, s63, 12
    s_add_u32 s61, s61, s60
    s_add_u32 m0, s61, 0
    s_add_u32 s61, s63, 8
    s_bfe_u32 s62, s61, 0x30001
    s_bitcmp1_b32 s61, 0
    s_cselect_b32 s61, s13, s12
    s_mul_i32 s62, s62, 3584
    s_add_u32 s62, s62, s61
    buffer_load_dwordx4 v240, s[24:27], s62 offen offset:0 lds
    v_lshlrev_b32 v3, 13, v0
    v_lshrrev_b32 v11, 6, v0
    buffer_load_dwordx4 v241, s[24:27], s62 offen offset:1024 lds
    v_and_b32 v12, 15, v0
    v_mul_u32_u24 v15, 272, v12
    buffer_load_dwordx4 v242, s[24:27], s62 offen offset:2048 lds
    v_lshl_add_u32 v12, v11, 4, v12
    v_bfe_u32 v13, v0, 4, 2
    buffer_load_dwordx4 v243, s[24:27], s62 offen offset:3072 lds
    v_lshl_add_u32 v15, v13, 4, v15
    v_add_u32 v15, 0x20000, v15
    s_add_u32 s63, s63, 1
    s_cmp_eq_u32 s63, 8
    s_cselect_b32 s63, 0, s63
    s_lshl_b32 s61, s63, 12
    s_add_u32 s61, s61, s60
    s_add_u32 m0, s61, 0
    s_add_u32 s61, s63, 8
    s_bfe_u32 s62, s61, 0x30001
    s_bitcmp1_b32 s61, 0
    s_cselect_b32 s61, s13, s12
    s_mul_i32 s62, s62, 3584
    s_add_u32 s62, s62, s61
    buffer_load_dwordx4 v240, s[24:27], s62 offen offset:0 lds
    v_lshrrev_b32 v14, 1, v11
    v_lshlrev_b32 v14, 4, v14
    buffer_load_dwordx4 v241, s[24:27], s62 offen offset:1024 lds
    v_and_b32 v30, 1, v11
    v_lshl_add_u32 v14, v30, 1, v14
    buffer_load_dwordx4 v242, s[24:27], s62 offen offset:2048 lds
    v_mul_u32_u24 v14, 272, v14
    v_and_b32 v30, 63, v0
    buffer_load_dwordx4 v243, s[24:27], s62 offen offset:3072 lds
    v_lshl_add_u32 v14, v30, 2, v14
    v_add_u32 v14, 0x20000, v14
    s_add_u32 s63, s63, 1
    s_cmp_eq_u32 s63, 8
    s_cselect_b32 s63, 0, s63
    s_lshl_b32 s61, s63, 12
    s_add_u32 s61, s61, s60
    s_add_u32 m0, s61, 0
    s_add_u32 s61, s63, 8
    s_bfe_u32 s62, s61, 0x30001
    s_bitcmp1_b32 s61, 0
    s_cselect_b32 s61, s13, s12
    s_mul_i32 s62, s62, 3584
    s_add_u32 s62, s62, s61
    buffer_load_dwordx4 v240, s[24:27], s62 offen offset:0 lds
    v_cvt_f32_u32 v30, v12
    v_mul_f32 v31, 0x3b124925, v30
    buffer_load_dwordx4 v241, s[24:27], s62 offen offset:1024 lds
    v_cos_f32 v24, v31
    v_sin_f32 v25, v31
    buffer_load_dwordx4 v242, s[24:27], s62 offen offset:2048 lds
    v_mul_f32 v31, 0x3b924925, v30
    v_cos_f32 v26, v31
    buffer_load_dwordx4 v243, s[24:27], s62 offen offset:3072 lds
    v_sin_f32 v27, v31
    v_mul_f32 v31, 0x3bdb6db7, v30
    s_add_u32 s63, s63, 1
    s_cmp_eq_u32 s63, 8
    s_cselect_b32 s63, 0, s63
    s_lshl_b32 s61, s63, 12
    s_add_u32 s61, s61, s60
    s_add_u32 m0, s61, 0
    s_add_u32 s61, s63, 8
    s_bfe_u32 s62, s61, 0x30001
    s_bitcmp1_b32 s61, 0
    s_cselect_b32 s61, s13, s12
    s_mul_i32 s62, s62, 3584
    s_add_u32 s62, s62, s61
    buffer_load_dwordx4 v240, s[24:27], s62 offen offset:0 lds
    v_cos_f32 v28, v31
    v_sin_f32 v29, v31
    buffer_load_dwordx4 v241, s[24:27], s62 offen offset:1024 lds
    v_add_f32 v24, v24, v24
    v_add_f32 v25, v25, v25
    buffer_load_dwordx4 v242, s[24:27], s62 offen offset:2048 lds
    v_add_f32 v26, v26, v26
    v_add_f32 v27, v27, v27
    buffer_load_dwordx4 v243, s[24:27], s62 offen offset:3072 lds
    v_add_f32 v28, v28, v28
    v_add_f32 v29, v29, v29
    s_add_u32 s63, s63, 1
    s_cmp_eq_u32 s63, 8
    s_cselect_b32 s63, 0, s63
    s_lshl_b32 s61, s63, 12
    s_add_u32 s61, s61, s60
    s_add_u32 m0, s61, 0
    s_add_u32 s61, s63, 8
    s_bfe_u32 s62, s61, 0x30001
    s_bitcmp1_b32 s61, 0
    s_cselect_b32 s61, s13, s12
    s_mul_i32 s62, s62, 3584
    s_add_u32 s62, s62, s61
    buffer_load_dwordx4 v240, s[24:27], s62 offen offset:0 lds
    v_mul_u32_u24 v62, 3712, v13
    v_lshl_add_u32 v62, v12, 2, v62
    buffer_load_dwordx4 v241, s[24:27], s62 offen offset:1024 lds
    v_add_u32 v62, 0x22200, v62
    v_lshrrev_b32 v31, 5, v0
    buffer_load_dwordx4 v242, s[24:27], s62 offen offset:2048 lds
    v_mul_u32_u24 v30, 928, v31
    v_lshl_add_u32 v30, v2, 2, v30
    buffer_load_dwordx4 v243, s[24:27], s62 offen offset:3072 lds
    v_add_u32 v30, 0x25c00, v30
    v_mul_u32_u24 v63, 1856, v31
    s_add_u32 s63, s63, 1
    s_cmp_eq_u32 s63, 8
    s_cselect_b32 s63, 0, s63
    s_lshl_b32 s61, s63, 12
    s_add_u32 s61, s61, s60
    s_add_u32 m0, s61, 0
    s_add_u32 s61, s63, 8
    s_bfe_u32 s62, s61, 0x30001
    s_bitcmp1_b32 s61, 0
    s_cselect_b32 s61, s13, s12
    s_mul_i32 s62, s62, 3584
    s_add_u32 s62, s62, s61
    buffer_load_dwordx4 v240, s[24:27], s62 offen offset:0 lds
    v_lshl_add_u32 v63, v2, 3, v63
    v_add_u32 v63, 0x22200, v63
    buffer_load_dwordx4 v241, s[24:27], s62 offen offset:1024 lds
    v_bfe_u32 v31, v0, 2, 2
    v_mul_u32_u24 v31, 928, v31
    buffer_load_dwordx4 v242, s[24:27], s62 offen offset:2048 lds
    v_and_b32 v12, 3, v0
    v_lshl_add_u32 v31, v12, 3, v31
    buffer_load_dwordx4 v243, s[24:27], s62 offen offset:3072 lds
    v_lshl_add_u32 v31, v13, 5, v31
    v_lshl_add_u32 v31, v11, 7, v31
    s_add_u32 s63, s63, 1
    s_cmp_eq_u32 s63, 8
    s_cselect_b32 s63, 0, s63
    s_lshl_b32 s61, s63, 12
    s_add_u32 s61, s61, s60
    s_add_u32 m0, s61, 0
    s_add_u32 s61, s63, 8
    s_bfe_u32 s62, s61, 0x30001
    s_bitcmp1_b32 s61, 0
    s_cselect_b32 s61, s13, s12
    s_mul_i32 s62, s62, 3584
    s_add_u32 s62, s62, s61
    buffer_load_dwordx4 v240, s[24:27], s62 offen offset:0 lds
    v_add_u32 v31, 0x25c00, v31
    v_lshlrev_b32 v12, 4, v0
    buffer_load_dwordx4 v241, s[24:27], s62 offen offset:1024 lds
    buffer_load_dwordx4 v242, s[24:27], s62 offen offset:2048 lds
    buffer_load_dwordx4 v243, s[24:27], s62 offen offset:3072 lds
    s_barrier
    global_load_dword v4, v1, s[4:5] offset:0
    global_load_dword v5, v1, s[4:5] offset:128
    global_load_dword v6, v1, s[4:5] offset:256
    global_load_dword v7, v1, s[4:5] offset:384
    global_load_dword v8, v1, s[4:5] offset:512
    global_load_dword v9, v1, s[4:5] offset:640
    global_load_dword v10, v1, s[4:5] offset:768
    s_lshl_b32 s56, s48, 5
    s_add_u32 s56, s56, 0x400000
    buffer_load_dwordx4 v[16:19], v3, s[32:35], s56 offen sc1
    buffer_load_dwordx4 v[20:23], v3, s[32:35], s56 offen offset:16 sc1
    s_waitcnt vmcnt(0)
    s_branch pollc_11
poll_9:
    buffer_load_dwordx4 v[16:19], v3, s[32:35], s56 offen sc1
    buffer_load_dwordx4 v[20:23], v3, s[32:35], s56 offen offset:16 sc1
    s_waitcnt vmcnt(0)
pollc_11:
    v_max3_u32 v32, v16, v17, v18
    v_max3_u32 v32, v32, v19, v20
    v_max3_u32 v32, v32, v21, v22
    v_max_u32 v32, v32, v23
    v_cmp_eq_u32 vcc, -1, v32
    s_cbranch_vccz pollok_10
    s_cmp_eq_u32 s55, 0
    s_cbranch_scc1 pollok_10
    s_sub_u32 s55, s55, 1
    s_mov_b64 exec, vcc
    s_sleep 2
    s_branch poll_9
pollok_10:
    s_mov_b64 exec, -1
    ds_write_b32 v14, v16 offset:0
    ds_write_b32 v14, v17 offset:272
    ds_write_b32 v14, v18 offset:1088
    ds_write_b32 v14, v19 offset:1360
    ds_write_b32 v14, v20 offset:2176
    ds_write_b32 v14, v21 offset:2448
    ds_write_b32 v14, v22 offset:3264
    ds_write_b32 v14, v23 offset:3536
    buffer_load_dwordx4 v[160:163], v254, s[28:31], 0 offen
    v_add_u32 v254, 8192, v254
    buffer_load_dwordx4 v[160:163], v254, s[28:31], 0 offen
    v_add_u32 v254, 8192, v254
    buffer_load_dwordx4 v[160:163], v254, s[28:31], 0 offen
    v_add_u32 v254, 8192, v254
    buffer_load_dwordx4 v[160:163], v254, s[28:31], 0 offen
    v_add_u32 v254, 8192, v254
    buffer_load_dwordx4 v[160:163], v254, s[28:31], 0 offen
    v_add_u32 v254, 8192, v254
    buffer_load_dwordx4 v[160:163], v254, s[28:31], 0 offen
    v_add_u32 v254, 8192, v254
    buffer_load_dwordx4 v[160:163], v254, s[28:31], 0 offen
    v_add_u32 v254, 8192, v254
    s_waitcnt lgkmcnt(0)
    s_barrier
    ds_read_b128 v[64:67], v15 offset:0
    ds_read_b128 v[68:71], v15 offset:64
    ds_read_b128 v[72:75], v15 offset:128
    ds_read_b128 v[76:79], v15 offset:192
    ds_read_b128 v[80:83], v15 offset:4352
    ds_read_b128 v[84:87], v15 offset:4416
    ds_read_b128 v[88:91], v15 offset:4480
    ds_read_b128 v[92:95], v15 offset:4544
    v_lshlrev_b32 v128, 16, v4
    v_and_b32 v129, 0xffff0000, v4
    v_lshlrev_b32 v130, 16, v5
    v_and_b32 v131, 0xffff0000, v5
    v_lshlrev_b32 v132, 16, v6
    v_and_b32 v133, 0xffff0000, v6
    v_lshlrev_b32 v134, 16, v7
    v_and_b32 v135, 0xffff0000, v7
    v_lshlrev_b32 v136, 16, v8
    v_and_b32 v137, 0xffff0000, v8
    v_lshlrev_b32 v138, 16, v9
    v_and_b32 v139, 0xffff0000, v9
    v_lshlrev_b32 v140, 16, v10
    v_and_b32 v141, 0xffff0000, v10
    s_waitcnt lgkmcnt(7)
    v_mfma_f32_16x16x32_bf16 v[40:43], v[64:67], v[96:99], 0
    v_mfma_f32_16x16x32_bf16 v[32:35], v[64:67], v[112:115], 0
    ds_read_b64_tr_b16 a[128:129], v248 offset:0
    ds_read_b64_tr_b16 a[130:131], v248 offset:512
    ds_read_b64_tr_b16 a[132:133], v249 offset:0
    ds_read_b64_tr_b16 a[134:135], v249 offset:512
    s_waitcnt lgkmcnt(10)
    v_mfma_f32_16x16x32_bf16 v[40:43], v[68:71], v[100:103], v[40:43]
    v_mfma_f32_16x16x32_bf16 v[32:35], v[68:71], v[116:119], v[32:35]
    ds_read_b64_tr_b16 a[136:137], v248 offset:2048
    ds_read_b64_tr_b16 a[138:139], v248 offset:2560
    ds_read_b64_tr_b16 a[140:141], v249 offset:2048
    ds_read_b64_tr_b16 a[142:143], v249 offset:2560
    s_waitcnt lgkmcnt(13)
    v_mfma_f32_16x16x32_bf16 v[40:43], v[72:75], v[104:107], v[40:43]
    v_mfma_f32_16x16x32_bf16 v[32:35], v[72:75], v[120:123], v[32:35]
    ds_read_b64_tr_b16 a[144:145], v248 offset:4096
    ds_read_b64_tr_b16 a[146:147], v248 offset:4608
    ds_read_b64_tr_b16 a[148:149], v249 offset:4096
    ds_read_b64_tr_b16 a[150:151], v249 offset:4608
    s_waitcnt lgkmcnt(15)
    v_mfma_f32_16x16x32_bf16 v[40:43], v[76:79], v[108:111], v[40:43]
    v_mfma_f32_16x16x32_bf16 v[32:35], v[76:79], v[124:127], v[32:35]
    ds_read_b64_tr_b16 a[152:153], v248 offset:6144
    ds_read_b64_tr_b16 a[154:155], v248 offset:6656
    ds_read_b64_tr_b16 a[156:157], v249 offset:6144
    ds_read_b64_tr_b16 a[158:159], v249 offset:6656
    s_waitcnt lgkmcnt(15)
    v_mfma_f32_16x16x32_bf16 v[44:47], v[80:83], v[96:99], 0
    v_mfma_f32_16x16x32_bf16 v[36:39], v[80:83], v[112:115], 0
    ds_read_b64_tr_b16 a[160:161], v248 offset:8192
    ds_read_b64_tr_b16 a[162:163], v248 offset:8704
    ds_read_b64_tr_b16 a[164:165], v249 offset:8192
    ds_read_b64_tr_b16 a[166:167], v249 offset:8704
    s_waitcnt lgkmcnt(15)
    v_mfma_f32_16x16x32_bf16 v[44:47], v[84:87], v[100:103], v[44:47]
    v_mfma_f32_16x16x32_bf16 v[36:39], v[84:87], v[116:119], v[36:39]
    ds_read_b64_tr_b16 a[168:169], v248 offset:10240
    ds_read_b64_tr_b16 a[170:171], v248 offset:10752
    ds_read_b64_tr_b16 a[172:173], v249 offset:10240
    ds_read_b64_tr_b16 a[174:175], v249 offset:10752
    s_waitcnt lgkmcnt(15)
    v_mfma_f32_16x16x32_bf16 v[44:47], v[88:91], v[104:107], v[44:47]
    v_mfma_f32_16x16x32_bf16 v[36:39], v[88:91], v[120:123], v[36:39]
    v_pk_mul_f32 v[48:49], v[42:43], v[24:25] op_sel:[0,1] op_sel_hi:[1,1]
    v_pk_mul_f32 v[54:55], v[42:43], v[24:25] op_sel:[0,0] op_sel_hi:[1,0]
    v_pk_fma_f32 v[48:49], v[34:35], v[24:25], v[48:49] op_sel:[0,0,0] op_sel_hi:[1,0,1] neg_lo:[0,0,1] neg_hi:[0,0,1]
    v_pk_fma_f32 v[54:55], v[34:35], v[24:25], v[54:55] op_sel:[0,1,0] op_sel_hi:[1,1,1]
    ds_read_b64_tr_b16 a[176:177], v248 offset:12288
    ds_read_b64_tr_b16 a[178:179], v248 offset:12800
    ds_read_b64_tr_b16 a[180:181], v249 offset:12288
    ds_read_b64_tr_b16 a[182:183], v249 offset:12800
    s_waitcnt lgkmcnt(15)
    v_mfma_f32_16x16x32_bf16 v[44:47], v[92:95], v[108:111], v[44:47]
    v_mfma_f32_16x16x32_bf16 v[36:39], v[92:95], v[124:127], v[36:39]
    v_pk_fma_f32 v[16:17], v[48:49], s[36:37], v[32:33]
    v_pk_mul_f32 v[18:19], v[54:55], s[42:43]
    v_pk_fma_f32 v[20:21], v[48:49], s[38:39], v[32:33]
    v_pk_mul_f32 v[22:23], v[54:55], s[44:45]
    ds_read_b64_tr_b16 a[184:185], v248 offset:14336
    ds_read_b64_tr_b16 a[186:187], v248 offset:14848
    ds_read_b64_tr_b16 a[188:189], v249 offset:14336
    ds_read_b64_tr_b16 a[190:191], v249 offset:14848
    v_pk_fma_f32 v[68:69], v[48:49], s[40:41], v[32:33]
    v_pk_mul_f32 v[70:71], v[54:55], s[46:47]
    v_pk_add_f32 v[60:61], v[32:33], v[48:49]
    v_pk_mul_f32 v[50:51], v[44:45], v[26:27] op_sel:[0,1] op_sel_hi:[1,1]
    v_pk_mul_f32 v[56:57], v[44:45], v[26:27] op_sel:[0,0] op_sel_hi:[1,0]
    v_pk_fma_f32 v[50:51], v[36:37], v[26:27], v[50:51] op_sel:[0,0,0] op_sel_hi:[1,0,1] neg_lo:[0,0,1] neg_hi:[0,0,1]
    v_pk_fma_f32 v[56:57], v[36:37], v[26:27], v[56:57] op_sel:[0,1,0] op_sel_hi:[1,1,1]
    ds_read_b64_tr_b16 a[192:193], v248 offset:16384
    ds_read_b64_tr_b16 a[194:195], v248 offset:16896
    ds_read_b64_tr_b16 a[196:197], v249 offset:16384
    ds_read_b64_tr_b16 a[198:199], v249 offset:16896
    v_pk_mul_f32 v[52:53], v[46:47], v[28:29] op_sel:[0,1] op_sel_hi:[1,1]
    v_pk_mul_f32 v[58:59], v[46:47], v[28:29] op_sel:[0,0] op_sel_hi:[1,0]
    v_pk_fma_f32 v[52:53], v[38:39], v[28:29], v[52:53] op_sel:[0,0,0] op_sel_hi:[1,0,1] neg_lo:[0,0,1] neg_hi:[0,0,1]
    v_pk_fma_f32 v[58:59], v[38:39], v[28:29], v[58:59] op_sel:[0,1,0] op_sel_hi:[1,1,1]
    ds_read_b64_tr_b16 a[200:201], v248 offset:18432
    ds_read_b64_tr_b16 a[202:203], v248 offset:18944
    ds_read_b64_tr_b16 a[204:205], v249 offset:18432
    ds_read_b64_tr_b16 a[206:207], v249 offset:18944
    v_pk_add_f32 v[66:67], v[50:51], v[52:53]
    v_pk_add_f32 v[64:65], v[60:61], v[66:67]
    ds_write_b32 v62, v64 offset:0
    ds_write_b32 v62, v65 offset:1856
    v_pk_fma_f32 v[16:17], v[50:51], s[38:39], v[16:17]
    v_pk_fma_f32 v[18:19], v[56:57], s[44:45], v[18:19]
    v_pk_fma_f32 v[16:17], v[52:53], s[40:41], v[16:17]
    v_pk_fma_f32 v[18:19], v[58:59], s[46:47], v[18:19]
    v_pk_add_f32 v[44:45], v[16:17], v[18:19] neg_lo:[0,1] neg_hi:[0,1]
    v_pk_add_f32 v[46:47], v[16:17], v[18:19]
    ds_write_b32 v62, v44 offset:256
    ds_write_b32 v62, v45 offset:2112
    ds_write_b32 v62, v46 offset:1536
    ds_write_b32 v62, v47 offset:3392
    ds_read_b64_tr_b16 a[208:209], v248 offset:20480
    ds_read_b64_tr_b16 a[210:211], v248 offset:20992
    ds_read_b64_tr_b16 a[212:213], v249 offset:20480
    ds_read_b64_tr_b16 a[214:215], v249 offset:20992
    ds_read_b64_tr_b16 a[216:217], v248 offset:22528
    ds_read_b64_tr_b16 a[218:219], v248 offset:23040
    ds_read_b64_tr_b16 a[220:221], v249 offset:22528
    ds_read_b64_tr_b16 a[222:223], v249 offset:23040
    v_pk_fma_f32 v[20:21], v[50:51], s[40:41], v[20:21]
    v_pk_fma_f32 v[22:23], v[56:57], s[46:47], v[22:23] neg_lo:[1,0,0] neg_hi:[1,0,0]
    v_pk_fma_f32 v[20:21], v[52:53], s[36:37], v[20:21]
    v_pk_fma_f32 v[22:23], v[58:59], s[42:43], v[22:23] neg_lo:[1,0,0] neg_hi:[1,0,0]
    v_pk_add_f32 v[40:41], v[20:21], v[22:23] neg_lo:[0,1] neg_hi:[0,1]
    v_pk_add_f32 v[42:43], v[20:21], v[22:23]
    ds_write_b32 v62, v40 offset:512
    ds_write_b32 v62, v41 offset:2368
    ds_write_b32 v62, v42 offset:1280
    ds_write_b32 v62, v43 offset:3136
    ds_read_b64_tr_b16 a[224:225], v248 offset:24576
    ds_read_b64_tr_b16 a[226:227], v248 offset:25088
    ds_read_b64_tr_b16 a[228:229], v249 offset:24576
    ds_read_b64_tr_b16 a[230:231], v249 offset:25088
    ds_read_b64_tr_b16 a[232:233], v248 offset:26624
    ds_read_b64_tr_b16 a[234:235], v248 offset:27136
    ds_read_b64_tr_b16 a[236:237], v249 offset:26624
    ds_read_b64_tr_b16 a[238:239], v249 offset:27136
    v_pk_fma_f32 v[68:69], v[50:51], s[36:37], v[68:69]
    v_pk_fma_f32 v[70:71], v[56:57], s[42:43], v[70:71] neg_lo:[1,0,0] neg_hi:[1,0,0]
    v_pk_fma_f32 v[68:69], v[52:53], s[38:39], v[68:69]
    v_pk_fma_f32 v[70:71], v[58:59], s[44:45], v[70:71]
    v_pk_add_f32 v[44:45], v[68:69], v[70:71] neg_lo:[0,1] neg_hi:[0,1]
    v_pk_add_f32 v[46:47], v[68:69], v[70:71]
    ds_write_b32 v62, v44 offset:768
    ds_write_b32 v62, v45 offset:2624
    ds_write_b32 v62, v46 offset:1024
    ds_write_b32 v62, v47 offset:2880
    ds_read_b64_tr_b16 a[240:241], v248 offset:28672
    ds_read_b64_tr_b16 a[242:243], v248 offset:29184
    ds_read_b64_tr_b16 a[244:245], v249 offset:28672
    ds_read_b64_tr_b16 a[246:247], v249 offset:29184
    ds_read_b64_tr_b16 a[248:249], v248 offset:30720
    ds_read_b64_tr_b16 a[250:251], v248 offset:31232
    ds_read_b64_tr_b16 a[252:253], v249 offset:30720
    ds_read_b64_tr_b16 a[254:255], v249 offset:31232
    s_waitcnt lgkmcnt(0)
    s_barrier
    ds_read_b64 v[64:65], v63 offset:0
    ds_read_b64 v[66:67], v63 offset:256
    ds_read_b64 v[68:69], v63 offset:512
    ds_read_b64 v[70:71], v63 offset:768
    ds_read_b64 v[72:73], v63 offset:1024
    ds_read_b64 v[74:75], v63 offset:1280
    ds_read_b64 v[76:77], v63 offset:1536
    s_waitcnt lgkmcnt(6)
    v_pk_add_f32 v[128:129], v[128:129], v[64:65]
    s_waitcnt lgkmcnt(5)
    v_pk_add_f32 v[130:131], v[130:131], v[66:67]
    s_waitcnt lgkmcnt(4)
    v_pk_add_f32 v[132:133], v[132:133], v[68:69]
    s_waitcnt lgkmcnt(3)
    v_pk_add_f32 v[134:135], v[134:135], v[70:71]
    s_waitcnt lgkmcnt(2)
    v_pk_add_f32 v[136:137], v[136:137], v[72:73]
    s_waitcnt lgkmcnt(1)
    v_pk_add_f32 v[138:139], v[138:139], v[74:75]
    s_waitcnt lgkmcnt(0)
    v_pk_add_f32 v[140:141], v[140:141], v[76:77]
    v_subrev_u32 v52, 23552, v30
    v_mov_b32 v53, 0x2edbe6ff
    s_mov_b32 s58, 0x3f800054
    v_pk_add_f32 v[46:47], v[128:129], v[130:131]
    v_pk_mul_f32 v[48:49], v[128:129], v[128:129]
    v_cvt_pk_bf16_f32 v4, v128, v129
    v_pk_add_f32 v[46:47], v[46:47], v[132:133]
    v_pk_fma_f32 v[48:49], v[130:131], v[130:131], v[48:49]
    ds_write_b32 v52, v4 offset:0
    v_pk_add_f32 v[46:47], v[46:47], v[134:135]
    v_pk_fma_f32 v[48:49], v[132:133], v[132:133], v[48:49]
    v_cvt_pk_bf16_f32 v5, v130, v131
    v_pk_add_f32 v[46:47], v[46:47], v[136:137]
    v_pk_fma_f32 v[48:49], v[134:135], v[134:135], v[48:49]
    ds_write_b32 v52, v5 offset:128
    v_pk_add_f32 v[46:47], v[46:47], v[138:139]
    v_pk_fma_f32 v[48:49], v[136:137], v[136:137], v[48:49]
    v_cvt_pk_bf16_f32 v6, v132, v133
    v_pk_add_f32 v[46:47], v[46:47], v[140:141]
    v_pk_fma_f32 v[48:49], v[138:139], v[138:139], v[48:49]
    ds_write_b32 v52, v6 offset:256
    v_add_f32 v46, v46, v47
    v_pk_fma_f32 v[48:49], v[140:141], v[140:141], v[48:49]
    v_cvt_pk_bf16_f32 v7, v134, v135
    v_add_f32_dpp v46, v46, v46 quad_perm:[1,0,3,2] row_mask:0xf bank_mask:0xf
    v_add_f32 v48, v48, v49
    ds_write_b32 v52, v7 offset:384
    v_add_f32_dpp v46, v46, v46 quad_perm:[2,3,0,1] row_mask:0xf bank_mask:0xf
    v_add_f32_dpp v48, v48, v48 quad_perm:[1,0,3,2] row_mask:0xf bank_mask:0xf
    v_cvt_pk_bf16_f32 v8, v136, v137
    v_add_f32_dpp v46, v46, v46 row_half_mirror row_mask:0xf bank_mask:0xf
    v_add_f32_dpp v48, v48, v48 quad_perm:[2,3,0,1] row_mask:0xf bank_mask:0xf
    ds_write_b32 v52, v8 offset:512
    v_add_f32_dpp v46, v46, v46 row_mirror row_mask:0xf bank_mask:0xf
    v_add_f32_dpp v48, v48, v48 row_half_mirror row_mask:0xf bank_mask:0xf
    v_cvt_pk_bf16_f32 v9, v138, v139
    v_mov_b32 v50, v46
    v_add_f32_dpp v48, v48, v48 row_mirror row_mask:0xf bank_mask:0xf
    ds_write_b32 v52, v9 offset:640
    v_permlane16_swap_b32 v46, v50
    v_mov_b32 v51, v48
    v_cvt_pk_bf16_f32 v10, v140, v141
    v_add_f32 v46, v46, v50
    v_permlane16_swap_b32 v48, v51
    ds_write_b32 v52, v10 offset:768
    v_add_f32 v48, v48, v51
    v_mul_f32 v46, 0x3b124925, v46
    v_mul_f32 v48, 0x3b124925, v48
    v_fma_f32 v48, -v46, v46, v48
    v_max_f32 v48, 0, v48
    v_fma_f32 v48, v48, s58, v53
    v_rsq_f32 v48, v48
    s_mul_i32 s56, s48, 7168
    s_add_u32 s56, s56, 0x1000000
    v_mul_f32 v46, v46, v48
    v_pk_fma_f32 v[128:129], v[128:129], v[48:49], v[46:47] op_sel_hi:[1,0,0] neg_lo:[0,0,1] neg_hi:[0,0,1]
    v_pk_fma_f32 v[130:131], v[130:131], v[48:49], v[46:47] op_sel_hi:[1,0,0] neg_lo:[0,0,1] neg_hi:[0,0,1]
    v_pk_fma_f32 v[132:133], v[132:133], v[48:49], v[46:47] op_sel_hi:[1,0,0] neg_lo:[0,0,1] neg_hi:[0,0,1]
    v_pk_fma_f32 v[134:135], v[134:135], v[48:49], v[46:47] op_sel_hi:[1,0,0] neg_lo:[0,0,1] neg_hi:[0,0,1]
    v_pk_fma_f32 v[136:137], v[136:137], v[48:49], v[46:47] op_sel_hi:[1,0,0] neg_lo:[0,0,1] neg_hi:[0,0,1]
    v_pk_fma_f32 v[138:139], v[138:139], v[48:49], v[46:47] op_sel_hi:[1,0,0] neg_lo:[0,0,1] neg_hi:[0,0,1]
    v_pk_fma_f32 v[140:141], v[140:141], v[48:49], v[46:47] op_sel_hi:[1,0,0] neg_lo:[0,0,1] neg_hi:[0,0,1]
    v_cvt_pk_bf16_f32 v64, v128, v129
    ds_write_b32 v30, v64 offset:0
    v_cvt_pk_bf16_f32 v65, v130, v131
    ds_write_b32 v30, v65 offset:128
    v_cvt_pk_bf16_f32 v66, v132, v133
    ds_write_b32 v30, v66 offset:256
    v_cvt_pk_bf16_f32 v67, v134, v135
    ds_write_b32 v30, v67 offset:384
    v_cvt_pk_bf16_f32 v68, v136, v137
    ds_write_b32 v30, v68 offset:512
    v_cvt_pk_bf16_f32 v69, v138, v139
    ds_write_b32 v30, v69 offset:640
    v_cvt_pk_bf16_f32 v70, v140, v141
    ds_write_b32 v30, v70 offset:768
    s_add_u32 s57, s56, 4096
    s_waitcnt lgkmcnt(0)
    s_barrier
    ds_read_b64_tr_b16 v[20:21], v31
    ds_read_b64_tr_b16 v[22:23], v31 offset:3712
    ds_read_b64_tr_b16 v[24:25], v31 offset:512
    ds_read_b64_tr_b16 v[26:27], v31 offset:4224
    v_cmp_gt_u32 vcc, 192, v0
    v_mov_b32 v13, 0x80000000
    s_nop 0
    v_cndmask_b32 v13, v13, v12, vcc
    v_and_b32 v14, 63, v0
    v_lshlrev_b32 v15, 4, v14
    s_mul_i32 s58, s49, 1856
    s_add_u32 s58, s58, 0x20000
    v_add_u32 v16, s58, v15
    ds_read_b128 v[32:35], v16
    ds_read_b128 v[36:39], v16 offset:928
    v_readfirstlane_b32 s58, v1
    v_mov_b32 v17, 0x80000000
    s_waitcnt lgkmcnt(4)
    buffer_store_dwordx4 v[20:23], v12, s[32:35], s56 offen sc1
    v_cmp_gt_u32 vcc, 56, v14
    s_add_u32 s58, s58, 0xa00000
    s_add_u32 s59, s58, 28672
    v_cndmask_b32 v15, v17, v15, vcc
    s_waitcnt lgkmcnt(2)
    buffer_store_dwordx4 v[24:27], v13, s[32:35], s57 offen sc1
    s_waitcnt lgkmcnt(0)
    buffer_store_dwordx4 v[32:35], v15, s[32:35], s58 offen sc1
    buffer_store_dwordx4 v[36:39], v15, s[32:35], s59 offen sc1
    s_waitcnt lgkmcnt(0)
    v_bfe_u32 v8, v0, 5, 1
    v_mul_u32_u24 v8, 448, v8
    s_mov_b32 s63, s64
    s_cmp_ge_u32 s63, 6
    s_cselect_b32 s61, 6, 0
    s_sub_u32 s63, s63, s61
    s_lshl_b32 s61, s63, 12
    s_add_u32 s61, s61, s60
    s_add_u32 m0, s61, 0
    s_add_u32 s61, s63, 0
    s_cmp_ge_u32 s61, 14
    s_cselect_b32 s62, s17, s16
    s_add_u32 s62, s62, s61
    s_lshl_b32 s62, s62, 17
    buffer_load_dwordx4 v250, s[28:31], s62 offen offset:0 lds
    s_mul_i32 s98, s50, 64
    v_add_u32 v8, s98, v8
    buffer_load_dwordx4 v251, s[28:31], s62 offen offset:1024 lds
    v_and_b32 v9, 31, v0
    v_add_lshl_u32 v2, v8, v9, 4
    buffer_load_dwordx4 v252, s[28:31], s62 offen offset:2048 lds
    v_lshrrev_b32 v3, 2, v0
    v_and_b32 v3, 16, v3
    buffer_load_dwordx4 v253, s[28:31], s62 offen offset:3072 lds
    v_xor_b32 v9, v9, v3
    v_add_lshl_u32 v3, v8, v9, 4
    s_add_u32 s63, s63, 1
    s_cmp_eq_u32 s63, 6
    s_cselect_b32 s63, 0, s63
    s_lshl_b32 s61, s63, 12
    s_add_u32 s61, s61, s60
    s_add_u32 m0, s61, 0
    s_add_u32 s61, s63, 0
    s_cmp_ge_u32 s61, 14
    s_cselect_b32 s62, s17, s16
    s_add_u32 s62, s62, s61
    s_lshl_b32 s62, s62, 17
    buffer_load_dwordx4 v250, s[28:31], s62 offen offset:0 lds
    v_and_b32 v8, 63, v0
    v_lshlrev_b32 v8, 4, v8
    buffer_load_dwordx4 v251, s[28:31], s62 offen offset:1024 lds
    v_add_u32 v6, 0x20000, v8
    v_bfe_u32 v8, v0, 2, 2
    buffer_load_dwordx4 v252, s[28:31], s62 offen offset:2048 lds
    v_bfe_u32 v9, v0, 5, 1
    v_mul_u32_u24 v9, 4, v9
    buffer_load_dwordx4 v253, s[28:31], s62 offen offset:3072 lds
    v_add_u32 v9, v9, v8
    v_lshlrev_b32 v4, 7, v9
    s_add_u32 s63, s63, 1
    s_cmp_eq_u32 s63, 6
    s_cselect_b32 s63, 0, s63
    s_lshl_b32 s61, s63, 12
    s_add_u32 s61, s61, s60
    s_add_u32 m0, s61, 0
    s_add_u32 s61, s63, 0
    s_cmp_ge_u32 s61, 14
    s_cselect_b32 s62, s17, s16
    s_add_u32 s62, s62, s61
    s_lshl_b32 s62, s62, 17
    buffer_load_dwordx4 v250, s[28:31], s62 offen offset:0 lds
    v_lshrrev_b32 v8, 4, v0
    v_xor_b32 v8, v8, v0
    buffer_load_dwordx4 v251, s[28:31], s62 offen offset:1024 lds
    v_bfe_u32 v8, v8, 3, 1
    v_lshl_add_u32 v4, v8, 6, v4
    buffer_load_dwordx4 v252, s[28:31], s62 offen offset:2048 lds
    v_bfe_u32 v8, v0, 4, 1
    v_lshl_add_u32 v4, v8, 5, v4
    buffer_load_dwordx4 v253, s[28:31], s62 offen offset:3072 lds
    v_and_b32 v8, 3, v0
    v_lshl_add_u32 v4, v8, 3, v4
    s_add_u32 s63, s63, 1
    s_cmp_eq_u32 s63, 6
    s_cselect_b32 s63, 0, s63
    s_lshl_b32 s61, s63, 12
    s_add_u32 s61, s61, s60
    s_add_u32 m0, s61, 0
    s_add_u32 s61, s63, 0
    s_cmp_ge_u32 s61, 14
    s_cselect_b32 s62, s17, s16
    s_add_u32 s62, s62, s61
    s_lshl_b32 s62, s62, 17
    buffer_load_dwordx4 v250, s[28:31], s62 offen offset:0 lds
    v_add_u32 v4, s60, v4
    v_xor_b32 v5, 64, v4
    buffer_load_dwordx4 v251, s[28:31], s62 offen offset:1024 lds
    buffer_load_dwordx4 v252, s[28:31], s62 offen offset:2048 lds
    buffer_load_dwordx4 v253, s[28:31], s62 offen offset:3072 lds
    s_add_u32 s63, s63, 1
    s_cmp_eq_u32 s63, 6
    s_cselect_b32 s63, 0, s63
    s_lshl_b32 s61, s63, 12
    s_add_u32 s61, s61, s60
    s_add_u32 m0, s61, 0
    s_add_u32 s61, s63, 0
    s_cmp_ge_u32 s61, 14
    s_cselect_b32 s62, s17, s16
    s_add_u32 s62, s62, s61
    s_lshl_b32 s62, s62, 17
    buffer_load_dwordx4 v250, s[28:31], s62 offen offset:0 lds
    buffer_load_dwordx4 v251, s[28:31], s62 offen offset:1024 lds
    buffer_load_dwordx4 v252, s[28:31], s62 offen offset:2048 lds
    buffer_load_dwordx4 v253, s[28:31], s62 offen offset:3072 lds
    s_add_u32 s63, s63, 1
    s_cmp_eq_u32 s63, 6
    s_cselect_b32 s63, 0, s63
    s_lshl_b32 s61, s63, 12
    s_add_u32 s61, s61, s60
    s_add_u32 m0, s61, 0
    s_add_u32 s61, s63, 0
    s_cmp_ge_u32 s61, 14
    s_cselect_b32 s62, s17, s16
    s_add_u32 s62, s62, s61
    s_lshl_b32 s62, s62, 17
    buffer_load_dwordx4 v250, s[28:31], s62 offen offset:0 lds
    buffer_load_dwordx4 v251, s[28:31], s62 offen offset:1024 lds
    buffer_load_dwordx4 v252, s[28:31], s62 offen offset:2048 lds
    buffer_load_dwordx4 v253, s[28:31], s62 offen offset:3072 lds
    s_barrier
    s_mul_i32 s56, s49, 458752
    s_add_u32 s56, s56, 0x1000000
    s_mul_i32 s57, s49, 401408
    s_add_u32 s57, s57, 0x1400000
    s_lshr_b32 s58, s49, 1
    s_lshl_b32 s58, s58, 5
    s_lshl_b32 s59, s52, 6
    s_add_u32 s58, s58, s59
    v_and_b32 v9, 31, v0
    v_add_lshl_u32 v9, v9, s58, 1
    v_and_b32 v9, 0xfff, v9
    global_load_ushort v26, v9, s[18:19]
    s_cmp_lg_u32 s53, 0
    s_cbranch_scc1 b1skip_12
    s_lshl_b32 s58, s49, 5
    s_lshl_b32 s59, s51, 7
    s_add_u32 s58, s58, s59
    v_bfe_u32 v9, v0, 5, 1
    v_lshlrev_b32 v9, 3, v9
    v_add_u32 v9, s58, v9
    global_load_dwordx2 v[28:29], v9, s[14:15]
    global_load_dwordx2 v[30:31], v9, s[14:15] offset:16
    s_lshl_b32 s44, s51, 2
    s_add_u32 s44, s44, s49
    s_mul_i32 s44, s44, 14336
    s_add_u32 s44, s44, 0x1400000
    s_mov_b32 s42, 0xbdd2d3e8
    s_mov_b32 s43, s42
    s_add_u32 s101, s56, 0
    buffer_load_dwordx4 v[32:35], v2, s[32:35], s101 offen offset:0 sc1
    s_add_u32 s101, s56, 14336
    buffer_load_dwordx4 v[36:39], v2, s[32:35], s101 offen offset:0 sc1
    s_add_u32 s101, s56, 28672
    buffer_load_dwordx4 v[40:43], v2, s[32:35], s101 offen offset:0 sc1
    s_add_u32 s101, s56, 43008
    buffer_load_dwordx4 v[44:47], v2, s[32:35], s101 offen offset:0 sc1
    s_add_u32 s101, s56, 57344
    buffer_load_dwordx4 v[48:51], v2, s[32:35], s101 offen offset:0 sc1
    s_add_u32 s101, s56, 71680
    buffer_load_dwordx4 v[52:55], v2, s[32:35], s101 offen offset:0 sc1
    s_add_u32 s101, s56, 86016
    buffer_load_dwordx4 v[56:59], v2, s[32:35], s101 offen offset:0 sc1
    s_add_u32 s101, s56, 100352
    buffer_load_dwordx4 v[60:63], v2, s[32:35], s101 offen offset:0 sc1
    s_add_u32 s101, s56, 114688
    buffer_load_dwordx4 v[64:67], v2, s[32:35], s101 offen offset:0 sc1
    s_add_u32 s101, s56, 129024
    buffer_load_dwordx4 v[68:71], v2, s[32:35], s101 offen offset:0 sc1
    s_add_u32 s101, s56, 143360
    buffer_load_dwordx4 v[72:75], v2, s[32:35], s101 offen offset:0 sc1
    s_add_u32 s101, s56, 157696
    buffer_load_dwordx4 v[76:79], v2, s[32:35], s101 offen offset:0 sc1
    s_waitcnt vmcnt(12)
    v_lshlrev_b32 v16, 16, v28
    v_and_b32 v17, 0xffff0000, v28
    v_lshlrev_b32 v18, 16, v29
    v_and_b32 v19, 0xffff0000, v29
    v_lshlrev_b32 v20, 16, v30
    v_and_b32 v21, 0xffff0000, v30
    v_lshlrev_b32 v22, 16, v31
    v_and_b32 v23, 0xffff0000, v31
    v_mov_b32 v27, 0xc0135761
    v_mov_b32 v96, v16
    v_mov_b32 v104, 0
    v_mov_b32 v97, v17
    v_mov_b32 v105, 0
    v_mov_b32 v98, v18
    v_mov_b32 v106, 0
    v_mov_b32 v99, v19
    v_mov_b32 v107, 0
    v_mov_b32 v100, v20
    v_mov_b32 v108, 0
    v_mov_b32 v101, v21
    v_mov_b32 v109, 0
    v_mov_b32 v102, v22
    v_mov_b32 v110, 0
    v_mov_b32 v103, v23
    v_mov_b32 v111, 0
    s_waitcnt vmcnt(10)
    v_max3_u32 v8, v32, v33, v34
    v_max3_u32 v8, v8, v35, v36
    v_max3_u32 v8, v8, v37, v38
    v_max_u32 v8, v8, v39
    v_cmp_eq_u32 vcc, -1, v8
    s_cbranch_vccnz rty_15
bk_16:
    v_mfma_f32_32x32x16_bf16 v[112:127], a[4:7], v[32:35], 0
    s_add_u32 s101, s56, 172032
    buffer_load_dwordx4 v[80:83], v2, s[32:35], s101 offen offset:0 sc1
    v_mfma_f32_32x32x16_bf16 v[96:111], a[0:3], v[32:35], v[96:111]
    s_waitcnt vmcnt(9)
    v_max3_u32 v8, v40, v41, v42
    v_max3_u32 v9, v43, v44, v45
    v_mfma_f32_32x32x16_bf16 v[112:127], a[12:15], v[36:39], v[112:127]
    s_add_u32 s101, s56, 186368
    buffer_load_dwordx4 v[84:87], v2, s[32:35], s101 offen offset:0 sc1
    v_max3_u32 v8, v8, v46, v47
    v_max_u32 v8, v8, v9
    v_cmp_eq_u32 vcc, -1, v8
    v_mfma_f32_32x32x16_bf16 v[96:111], a[8:11], v[36:39], v[96:111]
    s_cbranch_vccnz rty_17
bk_18:
    ds_read_b64_tr_b16 v[160:161], v4 offset:0
    ds_read_b64_tr_b16 v[162:163], v4 offset:1024
    ds_read_b64_tr_b16 v[164:165], v5 offset:0
    ds_read_b64_tr_b16 v[166:167], v5 offset:1024
    v_mfma_f32_32x32x16_bf16 v[112:127], a[20:23], v[40:43], v[112:127]
    s_add_u32 s101, s56, 200704
    buffer_load_dwordx4 v[88:91], v2, s[32:35], s101 offen offset:0 sc1
    v_mfma_f32_32x32x16_bf16 v[96:111], a[16:19], v[40:43], v[96:111]
    s_waitcnt vmcnt(9)
    v_max3_u32 v8, v48, v49, v50
    v_max3_u32 v9, v51, v52, v53
    v_mfma_f32_32x32x16_bf16 v[112:127], a[28:31], v[44:47], v[112:127]
    s_add_u32 s101, s56, 215040
    buffer_load_dwordx4 v[92:95], v2, s[32:35], s101 offen offset:0 sc1
    v_max3_u32 v8, v8, v54, v55
    v_max_u32 v8, v8, v9
    v_cmp_eq_u32 vcc, -1, v8
    v_mfma_f32_32x32x16_bf16 v[96:111], a[24:27], v[44:47], v[96:111]
    s_cbranch_vccnz rty_19
bk_20:
    ds_read_b64_tr_b16 v[168:169], v4 offset:2048
    ds_read_b64_tr_b16 v[170:171], v4 offset:3072
    ds_read_b64_tr_b16 v[172:173], v5 offset:2048
    ds_read_b64_tr_b16 v[174:175], v5 offset:3072
    v_mfma_f32_32x32x16_bf16 v[112:127], a[36:39], v[48:51], v[112:127]
    s_add_u32 s101, s56, 229376
    buffer_load_dwordx4 v[32:35], v2, s[32:35], s101 offen offset:0 sc1
    v_mfma_f32_32x32x16_bf16 v[96:111], a[32:35], v[48:51], v[96:111]
    s_waitcnt vmcnt(9)
    v_max3_u32 v8, v56, v57, v58
    v_max3_u32 v9, v59, v60, v61
    v_mfma_f32_32x32x16_bf16 v[112:127], a[44:47], v[52:55], v[112:127]
    s_add_u32 s101, s56, 243712
    buffer_load_dwordx4 v[36:39], v2, s[32:35], s101 offen offset:0 sc1
    v_max3_u32 v8, v8, v62, v63
    v_max_u32 v8, v8, v9
    v_cmp_eq_u32 vcc, -1, v8
    v_mfma_f32_32x32x16_bf16 v[96:111], a[40:43], v[52:55], v[96:111]
    s_cbranch_vccnz rty_21
bk_22:
    ds_read_b64_tr_b16 v[176:177], v4 offset:4096
    ds_read_b64_tr_b16 v[178:179], v4 offset:5120
    ds_read_b64_tr_b16 v[180:181], v5 offset:4096
    ds_read_b64_tr_b16 v[182:183], v5 offset:5120
    v_mfma_f32_32x32x16_bf16 v[112:127], a[52:55], v[56:59], v[112:127]
    s_add_u32 s101, s56, 258048
    buffer_load_dwordx4 v[40:43], v2, s[32:35], s101 offen offset:0 sc1
    v_mfma_f32_32x32x16_bf16 v[96:111], a[48:51], v[56:59], v[96:111]
    s_waitcnt vmcnt(9)
    v_max3_u32 v8, v64, v65, v66
    v_max3_u32 v9, v67, v68, v69
    v_mfma_f32_32x32x16_bf16 v[112:127], a[60:63], v[60:63], v[112:127]
    s_add_u32 s101, s56, 272384
    buffer_load_dwordx4 v[44:47], v2, s[32:35], s101 offen offset:0 sc1
    v_max3_u32 v8, v8, v70, v71
    v_max_u32 v8, v8, v9
    v_cmp_eq_u32 vcc, -1, v8
    v_mfma_f32_32x32x16_bf16 v[96:111], a[56:59], v[60:63], v[96:111]
    s_cbranch_vccnz rty_23
bk_24:
    ds_read_b64_tr_b16 v[184:185], v4 offset:6144
    ds_read_b64_tr_b16 v[186:187], v4 offset:7168
    ds_read_b64_tr_b16 v[188:189], v5 offset:6144
    ds_read_b64_tr_b16 v[190:191], v5 offset:7168
    v_mfma_f32_32x32x16_bf16 v[112:127], a[68:71], v[64:67], v[112:127]
    s_add_u32 s101, s56, 286720
    buffer_load_dwordx4 v[48:51], v2, s[32:35], s101 offen offset:0 sc1
    v_mfma_f32_32x32x16_bf16 v[96:111], a[64:67], v[64:67], v[96:111]
    s_waitcnt vmcnt(9)
    v_max3_u32 v8, v72, v73, v74
    v_max3_u32 v9, v75, v76, v77
    v_mfma_f32_32x32x16_bf16 v[112:127], a[76:79], v[68:71], v[112:127]
    s_add_u32 s101, s56, 301056
    buffer_load_dwordx4 v[52:55], v2, s[32:35], s101 offen offset:0 sc1
    v_max3_u32 v8, v8, v78, v79
    v_max_u32 v8, v8, v9
    v_cmp_eq_u32 vcc, -1, v8
    v_mfma_f32_32x32x16_bf16 v[96:111], a[72:75], v[68:71], v[96:111]
    s_cbranch_vccnz rty_25
bk_26:
    ds_read_b64_tr_b16 v[192:193], v4 offset:8192
    ds_read_b64_tr_b16 v[194:195], v4 offset:9216
    ds_read_b64_tr_b16 v[196:197], v5 offset:8192
    ds_read_b64_tr_b16 v[198:199], v5 offset:9216
    v_mfma_f32_32x32x16_bf16 v[112:127], a[84:87], v[72:75], v[112:127]
    s_add_u32 s101, s56, 315392
    buffer_load_dwordx4 v[56:59], v2, s[32:35], s101 offen offset:0 sc1
    v_mfma_f32_32x32x16_bf16 v[96:111], a[80:83], v[72:75], v[96:111]
    s_waitcnt vmcnt(9)
    v_max3_u32 v8, v80, v81, v82
    v_max3_u32 v9, v83, v84, v85
    v_mfma_f32_32x32x16_bf16 v[112:127], a[92:95], v[76:79], v[112:127]
    s_add_u32 s101, s56, 329728
    buffer_load_dwordx4 v[60:63], v2, s[32:35], s101 offen offset:0 sc1
    v_max3_u32 v8, v8, v86, v87
    v_max_u32 v8, v8, v9
    v_cmp_eq_u32 vcc, -1, v8
    v_mfma_f32_32x32x16_bf16 v[96:111], a[88:91], v[76:79], v[96:111]
    s_cbranch_vccnz rty_27
bk_28:
    ds_read_b64_tr_b16 v[200:201], v4 offset:10240
    ds_read_b64_tr_b16 v[202:203], v4 offset:11264
    ds_read_b64_tr_b16 v[204:205], v5 offset:10240
    ds_read_b64_tr_b16 v[206:207], v5 offset:11264
    v_mfma_f32_32x32x16_bf16 v[112:127], a[100:103], v[80:83], v[112:127]
    s_add_u32 s101, s56, 344064
    buffer_load_dwordx4 v[64:67], v2, s[32:35], s101 offen offset:0 sc1
    v_mfma_f32_32x32x16_bf16 v[96:111], a[96:99], v[80:83], v[96:111]
    s_waitcnt vmcnt(9)
    v_max3_u32 v8, v88, v89, v90
    v_max3_u32 v9, v91, v92, v93
    v_mfma_f32_32x32x16_bf16 v[112:127], a[108:111], v[84:87], v[112:127]
    s_add_u32 s101, s56, 358400
    buffer_load_dwordx4 v[68:71], v2, s[32:35], s101 offen offset:0 sc1
    v_max3_u32 v8, v8, v94, v95
    v_max_u32 v8, v8, v9
    v_cmp_eq_u32 vcc, -1, v8
    v_mfma_f32_32x32x16_bf16 v[96:111], a[104:107], v[84:87], v[96:111]
    s_cbranch_vccnz rty_29
bk_30:
    ds_read_b64_tr_b16 v[208:209], v4 offset:12288
    ds_read_b64_tr_b16 v[210:211], v4 offset:13312
    ds_read_b64_tr_b16 v[212:213], v5 offset:12288
    ds_read_b64_tr_b16 v[214:215], v5 offset:13312
    v_mfma_f32_32x32x16_bf16 v[112:127], a[116:119], v[88:91], v[112:127]
    s_add_u32 s101, s56, 372736
    buffer_load_dwordx4 v[72:75], v2, s[32:35], s101 offen offset:0 sc1
    v_mfma_f32_32x32x16_bf16 v[96:111], a[112:115], v[88:91], v[96:111]
    s_waitcnt vmcnt(9)
    v_max3_u32 v8, v32, v33, v34
    v_max3_u32 v9, v35, v36, v37
    v_mfma_f32_32x32x16_bf16 v[112:127], a[124:127], v[92:95], v[112:127]
    s_add_u32 s101, s56, 387072
    buffer_load_dwordx4 v[76:79], v2, s[32:35], s101 offen offset:0 sc1
    v_max3_u32 v8, v8, v38, v39
    v_max_u32 v8, v8, v9
    v_cmp_eq_u32 vcc, -1, v8
    v_mfma_f32_32x32x16_bf16 v[96:111], a[120:123], v[92:95], v[96:111]
    s_cbranch_vccnz rty_31
bk_32:
    ds_read_b64_tr_b16 v[216:217], v4 offset:14336
    ds_read_b64_tr_b16 v[218:219], v4 offset:15360
    ds_read_b64_tr_b16 v[220:221], v5 offset:14336
    ds_read_b64_tr_b16 v[222:223], v5 offset:15360
    v_mfma_f32_32x32x16_bf16 v[112:127], a[132:135], v[32:35], v[112:127]
    s_add_u32 s101, s56, 401408
    buffer_load_dwordx4 v[80:83], v2, s[32:35], s101 offen offset:0 sc1
    v_mfma_f32_32x32x16_bf16 v[96:111], a[128:131], v[32:35], v[96:111]
    s_waitcnt vmcnt(9)
    v_max3_u32 v8, v40, v41, v42
    v_max3_u32 v9, v43, v44, v45
    v_mfma_f32_32x32x16_bf16 v[112:127], a[140:143], v[36:39], v[112:127]
    s_add_u32 s101, s56, 415744
    buffer_load_dwordx4 v[84:87], v2, s[32:35], s101 offen offset:0 sc1
    v_max3_u32 v8, v8, v46, v47
    v_max_u32 v8, v8, v9
    v_cmp_eq_u32 vcc, -1, v8
    v_mfma_f32_32x32x16_bf16 v[96:111], a[136:139], v[36:39], v[96:111]
    s_cbranch_vccnz rty_33
bk_34:
    ds_read_b64_tr_b16 v[224:225], v4 offset:16384
    ds_read_b64_tr_b16 v[226:227], v4 offset:17408
    ds_read_b64_tr_b16 v[228:229], v5 offset:16384
    ds_read_b64_tr_b16 v[230:231], v5 offset:17408
    v_mfma_f32_32x32x16_bf16 v[112:127], a[148:151], v[40:43], v[112:127]
    s_add_u32 s101, s56, 430080
    buffer_load_dwordx4 v[88:91], v2, s[32:35], s101 offen offset:0 sc1
    v_mfma_f32_32x32x16_bf16 v[96:111], a[144:147], v[40:43], v[96:111]
    s_waitcnt vmcnt(9)
    v_max3_u32 v8, v48, v49, v50
    v_max3_u32 v9, v51, v52, v53
    v_mfma_f32_32x32x16_bf16 v[112:127], a[156:159], v[44:47], v[112:127]
    s_add_u32 s101, s56, 444416
    buffer_load_dwordx4 v[92:95], v2, s[32:35], s101 offen offset:0 sc1
    v_max3_u32 v8, v8, v54, v55
    v_max_u32 v8, v8, v9
    v_cmp_eq_u32 vcc, -1, v8
    v_mfma_f32_32x32x16_bf16 v[96:111], a[152:155], v[44:47], v[96:111]
    s_cbranch_vccnz rty_35
bk_36:
    ds_read_b64_tr_b16 v[232:233], v4 offset:18432
    ds_read_b64_tr_b16 v[234:235], v4 offset:19456
    ds_read_b64_tr_b16 v[236:237], v5 offset:18432
    ds_read_b64_tr_b16 v[238:239], v5 offset:19456
    v_mfma_f32_32x32x16_bf16 v[112:127], a[164:167], v[48:51], v[112:127]
    s_add_u32 s101, s56, 0
    buffer_load_dwordx4 v[32:35], v2, s[32:35], s101 offen offset:512 sc1
    v_mfma_f32_32x32x16_bf16 v[96:111], a[160:163], v[48:51], v[96:111]
    s_waitcnt vmcnt(9)
    v_max3_u32 v8, v56, v57, v58
    v_max3_u32 v9, v59, v60, v61
    v_mfma_f32_32x32x16_bf16 v[112:127], a[172:175], v[52:55], v[112:127]
    s_add_u32 s101, s56, 14336
    buffer_load_dwordx4 v[36:39], v2, s[32:35], s101 offen offset:512 sc1
    v_max3_u32 v8, v8, v62, v63
    v_max_u32 v8, v8, v9
    v_cmp_eq_u32 vcc, -1, v8
    v_mfma_f32_32x32x16_bf16 v[96:111], a[168:171], v[52:55], v[96:111]
    s_cbranch_vccnz rty_37
bk_38:
    ds_read_b64_tr_b16 v[240:241], v4 offset:20480
    ds_read_b64_tr_b16 v[242:243], v4 offset:21504
    ds_read_b64_tr_b16 v[244:245], v5 offset:20480
    ds_read_b64_tr_b16 v[246:247], v5 offset:21504
    v_mfma_f32_32x32x16_bf16 v[112:127], a[180:183], v[56:59], v[112:127]
    s_add_u32 s101, s56, 28672
    buffer_load_dwordx4 v[40:43], v2, s[32:35], s101 offen offset:512 sc1
    v_mfma_f32_32x32x16_bf16 v[96:111], a[176:179], v[56:59], v[96:111]
    s_waitcnt vmcnt(9)
    v_max3_u32 v8, v64, v65, v66
    v_max3_u32 v9, v67, v68, v69
    v_mfma_f32_32x32x16_bf16 v[112:127], a[188:191], v[60:63], v[112:127]
    s_add_u32 s101, s56, 43008
    buffer_load_dwordx4 v[44:47], v2, s[32:35], s101 offen offset:512 sc1
    v_max3_u32 v8, v8, v70, v71
    v_max_u32 v8, v8, v9
    v_cmp_eq_u32 vcc, -1, v8
    v_mfma_f32_32x32x16_bf16 v[96:111], a[184:187], v[60:63], v[96:111]
    s_cbranch_vccnz rty_39
bk_40:
    ds_read_b64_tr_b16 v[248:249], v4 offset:22528
    ds_read_b64_tr_b16 v[250:251], v4 offset:23552
    ds_read_b64_tr_b16 v[252:253], v5 offset:22528
    ds_read_b64_tr_b16 v[254:255], v5 offset:23552
    v_mfma_f32_32x32x16_bf16 v[112:127], a[196:199], v[64:67], v[112:127]
    s_add_u32 s101, s56, 57344
    buffer_load_dwordx4 v[48:51], v2, s[32:35], s101 offen offset:512 sc1
    v_mfma_f32_32x32x16_bf16 v[96:111], a[192:195], v[64:67], v[96:111]
    s_waitcnt vmcnt(9)
    v_max3_u32 v8, v72, v73, v74
    v_max3_u32 v9, v75, v76, v77
    v_mfma_f32_32x32x16_bf16 v[112:127], a[204:207], v[68:71], v[112:127]
    s_add_u32 s101, s56, 71680
    buffer_load_dwordx4 v[52:55], v2, s[32:35], s101 offen offset:512 sc1
    v_max3_u32 v8, v8, v78, v79
    v_max_u32 v8, v8, v9
    v_cmp_eq_u32 vcc, -1, v8
    v_mfma_f32_32x32x16_bf16 v[96:111], a[200:203], v[68:71], v[96:111]
    s_cbranch_vccnz rty_41
bk_42:
    v_bfe_u32 v14, v0, 3, 3
    s_mov_b32 s98, 4096
    v_mul_lo_u32 v28, v14, s98
    v_bfe_u32 v14, v0, 4, 1
    v_mfma_f32_32x32x16_bf16 v[112:127], a[212:215], v[72:75], v[112:127]
    s_add_u32 s101, s56, 86016
    buffer_load_dwordx4 v[56:59], v2, s[32:35], s101 offen offset:512 sc1
    v_mfma_f32_32x32x16_bf16 v[96:111], a[208:211], v[72:75], v[96:111]
    s_waitcnt vmcnt(9)
    v_max3_u32 v8, v80, v81, v82
    v_max3_u32 v9, v83, v84, v85
    v_mfma_f32_32x32x16_bf16 v[112:127], a[220:223], v[76:79], v[112:127]
    s_add_u32 s101, s56, 100352
    buffer_load_dwordx4 v[60:63], v2, s[32:35], s101 offen offset:512 sc1
    v_max3_u32 v8, v8, v86, v87
    v_max_u32 v8, v8, v9
    v_cmp_eq_u32 vcc, -1, v8
    v_mfma_f32_32x32x16_bf16 v[96:111], a[216:219], v[76:79], v[96:111]
    s_cbranch_vccnz rty_43
bk_44:
    v_lshlrev_b32 v14, 2, v14
    v_and_b32 v15, 7, v0
    v_xor_b32 v14, v14, v15
    v_lshl_add_u32 v28, v14, 4, v28
    s_xor_b32 s98, s49, 0
    s_mul_i32 s98, s98, 6144
    v_add_u32 v10, s98, v6
    s_xor_b32 s98, s49, 1
    s_mul_i32 s98, s98, 6144
    v_add_u32 v11, s98, v6
    s_xor_b32 s98, s49, 2
    s_mul_i32 s98, s98, 6144
    v_add_u32 v12, s98, v6
    s_xor_b32 s98, s49, 3
    s_mul_i32 s98, s98, 6144
    v_add_u32 v13, s98, v6
    v_mfma_f32_32x32x16_bf16 v[112:127], a[228:231], v[80:83], v[112:127]
    s_add_u32 s101, s56, 114688
    buffer_load_dwordx4 v[64:67], v2, s[32:35], s101 offen offset:512 sc1
    v_mfma_f32_32x32x16_bf16 v[96:111], a[224:227], v[80:83], v[96:111]
    s_waitcnt vmcnt(9)
    v_max3_u32 v8, v88, v89, v90
    v_max3_u32 v9, v91, v92, v93
    v_mfma_f32_32x32x16_bf16 v[112:127], a[236:239], v[84:87], v[112:127]
    s_add_u32 s101, s56, 129024
    buffer_load_dwordx4 v[68:71], v2, s[32:35], s101 offen offset:512 sc1
    v_max3_u32 v8, v8, v94, v95
    v_max_u32 v8, v8, v9
    v_cmp_eq_u32 vcc, -1, v8
    v_mfma_f32_32x32x16_bf16 v[96:111], a[232:235], v[84:87], v[96:111]
    s_cbranch_vccnz rty_45
bk_46:
    s_lshl_b32 s98, s52, 7
    s_or_b32 s98, s98, s54
    v_add_u32 v28, s98, v28
    v_add_u32 v29, 0x7c00, v28
    v_mfma_f32_32x32x16_bf16 v[112:127], a[244:247], v[88:91], v[112:127]
    s_add_u32 s101, s56, 143360
    buffer_load_dwordx4 v[72:75], v2, s[32:35], s101 offen offset:512 sc1
    v_mfma_f32_32x32x16_bf16 v[96:111], a[240:243], v[88:91], v[96:111]
    s_waitcnt vmcnt(9)
    v_max3_u32 v8, v32, v33, v34
    v_max3_u32 v9, v35, v36, v37
    v_mfma_f32_32x32x16_bf16 v[112:127], a[252:255], v[92:95], v[112:127]
    s_add_u32 s101, s56, 157696
    buffer_load_dwordx4 v[76:79], v2, s[32:35], s101 offen offset:512 sc1
    v_max3_u32 v8, v8, v38, v39
    v_max_u32 v8, v8, v9
    v_cmp_eq_u32 vcc, -1, v8
    v_mfma_f32_32x32x16_bf16 v[96:111], a[248:251], v[92:95], v[96:111]
    s_cbranch_vccnz rty_47
bk_48:
    v_mov_b32 v128, v16
    v_mov_b32 v136, 0
    v_mov_b32 v129, v17
    v_mov_b32 v137, 0
    v_mov_b32 v130, v18
    v_mov_b32 v138, 0
    v_mov_b32 v131, v19
    v_mov_b32 v139, 0
    v_mov_b32 v132, v20
    v_mov_b32 v140, 0
    v_mov_b32 v133, v21
    v_mov_b32 v141, 0
    v_mov_b32 v134, v22
    v_mov_b32 v142, 0
    v_mov_b32 v135, v23
    v_mov_b32 v143, 0
    v_add_u32 v30, 0xf800, v28
    v_add_u32 v31, 0x17400, v28
    s_add_u32 s101, s56, 172032
    buffer_load_dwordx4 v[80:83], v2, s[32:35], s101 offen offset:512 sc1
    s_add_u32 s101, s56, 186368
    buffer_load_dwordx4 v[84:87], v2, s[32:35], s101 offen offset:512 sc1
    s_add_u32 s101, s56, 200704
    buffer_load_dwordx4 v[88:91], v2, s[32:35], s101 offen offset:512 sc1
    s_add_u32 s101, s56, 215040
    buffer_load_dwordx4 v[92:95], v2, s[32:35], s101 offen offset:512 sc1
    ds_write_b128 v12, v[112:115] offset:2048
    ds_write_b128 v12, v[116:119] offset:3072
    ds_write_b128 v13, v[120:123] offset:4096
    ds_write_b128 v13, v[124:127] offset:5120
    ds_write_b128 v11, v[104:107] offset:0
    ds_write_b128 v11, v[108:111] offset:1024
    s_waitcnt lgkmcnt(0)
    s_barrier
    ds_read_b128 v[104:107], v10 offset:0
    ds_read_b128 v[108:111], v10 offset:1024
    ds_read_b128 v[112:115], v10 offset:2048
    ds_read_b128 v[116:119], v10 offset:3072
    ds_read_b128 v[120:123], v10 offset:4096
    ds_read_b128 v[124:127], v10 offset:5120
    s_waitcnt lgkmcnt(4)
    v_pk_add_f32 v[96:97], v[96:97], v[104:105]
    v_pk_add_f32 v[98:99], v[98:99], v[106:107]
    v_pk_add_f32 v[100:101], v[100:101], v[108:109]
    v_pk_add_f32 v[102:103], v[102:103], v[110:111]
    s_waitcnt lgkmcnt(2)
    v_pk_add_f32 v[96:97], v[96:97], v[112:113]
    v_pk_add_f32 v[98:99], v[98:99], v[114:115]
    v_pk_add_f32 v[100:101], v[100:101], v[116:117]
    v_pk_add_f32 v[102:103], v[102:103], v[118:119]
    s_waitcnt lgkmcnt(0)
    v_pk_add_f32 v[96:97], v[96:97], v[120:121]
    v_pk_add_f32 v[98:99], v[98:99], v[122:123]
    v_pk_add_f32 v[100:101], v[100:101], v[124:125]
    v_pk_add_f32 v[102:103], v[102:103], v[126:127]
    v_pk_mul_f32 v[104:105], v[96:97], v[96:97]
    v_pk_mul_f32 v[106:107], v[98:99], v[98:99]
    v_pk_mul_f32 v[108:109], v[100:101], v[100:101]
    v_pk_mul_f32 v[110:111], v[102:103], v[102:103]
    v_pk_fma_f32 v[104:105], v[104:105], s[42:43], v[26:27] op_sel:[0,0,1] op_sel_hi:[1,1,1]
    v_pk_fma_f32 v[106:107], v[106:107], s[42:43], v[26:27] op_sel:[0,0,1] op_sel_hi:[1,1,1]
    v_pk_fma_f32 v[108:109], v[108:109], s[42:43], v[26:27] op_sel:[0,0,1] op_sel_hi:[1,1,1]
    v_pk_fma_f32 v[110:111], v[110:111], s[42:43], v[26:27] op_sel:[0,0,1] op_sel_hi:[1,1,1]
    v_pk_mul_f32 v[104:105], v[104:105], v[96:97]
    v_pk_mul_f32 v[106:107], v[106:107], v[98:99]
    v_pk_mul_f32 v[108:109], v[108:109], v[100:101]
    v_pk_mul_f32 v[110:111], v[110:111], v[102:103]
    v_exp_f32 v104, v104
    v_exp_f32 v105, v105
    v_exp_f32 v106, v106
    v_exp_f32 v107, v107
    v_exp_f32 v108, v108
    v_exp_f32 v109, v109
    v_exp_f32 v110, v110
    v_exp_f32 v111, v111
    v_pk_add_f32 v[104:105], v[104:105], 1.0 op_sel_hi:[1,0]
    v_pk_add_f32 v[106:107], v[106:107], 1.0 op_sel_hi:[1,0]
    v_pk_add_f32 v[108:109], v[108:109], 1.0 op_sel_hi:[1,0]
    v_pk_add_f32 v[110:111], v[110:111], 1.0 op_sel_hi:[1,0]
    v_rcp_f32 v104, v104
    v_rcp_f32 v105, v105
    v_rcp_f32 v106, v106
    v_rcp_f32 v107, v107
    v_rcp_f32 v108, v108
    v_rcp_f32 v109, v109
    v_rcp_f32 v110, v110
    v_rcp_f32 v111, v111
    v_pk_mul_f32 v[96:97], v[96:97], v[104:105]
    v_pk_mul_f32 v[98:99], v[98:99], v[106:107]
    v_pk_mul_f32 v[100:101], v[100:101], v[108:109]
    v_pk_mul_f32 v[102:103], v[102:103], v[110:111]
    v_cvt_pk_bf16_f32 v112, v96, v97
    v_cvt_pk_bf16_f32 v113, v98, v99
    v_cvt_pk_bf16_f32 v114, v100, v101
    v_cvt_pk_bf16_f32 v115, v102, v103
    buffer_store_dwordx4 v[112:115], v2, s[32:35], s44 offen offset:0 sc1
    v_mfma_f32_32x32x16_bf16 v[144:159], a[4:7], v[32:35], 0
    v_mfma_f32_32x32x16_bf16 v[128:143], a[0:3], v[32:35], v[128:143]
    s_waitcnt vmcnt(13)
    v_max3_u32 v8, v40, v41, v42
    v_max3_u32 v9, v43, v44, v45
    v_mfma_f32_32x32x16_bf16 v[144:159], a[12:15], v[36:39], v[144:159]
    v_max3_u32 v8, v8, v46, v47
    v_max_u32 v8, v8, v9
    v_cmp_eq_u32 vcc, -1, v8
    v_mfma_f32_32x32x16_bf16 v[128:143], a[8:11], v[36:39], v[128:143]
    s_cbranch_vccnz rty_49
bk_50:
    v_mfma_f32_32x32x16_bf16 v[144:159], a[20:23], v[40:43], v[144:159]
    s_add_u32 s101, s56, 229376
    buffer_load_dwordx4 v[32:35], v2, s[32:35], s101 offen offset:512 sc1
    v_mfma_f32_32x32x16_bf16 v[128:143], a[16:19], v[40:43], v[128:143]
    s_waitcnt vmcnt(12)
    v_max3_u32 v8, v48, v49, v50
    v_max3_u32 v9, v51, v52, v53
    v_mfma_f32_32x32x16_bf16 v[144:159], a[28:31], v[44:47], v[144:159]
    s_add_u32 s101, s56, 243712
    buffer_load_dwordx4 v[36:39], v2, s[32:35], s101 offen offset:512 sc1
    v_max3_u32 v8, v8, v54, v55
    v_max_u32 v8, v8, v9
    v_cmp_eq_u32 vcc, -1, v8
    v_mfma_f32_32x32x16_bf16 v[128:143], a[24:27], v[44:47], v[128:143]
    s_cbranch_vccnz rty_51
bk_52:
    v_mfma_f32_32x32x16_bf16 v[144:159], a[36:39], v[48:51], v[144:159]
    s_add_u32 s101, s56, 258048
    buffer_load_dwordx4 v[40:43], v2, s[32:35], s101 offen offset:512 sc1
    v_mfma_f32_32x32x16_bf16 v[128:143], a[32:35], v[48:51], v[128:143]
    s_waitcnt vmcnt(12)
    v_max3_u32 v8, v56, v57, v58
    v_max3_u32 v9, v59, v60, v61
    v_mfma_f32_32x32x16_bf16 v[144:159], a[44:47], v[52:55], v[144:159]
    s_add_u32 s101, s56, 272384
    buffer_load_dwordx4 v[44:47], v2, s[32:35], s101 offen offset:512 sc1
    v_max3_u32 v8, v8, v62, v63
    v_max_u32 v8, v8, v9
    v_cmp_eq_u32 vcc, -1, v8
    v_mfma_f32_32x32x16_bf16 v[128:143], a[40:43], v[52:55], v[128:143]
    s_cbranch_vccnz rty_53
bk_54:
    v_mfma_f32_32x32x16_bf16 v[144:159], a[52:55], v[56:59], v[144:159]
    s_add_u32 s101, s56, 286720
    buffer_load_dwordx4 v[48:51], v2, s[32:35], s101 offen offset:512 sc1
    v_mfma_f32_32x32x16_bf16 v[128:143], a[48:51], v[56:59], v[128:143]
    s_waitcnt vmcnt(12)
    v_max3_u32 v8, v64, v65, v66
    v_max3_u32 v9, v67, v68, v69
    v_mfma_f32_32x32x16_bf16 v[144:159], a[60:63], v[60:63], v[144:159]
    s_add_u32 s101, s56, 301056
    buffer_load_dwordx4 v[52:55], v2, s[32:35], s101 offen offset:512 sc1
    v_max3_u32 v8, v8, v70, v71
    v_max_u32 v8, v8, v9
    v_cmp_eq_u32 vcc, -1, v8
    v_mfma_f32_32x32x16_bf16 v[128:143], a[56:59], v[60:63], v[128:143]
    s_cbranch_vccnz rty_55
bk_56:
    v_mfma_f32_32x32x16_bf16 v[144:159], a[68:71], v[64:67], v[144:159]
    s_add_u32 s101, s56, 315392
    buffer_load_dwordx4 v[56:59], v2, s[32:35], s101 offen offset:512 sc1
    v_mfma_f32_32x32x16_bf16 v[128:143], a[64:67], v[64:67], v[128:143]
    s_waitcnt vmcnt(12)
    v_max3_u32 v8, v72, v73, v74
    v_max3_u32 v9, v75, v76, v77
    v_mfma_f32_32x32x16_bf16 v[144:159], a[76:79], v[68:71], v[144:159]
    s_add_u32 s101, s56, 329728
    buffer_load_dwordx4 v[60:63], v2, s[32:35], s101 offen offset:512 sc1
    v_max3_u32 v8, v8, v78, v79
    v_max_u32 v8, v8, v9
    v_cmp_eq_u32 vcc, -1, v8
    v_mfma_f32_32x32x16_bf16 v[128:143], a[72:75], v[68:71], v[128:143]
    s_cbranch_vccnz rty_57
bk_58:
    v_mfma_f32_32x32x16_bf16 v[144:159], a[84:87], v[72:75], v[144:159]
    s_add_u32 s101, s56, 344064
    buffer_load_dwordx4 v[64:67], v2, s[32:35], s101 offen offset:512 sc1
    v_mfma_f32_32x32x16_bf16 v[128:143], a[80:83], v[72:75], v[128:143]
    s_waitcnt vmcnt(12)
    v_max3_u32 v8, v80, v81, v82
    v_max3_u32 v9, v83, v84, v85
    v_mfma_f32_32x32x16_bf16 v[144:159], a[92:95], v[76:79], v[144:159]
    s_add_u32 s101, s56, 358400
    buffer_load_dwordx4 v[68:71], v2, s[32:35], s101 offen offset:512 sc1
    v_max3_u32 v8, v8, v86, v87
    v_max_u32 v8, v8, v9
    v_cmp_eq_u32 vcc, -1, v8
    v_mfma_f32_32x32x16_bf16 v[128:143], a[88:91], v[76:79], v[128:143]
    s_cbranch_vccnz rty_59
bk_60:
    v_mfma_f32_32x32x16_bf16 v[144:159], a[100:103], v[80:83], v[144:159]
    s_add_u32 s101, s56, 372736
    buffer_load_dwordx4 v[72:75], v2, s[32:35], s101 offen offset:512 sc1
    v_mfma_f32_32x32x16_bf16 v[128:143], a[96:99], v[80:83], v[128:143]
    s_waitcnt vmcnt(12)
    v_max3_u32 v8, v88, v89, v90
    v_max3_u32 v9, v91, v92, v93
    v_mfma_f32_32x32x16_bf16 v[144:159], a[108:111], v[84:87], v[144:159]
    s_add_u32 s101, s56, 387072
    buffer_load_dwordx4 v[76:79], v2, s[32:35], s101 offen offset:512 sc1
    v_max3_u32 v8, v8, v94, v95
    v_max_u32 v8, v8, v9
    v_cmp_eq_u32 vcc, -1, v8
    v_mfma_f32_32x32x16_bf16 v[128:143], a[104:107], v[84:87], v[128:143]
    s_cbranch_vccnz rty_61
bk_62:
    v_mfma_f32_32x32x16_bf16 v[144:159], a[116:119], v[88:91], v[144:159]
    s_add_u32 s101, s56, 401408
    buffer_load_dwordx4 v[80:83], v2, s[32:35], s101 offen offset:512 sc1
    v_mfma_f32_32x32x16_bf16 v[128:143], a[112:115], v[88:91], v[128:143]
    s_waitcnt vmcnt(11)
    v_max3_u32 v8, v32, v33, v34
    v_max3_u32 v9, v35, v36, v37
    v_mfma_f32_32x32x16_bf16 v[144:159], a[124:127], v[92:95], v[144:159]
    s_add_u32 s101, s56, 415744
    buffer_load_dwordx4 v[84:87], v2, s[32:35], s101 offen offset:512 sc1
    v_max3_u32 v8, v8, v38, v39
    v_max_u32 v8, v8, v9
    v_cmp_eq_u32 vcc, -1, v8
    v_mfma_f32_32x32x16_bf16 v[128:143], a[120:123], v[92:95], v[128:143]
    s_cbranch_vccnz rty_63
bk_64:
    v_mfma_f32_32x32x16_bf16 v[144:159], a[132:135], v[32:35], v[144:159]
    v_mfma_f32_32x32x16_bf16 v[128:143], a[128:131], v[32:35], v[128:143]
    s_waitcnt vmcnt(10)
    v_max3_u32 v8, v40, v41, v42
    v_max3_u32 v9, v43, v44, v45
    v_mfma_f32_32x32x16_bf16 v[144:159], a[140:143], v[36:39], v[144:159]
    v_max3_u32 v8, v8, v46, v47
    v_max_u32 v8, v8, v9
    v_cmp_eq_u32 vcc, -1, v8
    v_mfma_f32_32x32x16_bf16 v[128:143], a[136:139], v[36:39], v[128:143]
    s_cbranch_vccnz rty_65
bk_66:
    v_mfma_f32_32x32x16_bf16 v[144:159], a[148:151], v[40:43], v[144:159]
    s_add_u32 s101, s56, 430080
    buffer_load_dwordx4 v[88:91], v2, s[32:35], s101 offen offset:512 sc1
    v_mfma_f32_32x32x16_bf16 v[128:143], a[144:147], v[40:43], v[128:143]
    s_waitcnt vmcnt(9)
    v_max3_u32 v8, v48, v49, v50
    v_max3_u32 v9, v51, v52, v53
    v_mfma_f32_32x32x16_bf16 v[144:159], a[156:159], v[44:47], v[144:159]
    s_add_u32 s101, s56, 444416
    buffer_load_dwordx4 v[92:95], v2, s[32:35], s101 offen offset:512 sc1
    v_max3_u32 v8, v8, v54, v55
    v_max_u32 v8, v8, v9
    v_cmp_eq_u32 vcc, -1, v8
    v_mfma_f32_32x32x16_bf16 v[128:143], a[152:155], v[44:47], v[128:143]
    s_cbranch_vccnz rty_67
bk_68:
    v_mfma_f32_32x32x16_bf16 v[144:159], a[164:167], v[48:51], v[144:159]
    s_add_u32 s101, s57, 0
    buffer_load_dwordx4 v[32:35], v3, s[32:35], s101 offen offset:0 sc1
    v_mfma_f32_32x32x16_bf16 v[128:143], a[160:163], v[48:51], v[128:143]
    s_waitcnt vmcnt(9)
    v_max3_u32 v8, v56, v57, v58
    v_max3_u32 v9, v59, v60, v61
    v_mfma_f32_32x32x16_bf16 v[144:159], a[172:175], v[52:55], v[144:159]
    s_add_u32 s101, s57, 14336
    buffer_load_dwordx4 v[36:39], v3, s[32:35], s101 offen offset:0 sc1
    v_max3_u32 v8, v8, v62, v63
    v_max_u32 v8, v8, v9
    v_cmp_eq_u32 vcc, -1, v8
    v_mfma_f32_32x32x16_bf16 v[128:143], a[168:171], v[52:55], v[128:143]
    s_cbranch_vccnz rty_69
bk_70:
    s_waitcnt lgkmcnt(0)
    s_mov_b32 s63, s64
    s_lshl_b32 s61, s63, 12
    s_add_u32 s61, s61, s60
    s_add_u32 m0, s61, 0
    s_add_u32 s61, s63, 6
    s_cmp_ge_u32 s61, 14
    s_cselect_b32 s62, s17, s16
    s_add_u32 s62, s62, s61
    s_lshl_b32 s62, s62, 17
    buffer_load_dwordx4 v28, s[28:31], s62 offen offset:0 lds
    buffer_load_dwordx4 v29, s[28:31], s62 offen offset:1024 lds
    v_mfma_f32_32x32x16_bf16 v[144:159], a[180:183], v[56:59], v[144:159]
    s_add_u32 s101, s57, 28672
    buffer_load_dwordx4 v[40:43], v3, s[32:35], s101 offen offset:0 sc1
    v_mfma_f32_32x32x16_bf16 v[128:143], a[176:179], v[56:59], v[128:143]
    s_waitcnt vmcnt(11)
    v_max3_u32 v8, v64, v65, v66
    v_max3_u32 v9, v67, v68, v69
    v_mfma_f32_32x32x16_bf16 v[144:159], a[188:191], v[60:63], v[144:159]
    s_add_u32 s101, s57, 43008
    buffer_load_dwordx4 v[44:47], v3, s[32:35], s101 offen offset:0 sc1
    v_max3_u32 v8, v8, v70, v71
    v_max_u32 v8, v8, v9
    v_cmp_eq_u32 vcc, -1, v8
    v_mfma_f32_32x32x16_bf16 v[128:143], a[184:187], v[60:63], v[128:143]
    s_cbranch_vccnz rty_71
bk_72:
    buffer_load_dwordx4 v30, s[28:31], s62 offen offset:2048 lds
    buffer_load_dwordx4 v31, s[28:31], s62 offen offset:3072 lds
    v_mfma_f32_32x32x16_bf16 v[144:159], a[196:199], v[64:67], v[144:159]
    s_add_u32 s101, s57, 57344
    buffer_load_dwordx4 v[48:51], v3, s[32:35], s101 offen offset:0 sc1
    v_mfma_f32_32x32x16_bf16 v[128:143], a[192:195], v[64:67], v[128:143]
    s_waitcnt vmcnt(13)
    v_max3_u32 v8, v72, v73, v74
    v_max3_u32 v9, v75, v76, v77
    v_mfma_f32_32x32x16_bf16 v[144:159], a[204:207], v[68:71], v[144:159]
    s_add_u32 s101, s57, 71680
    buffer_load_dwordx4 v[52:55], v3, s[32:35], s101 offen offset:0 sc1
    v_max3_u32 v8, v8, v78, v79
    v_max_u32 v8, v8, v9
    v_cmp_eq_u32 vcc, -1, v8
    v_mfma_f32_32x32x16_bf16 v[128:143], a[200:203], v[68:71], v[128:143]
    s_cbranch_vccnz rty_73
bk_74:
    s_barrier
    s_add_u32 s63, s63, 1
    s_cmp_eq_u32 s63, 8
    s_cselect_b32 s63, 0, s63
    s_lshl_b32 s61, s63, 12
    s_add_u32 s61, s61, s60
    s_add_u32 m0, s61, 0
    s_add_u32 s61, s63, 6
    s_cmp_ge_u32 s61, 14
    s_cselect_b32 s62, s17, s16
    s_add_u32 s62, s62, s61
    s_lshl_b32 s62, s62, 17
    buffer_load_dwordx4 v28, s[28:31], s62 offen offset:0 lds
    buffer_load_dwordx4 v29, s[28:31], s62 offen offset:1024 lds
    v_mfma_f32_32x32x16_bf16 v[144:159], a[212:215], v[72:75], v[144:159]
    s_add_u32 s101, s57, 86016
    buffer_load_dwordx4 v[56:59], v3, s[32:35], s101 offen offset:0 sc1
    v_mfma_f32_32x32x16_bf16 v[128:143], a[208:211], v[72:75], v[128:143]
    s_waitcnt vmcnt(15)
    v_max3_u32 v8, v80, v81, v82
    v_max3_u32 v9, v83, v84, v85
    v_mfma_f32_32x32x16_bf16 v[144:159], a[220:223], v[76:79], v[144:159]
    s_add_u32 s101, s57, 100352
    buffer_load_dwordx4 v[60:63], v3, s[32:35], s101 offen offset:0 sc1
    v_max3_u32 v8, v8, v86, v87
    v_max_u32 v8, v8, v9
    v_cmp_eq_u32 vcc, -1, v8
    v_mfma_f32_32x32x16_bf16 v[128:143], a[216:219], v[76:79], v[128:143]
    s_cbranch_vccnz rty_75
bk_76:
    buffer_load_dwordx4 v30, s[28:31], s62 offen offset:2048 lds
    buffer_load_dwordx4 v31, s[28:31], s62 offen offset:3072 lds
    v_mfma_f32_32x32x16_bf16 v[144:159], a[228:231], v[80:83], v[144:159]
    s_add_u32 s101, s57, 114688
    buffer_load_dwordx4 v[64:67], v3, s[32:35], s101 offen offset:0 sc1
    v_mfma_f32_32x32x16_bf16 v[128:143], a[224:227], v[80:83], v[128:143]
    s_waitcnt vmcnt(17)
    v_max3_u32 v8, v88, v89, v90
    v_max3_u32 v9, v91, v92, v93
    v_mfma_f32_32x32x16_bf16 v[144:159], a[236:239], v[84:87], v[144:159]
    s_add_u32 s101, s57, 129024
    buffer_load_dwordx4 v[68:71], v3, s[32:35], s101 offen offset:0 sc1
    v_max3_u32 v8, v8, v94, v95
    v_max_u32 v8, v8, v9
    v_cmp_eq_u32 vcc, -1, v8
    v_mfma_f32_32x32x16_bf16 v[128:143], a[232:235], v[84:87], v[128:143]
    s_cbranch_vccnz rty_77
bk_78:
    s_add_u32 s63, s63, 1
    s_cmp_eq_u32 s63, 8
    s_cselect_b32 s63, 0, s63
    s_lshl_b32 s61, s63, 12
    s_add_u32 s61, s61, s60
    s_add_u32 m0, s61, 0
    s_add_u32 s61, s63, 6
    s_cmp_ge_u32 s61, 14
    s_cselect_b32 s62, s17, s16
    s_add_u32 s62, s62, s61
    s_lshl_b32 s62, s62, 17
    buffer_load_dwordx4 v28, s[28:31], s62 offen offset:0 lds
    buffer_load_dwordx4 v29, s[28:31], s62 offen offset:1024 lds
    v_mfma_f32_32x32x16_bf16 v[144:159], a[244:247], v[88:91], v[144:159]
    s_add_u32 s101, s57, 143360
    buffer_load_dwordx4 v[72:75], v3, s[32:35], s101 offen offset:0 sc1
    v_mfma_f32_32x32x16_bf16 v[128:143], a[240:243], v[88:91], v[128:143]
    s_waitcnt vmcnt(19)
    v_max3_u32 v8, v32, v33, v34
    v_max3_u32 v9, v35, v36, v37
    v_mfma_f32_32x32x16_bf16 v[144:159], a[252:255], v[92:95], v[144:159]
    s_add_u32 s101, s57, 157696
    buffer_load_dwordx4 v[76:79], v3, s[32:35], s101 offen offset:0 sc1
    v_max3_u32 v8, v8, v38, v39
    v_max_u32 v8, v8, v9
    v_cmp_eq_u32 vcc, -1, v8
    v_mfma_f32_32x32x16_bf16 v[128:143], a[248:251], v[92:95], v[128:143]
    s_cbranch_vccnz rty_79
bk_80:
    v_lshlrev_b32 v96, 16, v26
    v_mov_b32 v104, 0
    v_lshlrev_b32 v97, 16, v26
    v_mov_b32 v105, 0
    v_lshlrev_b32 v98, 16, v26
    v_mov_b32 v106, 0
    v_lshlrev_b32 v99, 16, v26
    v_mov_b32 v107, 0
    v_lshlrev_b32 v100, 16, v26
    v_mov_b32 v108, 0
    v_lshlrev_b32 v101, 16, v26
    v_mov_b32 v109, 0
    v_lshlrev_b32 v102, 16, v26
    v_mov_b32 v110, 0
    v_lshlrev_b32 v103, 16, v26
    v_mov_b32 v111, 0
    buffer_load_dwordx4 v30, s[28:31], s62 offen offset:2048 lds
    buffer_load_dwordx4 v31, s[28:31], s62 offen offset:3072 lds
    ds_write_b128 v12, v[144:147] offset:2048
    ds_write_b128 v12, v[148:151] offset:3072
    ds_write_b128 v13, v[152:155] offset:4096
    ds_write_b128 v13, v[156:159] offset:5120
    ds_write_b128 v11, v[136:139] offset:0
    ds_write_b128 v11, v[140:143] offset:1024
    s_add_u32 s63, s63, 1
    s_cmp_eq_u32 s63, 8
    s_cselect_b32 s63, 0, s63
    s_lshl_b32 s61, s63, 12
    s_add_u32 s61, s61, s60
    s_add_u32 m0, s61, 0
    s_add_u32 s61, s63, 6
    s_cmp_ge_u32 s61, 14
    s_cselect_b32 s62, s17, s16
    s_add_u32 s62, s62, s61
    s_lshl_b32 s62, s62, 17
    buffer_load_dwordx4 v28, s[28:31], s62 offen offset:0 lds
    buffer_load_dwordx4 v29, s[28:31], s62 offen offset:1024 lds
    buffer_load_dwordx4 v30, s[28:31], s62 offen offset:2048 lds
    buffer_load_dwordx4 v31, s[28:31], s62 offen offset:3072 lds
    s_add_u32 s63, s63, 1
    s_cmp_eq_u32 s63, 8
    s_cselect_b32 s63, 0, s63
    s_lshl_b32 s61, s63, 12
    s_add_u32 s61, s61, s60
    s_add_u32 m0, s61, 0
    s_add_u32 s61, s63, 6
    s_cmp_ge_u32 s61, 14
    s_cselect_b32 s62, s17, s16
    s_add_u32 s62, s62, s61
    s_lshl_b32 s62, s62, 17
    buffer_load_dwordx4 v28, s[28:31], s62 offen offset:0 lds
    buffer_load_dwordx4 v29, s[28:31], s62 offen offset:1024 lds
    s_waitcnt lgkmcnt(0)
    s_barrier
    ds_read_b128 v[136:139], v10 offset:0
    ds_read_b128 v[140:143], v10 offset:1024
    ds_read_b128 v[144:147], v10 offset:2048
    ds_read_b128 v[148:151], v10 offset:3072
    ds_read_b128 v[152:155], v10 offset:4096
    ds_read_b128 v[156:159], v10 offset:5120
    buffer_load_dwordx4 v30, s[28:31], s62 offen offset:2048 lds
    buffer_load_dwordx4 v31, s[28:31], s62 offen offset:3072 lds
    s_add_u32 s63, s63, 1
    s_cmp_eq_u32 s63, 8
    s_cselect_b32 s63, 0, s63
    s_lshl_b32 s61, s63, 12
    s_add_u32 s61, s61, s60
    s_add_u32 m0, s61, 0
    s_add_u32 s61, s63, 6
    s_cmp_ge_u32 s61, 14
    s_cselect_b32 s62, s17, s16
    s_add_u32 s62, s62, s61
    s_lshl_b32 s62, s62, 17
    buffer_load_dwordx4 v28, s[28:31], s62 offen offset:0 lds
    buffer_load_dwordx4 v29, s[28:31], s62 offen offset:1024 lds
    buffer_load_dwordx4 v30, s[28:31], s62 offen offset:2048 lds
    buffer_load_dwordx4 v31, s[28:31], s62 offen offset:3072 lds
    s_waitcnt lgkmcnt(4)
    v_pk_add_f32 v[128:129], v[128:129], v[136:137]
    v_pk_add_f32 v[130:131], v[130:131], v[138:139]
    v_pk_add_f32 v[132:133], v[132:133], v[140:141]
    v_pk_add_f32 v[134:135], v[134:135], v[142:143]
    s_waitcnt lgkmcnt(2)
    v_pk_add_f32 v[128:129], v[128:129], v[144:145]
    v_pk_add_f32 v[130:131], v[130:131], v[146:147]
    v_pk_add_f32 v[132:133], v[132:133], v[148:149]
    v_pk_add_f32 v[134:135], v[134:135], v[150:151]
    s_waitcnt lgkmcnt(0)
    v_pk_add_f32 v[128:129], v[128:129], v[152:153]
    v_pk_add_f32 v[130:131], v[130:131], v[154:155]
    v_pk_add_f32 v[132:133], v[132:133], v[156:157]
    v_pk_add_f32 v[134:135], v[134:135], v[158:159]
    v_pk_mul_f32 v[136:137], v[128:129], v[128:129]
    v_pk_mul_f32 v[138:139], v[130:131], v[130:131]
    v_pk_mul_f32 v[140:141], v[132:133], v[132:133]
    v_pk_mul_f32 v[142:143], v[134:135], v[134:135]
    v_pk_fma_f32 v[136:137], v[136:137], s[42:43], v[26:27] op_sel:[0,0,1] op_sel_hi:[1,1,1]
    v_pk_fma_f32 v[138:139], v[138:139], s[42:43], v[26:27] op_sel:[0,0,1] op_sel_hi:[1,1,1]
    v_pk_fma_f32 v[140:141], v[140:141], s[42:43], v[26:27] op_sel:[0,0,1] op_sel_hi:[1,1,1]
    v_pk_fma_f32 v[142:143], v[142:143], s[42:43], v[26:27] op_sel:[0,0,1] op_sel_hi:[1,1,1]
    v_pk_mul_f32 v[136:137], v[136:137], v[128:129]
    v_pk_mul_f32 v[138:139], v[138:139], v[130:131]
    v_pk_mul_f32 v[140:141], v[140:141], v[132:133]
    v_pk_mul_f32 v[142:143], v[142:143], v[134:135]
    v_exp_f32 v136, v136
    v_exp_f32 v137, v137
    v_exp_f32 v138, v138
    v_exp_f32 v139, v139
    v_exp_f32 v140, v140
    v_exp_f32 v141, v141
    v_exp_f32 v142, v142
    v_exp_f32 v143, v143
    v_pk_add_f32 v[136:137], v[136:137], 1.0 op_sel_hi:[1,0]
    v_pk_add_f32 v[138:139], v[138:139], 1.0 op_sel_hi:[1,0]
    v_pk_add_f32 v[140:141], v[140:141], 1.0 op_sel_hi:[1,0]
    v_pk_add_f32 v[142:143], v[142:143], 1.0 op_sel_hi:[1,0]
    v_rcp_f32 v136, v136
    v_rcp_f32 v137, v137
    v_rcp_f32 v138, v138
    v_rcp_f32 v139, v139
    v_rcp_f32 v140, v140
    v_rcp_f32 v141, v141
    v_rcp_f32 v142, v142
    v_rcp_f32 v143, v143
    v_pk_mul_f32 v[128:129], v[128:129], v[136:137]
    v_pk_mul_f32 v[130:131], v[130:131], v[138:139]
    v_pk_mul_f32 v[132:133], v[132:133], v[140:141]
    v_pk_mul_f32 v[134:135], v[134:135], v[142:143]
    v_cvt_pk_bf16_f32 v144, v128, v129
    v_cvt_pk_bf16_f32 v145, v130, v131
    v_cvt_pk_bf16_f32 v146, v132, v133
    v_cvt_pk_bf16_f32 v147, v134, v135
    buffer_store_dwordx4 v[144:147], v2, s[32:35], s44 offen offset:512 sc1
    s_add_u32 s63, s63, 1
    s_cmp_eq_u32 s63, 8
    s_cselect_b32 s63, 0, s63
    s_lshl_b32 s61, s63, 12
    s_add_u32 s61, s61, s60
    s_add_u32 m0, s61, 0
    s_add_u32 s61, s63, 6
    s_cmp_ge_u32 s61, 14
    s_cselect_b32 s62, s17, s16
    s_add_u32 s62, s62, s61
    s_lshl_b32 s62, s62, 17
    buffer_load_dwordx4 v28, s[28:31], s62 offen offset:0 lds
    buffer_load_dwordx4 v29, s[28:31], s62 offen offset:1024 lds
    buffer_load_dwordx4 v30, s[28:31], s62 offen offset:2048 lds
    buffer_load_dwordx4 v31, s[28:31], s62 offen offset:3072 lds
    s_add_u32 s63, s63, 1
    s_cmp_eq_u32 s63, 8
    s_cselect_b32 s63, 0, s63
    s_lshl_b32 s61, s63, 12
    s_add_u32 s61, s61, s60
    s_add_u32 m0, s61, 0
    s_add_u32 s61, s63, 6
    s_cmp_ge_u32 s61, 14
    s_cselect_b32 s62, s17, s16
    s_add_u32 s62, s62, s61
    s_lshl_b32 s62, s62, 17
    buffer_load_dwordx4 v28, s[28:31], s62 offen offset:0 lds
    buffer_load_dwordx4 v29, s[28:31], s62 offen offset:1024 lds
    buffer_load_dwordx4 v30, s[28:31], s62 offen offset:2048 lds
    buffer_load_dwordx4 v31, s[28:31], s62 offen offset:3072 lds
b2e_14:
    v_mfma_f32_32x32x16_bf16 v[112:127], v[32:35], v[164:167], 0
    s_add_u32 s101, s57, 172032
    buffer_load_dwordx4 v[80:83], v3, s[32:35], s101 offen offset:0 sc1
    v_mfma_f32_32x32x16_bf16 v[96:111], v[32:35], v[160:163], v[96:111]
    s_waitcnt vmcnt(40)
    v_max3_u32 v8, v40, v41, v42
    v_max3_u32 v9, v43, v44, v45
    v_mfma_f32_32x32x16_bf16 v[112:127], v[36:39], v[172:175], v[112:127]
    s_add_u32 s101, s57, 186368
    buffer_load_dwordx4 v[84:87], v3, s[32:35], s101 offen offset:0 sc1
    v_max3_u32 v8, v8, v46, v47
    v_max_u32 v8, v8, v9
    v_cmp_eq_u32 vcc, -1, v8
    v_mfma_f32_32x32x16_bf16 v[96:111], v[36:39], v[168:171], v[96:111]
    s_cbranch_vccnz rty_81
bk_82:
    v_mfma_f32_32x32x16_bf16 v[112:127], v[40:43], v[180:183], v[112:127]
    s_add_u32 s101, s57, 200704
    buffer_load_dwordx4 v[88:91], v3, s[32:35], s101 offen offset:0 sc1
    v_mfma_f32_32x32x16_bf16 v[96:111], v[40:43], v[176:179], v[96:111]
    s_waitcnt vmcnt(38)
    v_max3_u32 v8, v48, v49, v50
    v_max3_u32 v9, v51, v52, v53
    v_mfma_f32_32x32x16_bf16 v[112:127], v[44:47], v[188:191], v[112:127]
    s_add_u32 s101, s57, 215040
    buffer_load_dwordx4 v[92:95], v3, s[32:35], s101 offen offset:0 sc1
    v_max3_u32 v8, v8, v54, v55
    v_max_u32 v8, v8, v9
    v_cmp_eq_u32 vcc, -1, v8
    v_mfma_f32_32x32x16_bf16 v[96:111], v[44:47], v[184:187], v[96:111]
    s_cbranch_vccnz rty_83
bk_84:
    v_mfma_f32_32x32x16_bf16 v[112:127], v[48:51], v[196:199], v[112:127]
    s_add_u32 s101, s57, 229376
    buffer_load_dwordx4 v[32:35], v3, s[32:35], s101 offen offset:0 sc1
    v_mfma_f32_32x32x16_bf16 v[96:111], v[48:51], v[192:195], v[96:111]
    s_waitcnt vmcnt(36)
    v_max3_u32 v8, v56, v57, v58
    v_max3_u32 v9, v59, v60, v61
    v_mfma_f32_32x32x16_bf16 v[112:127], v[52:55], v[204:207], v[112:127]
    s_add_u32 s101, s57, 243712
    buffer_load_dwordx4 v[36:39], v3, s[32:35], s101 offen offset:0 sc1
    v_max3_u32 v8, v8, v62, v63
    v_max_u32 v8, v8, v9
    v_cmp_eq_u32 vcc, -1, v8
    v_mfma_f32_32x32x16_bf16 v[96:111], v[52:55], v[200:203], v[96:111]
    s_cbranch_vccnz rty_85
bk_86:
    v_mfma_f32_32x32x16_bf16 v[112:127], v[56:59], v[212:215], v[112:127]
    s_add_u32 s101, s57, 258048
    buffer_load_dwordx4 v[40:43], v3, s[32:35], s101 offen offset:0 sc1
    v_mfma_f32_32x32x16_bf16 v[96:111], v[56:59], v[208:211], v[96:111]
    s_waitcnt vmcnt(34)
    v_max3_u32 v8, v64, v65, v66
    v_max3_u32 v9, v67, v68, v69
    v_mfma_f32_32x32x16_bf16 v[112:127], v[60:63], v[220:223], v[112:127]
    s_add_u32 s101, s57, 272384
    buffer_load_dwordx4 v[44:47], v3, s[32:35], s101 offen offset:0 sc1
    v_max3_u32 v8, v8, v70, v71
    v_max_u32 v8, v8, v9
    v_cmp_eq_u32 vcc, -1, v8
    v_mfma_f32_32x32x16_bf16 v[96:111], v[60:63], v[216:219], v[96:111]
    s_cbranch_vccnz rty_87
bk_88:
    s_barrier
    v_mfma_f32_32x32x16_bf16 v[112:127], v[64:67], v[228:231], v[112:127]
    s_add_u32 s101, s57, 286720
    buffer_load_dwordx4 v[48:51], v3, s[32:35], s101 offen offset:0 sc1
    v_mfma_f32_32x32x16_bf16 v[96:111], v[64:67], v[224:227], v[96:111]
    s_waitcnt vmcnt(32)
    v_max3_u32 v8, v72, v73, v74
    v_max3_u32 v9, v75, v76, v77
    v_mfma_f32_32x32x16_bf16 v[112:127], v[68:71], v[236:239], v[112:127]
    s_add_u32 s101, s57, 301056
    buffer_load_dwordx4 v[52:55], v3, s[32:35], s101 offen offset:0 sc1
    v_max3_u32 v8, v8, v78, v79
    v_max_u32 v8, v8, v9
    v_cmp_eq_u32 vcc, -1, v8
    v_mfma_f32_32x32x16_bf16 v[96:111], v[68:71], v[232:235], v[96:111]
    s_cbranch_vccnz rty_89
bk_90:
    v_mfma_f32_32x32x16_bf16 v[112:127], v[72:75], v[244:247], v[112:127]
    s_add_u32 s101, s57, 315392
    buffer_load_dwordx4 v[56:59], v3, s[32:35], s101 offen offset:0 sc1
    s_waitcnt vmcnt(11)
    ds_read_b64_tr_b16 v[128:129], v4 offset:0
    ds_read_b64_tr_b16 v[130:131], v4 offset:1024
    ds_read_b64_tr_b16 v[132:133], v5 offset:0
    v_mfma_f32_32x32x16_bf16 v[96:111], v[72:75], v[240:243], v[96:111]
    ds_read_b64_tr_b16 v[134:135], v5 offset:1024
    ds_read_b64_tr_b16 v[136:137], v4 offset:2048
    ds_read_b64_tr_b16 v[138:139], v4 offset:3072
    s_waitcnt vmcnt(9)
    v_max3_u32 v8, v80, v81, v82
    v_max3_u32 v9, v83, v84, v85
    v_mfma_f32_32x32x16_bf16 v[112:127], v[76:79], v[252:255], v[112:127]
    s_add_u32 s101, s57, 329728
    buffer_load_dwordx4 v[60:63], v3, s[32:35], s101 offen offset:0 sc1
    ds_read_b64_tr_b16 v[140:141], v5 offset:2048
    ds_read_b64_tr_b16 v[142:143], v5 offset:3072
    v_max3_u32 v8, v8, v86, v87
    v_max_u32 v8, v8, v9
    v_cmp_eq_u32 vcc, -1, v8
    v_mfma_f32_32x32x16_bf16 v[96:111], v[76:79], v[248:251], v[96:111]
    s_cbranch_vccnz rty_91
bk_92:
    s_waitcnt lgkmcnt(0)
    v_mfma_f32_32x32x16_bf16 v[112:127], v[80:83], v[132:135], v[112:127]
    s_add_u32 s101, s57, 344064
    buffer_load_dwordx4 v[64:67], v3, s[32:35], s101 offen offset:0 sc1
    ds_read_b64_tr_b16 v[144:145], v4 offset:4096
    ds_read_b64_tr_b16 v[146:147], v4 offset:5120
    ds_read_b64_tr_b16 v[148:149], v5 offset:4096
    v_mfma_f32_32x32x16_bf16 v[96:111], v[80:83], v[128:131], v[96:111]
    ds_read_b64_tr_b16 v[150:151], v5 offset:5120
    ds_read_b64_tr_b16 v[152:153], v4 offset:6144
    ds_read_b64_tr_b16 v[154:155], v4 offset:7168
    s_waitcnt vmcnt(9)
    v_max3_u32 v8, v88, v89, v90
    v_max3_u32 v9, v91, v92, v93
    v_mfma_f32_32x32x16_bf16 v[112:127], v[84:87], v[140:143], v[112:127]
    s_add_u32 s101, s57, 358400
    buffer_load_dwordx4 v[68:71], v3, s[32:35], s101 offen offset:0 sc1
    ds_read_b64_tr_b16 v[156:157], v5 offset:6144
    ds_read_b64_tr_b16 v[158:159], v5 offset:7168
    v_max3_u32 v8, v8, v94, v95
    v_max_u32 v8, v8, v9
    v_cmp_eq_u32 vcc, -1, v8
    v_mfma_f32_32x32x16_bf16 v[96:111], v[84:87], v[136:139], v[96:111]
    s_cbranch_vccnz rty_93
bk_94:
    s_waitcnt lgkmcnt(0)
    v_mfma_f32_32x32x16_bf16 v[112:127], v[88:91], v[148:151], v[112:127]
    s_add_u32 s101, s57, 372736
    buffer_load_dwordx4 v[72:75], v3, s[32:35], s101 offen offset:0 sc1
    ds_read_b64_tr_b16 v[128:129], v4 offset:8192
    ds_read_b64_tr_b16 v[130:131], v4 offset:9216
    ds_read_b64_tr_b16 v[132:133], v5 offset:8192
    v_mfma_f32_32x32x16_bf16 v[96:111], v[88:91], v[144:147], v[96:111]
    ds_read_b64_tr_b16 v[134:135], v5 offset:9216
    ds_read_b64_tr_b16 v[136:137], v4 offset:10240
    ds_read_b64_tr_b16 v[138:139], v4 offset:11264
    s_waitcnt vmcnt(9)
    v_max3_u32 v8, v32, v33, v34
    v_max3_u32 v9, v35, v36, v37
    v_mfma_f32_32x32x16_bf16 v[112:127], v[92:95], v[156:159], v[112:127]
    s_add_u32 s101, s57, 387072
    buffer_load_dwordx4 v[76:79], v3, s[32:35], s101 offen offset:0 sc1
    ds_read_b64_tr_b16 v[140:141], v5 offset:10240
    ds_read_b64_tr_b16 v[142:143], v5 offset:11264
    v_max3_u32 v8, v8, v38, v39
    v_max_u32 v8, v8, v9
    v_cmp_eq_u32 vcc, -1, v8
    v_mfma_f32_32x32x16_bf16 v[96:111], v[92:95], v[152:155], v[96:111]
    s_cbranch_vccnz rty_95
bk_96:
    s_waitcnt lgkmcnt(0)
    v_mfma_f32_32x32x16_bf16 v[112:127], v[32:35], v[132:135], v[112:127]
    s_add_u32 s101, s57, 0
    buffer_load_dwordx4 v[80:83], v3, s[32:35], s101 offen offset:512 sc1
    ds_read_b64_tr_b16 v[144:145], v4 offset:12288
    ds_read_b64_tr_b16 v[146:147], v4 offset:13312
    ds_read_b64_tr_b16 v[148:149], v5 offset:12288
    v_mfma_f32_32x32x16_bf16 v[96:111], v[32:35], v[128:131], v[96:111]
    ds_read_b64_tr_b16 v[150:151], v5 offset:13312
    ds_read_b64_tr_b16 v[152:153], v4 offset:14336
    ds_read_b64_tr_b16 v[154:155], v4 offset:15360
    s_waitcnt vmcnt(9)
    v_max3_u32 v8, v40, v41, v42
    v_max3_u32 v9, v43, v44, v45
    v_mfma_f32_32x32x16_bf16 v[112:127], v[36:39], v[140:143], v[112:127]
    s_add_u32 s101, s57, 14336
    buffer_load_dwordx4 v[84:87], v3, s[32:35], s101 offen offset:512 sc1
    ds_read_b64_tr_b16 v[156:157], v5 offset:14336
    ds_read_b64_tr_b16 v[158:159], v5 offset:15360
    v_max3_u32 v8, v8, v46, v47
    v_max_u32 v8, v8, v9
    v_cmp_eq_u32 vcc, -1, v8
    v_mfma_f32_32x32x16_bf16 v[96:111], v[36:39], v[136:139], v[96:111]
    s_cbranch_vccnz rty_97
bk_98:
    s_waitcnt lgkmcnt(0)
    v_lshrrev_b32 v15, 6, v0
    v_bfe_u32 v9, v0, 3, 3
    v_lshl_add_u32 v9, v15, 4, v9
    s_lshl_b32 s59, s52, 6
    v_add_u32 v24, s59, v9
    v_mul_u32_u24 v24, 896, v24
    v_and_b32 v15, 7, v0
    v_lshl_add_u32 v24, v15, 4, v24
    s_mul_i32 s59, s50, 128
    v_add_u32 v24, s59, v24
    v_add_u32 v25, 7168, v24
    v_xor_b32 v15, v15, v9
    v_and_b32 v15, 7, v15
    v_lshlrev_b32 v14, 7, v9
    v_lshl_add_u32 v14, v15, 4, v14
    v_add_u32 v14, 0x26000, v14
    v_mfma_f32_32x32x16_bf16 v[112:127], v[40:43], v[148:151], v[112:127]
    s_add_u32 s101, s57, 28672
    buffer_load_dwordx4 v[88:91], v3, s[32:35], s101 offen offset:512 sc1
    ds_read_b64_tr_b16 v[128:129], v4 offset:16384
    ds_read_b64_tr_b16 v[130:131], v4 offset:17408
    ds_read_b64_tr_b16 v[132:133], v5 offset:16384
    v_mfma_f32_32x32x16_bf16 v[96:111], v[40:43], v[144:147], v[96:111]
    ds_read_b64_tr_b16 v[134:135], v5 offset:17408
    ds_read_b64_tr_b16 v[136:137], v4 offset:18432
    ds_read_b64_tr_b16 v[138:139], v4 offset:19456
    s_waitcnt vmcnt(9)
    v_max3_u32 v8, v48, v49, v50
    v_max3_u32 v9, v51, v52, v53
    v_mfma_f32_32x32x16_bf16 v[112:127], v[44:47], v[156:159], v[112:127]
    s_add_u32 s101, s57, 43008
    buffer_load_dwordx4 v[92:95], v3, s[32:35], s101 offen offset:512 sc1
    ds_read_b64_tr_b16 v[140:141], v5 offset:18432
    ds_read_b64_tr_b16 v[142:143], v5 offset:19456
    v_max3_u32 v8, v8, v54, v55
    v_max_u32 v8, v8, v9
    v_cmp_eq_u32 vcc, -1, v8
    v_mfma_f32_32x32x16_bf16 v[96:111], v[44:47], v[152:155], v[96:111]
    s_cbranch_vccnz rty_99
bk_100:
    s_waitcnt lgkmcnt(0)
    v_bfe_u32 v9, v0, 7, 1
    v_lshlrev_b32 v9, 5, v9
    v_and_b32 v15, 31, v0
    v_add_u32 v9, v9, v15
    v_bfe_u32 v15, v0, 6, 1
    v_lshlrev_b32 v15, 1, v15
    v_xor_b32 v15, v15, v9
    v_and_b32 v15, 7, v15
    v_lshlrev_b32 v7, 7, v9
    v_lshl_add_u32 v7, v15, 4, v7
    v_bfe_u32 v15, v0, 5, 1
    v_lshl_add_u32 v7, v15, 3, v7
    v_add_u32 v7, 0x26000, v7
    v_mfma_f32_32x32x16_bf16 v[112:127], v[48:51], v[132:135], v[112:127]
    s_add_u32 s101, s57, 57344
    buffer_load_dwordx4 v[32:35], v3, s[32:35], s101 offen offset:512 sc1
    ds_read_b64_tr_b16 v[144:145], v4 offset:20480
    ds_read_b64_tr_b16 v[146:147], v4 offset:21504
    ds_read_b64_tr_b16 v[148:149], v5 offset:20480
    v_mfma_f32_32x32x16_bf16 v[96:111], v[48:51], v[128:131], v[96:111]
    ds_read_b64_tr_b16 v[150:151], v5 offset:21504
    ds_read_b64_tr_b16 v[152:153], v4 offset:22528
    ds_read_b64_tr_b16 v[154:155], v4 offset:23552
    s_waitcnt vmcnt(9)
    v_max3_u32 v8, v56, v57, v58
    v_max3_u32 v9, v59, v60, v61
    v_mfma_f32_32x32x16_bf16 v[112:127], v[52:55], v[140:143], v[112:127]
    s_add_u32 s101, s57, 71680
    buffer_load_dwordx4 v[36:39], v3, s[32:35], s101 offen offset:512 sc1
    ds_read_b64_tr_b16 v[156:157], v5 offset:22528
    ds_read_b64_tr_b16 v[158:159], v5 offset:23552
    v_max3_u32 v8, v8, v62, v63
    v_max_u32 v8, v8, v9
    v_cmp_eq_u32 vcc, -1, v8
    v_mfma_f32_32x32x16_bf16 v[96:111], v[52:55], v[136:139], v[96:111]
    s_cbranch_vccnz rty_101
bk_102:
    s_waitcnt lgkmcnt(0)
    v_mfma_f32_32x32x16_bf16 v[112:127], v[56:59], v[148:151], v[112:127]
    s_add_u32 s101, s57, 86016
    buffer_load_dwordx4 v[40:43], v3, s[32:35], s101 offen offset:512 sc1
    ds_read_b64_tr_b16 v[128:129], v4 offset:24576
    ds_read_b64_tr_b16 v[130:131], v4 offset:25600
    ds_read_b64_tr_b16 v[132:133], v5 offset:24576
    v_mfma_f32_32x32x16_bf16 v[96:111], v[56:59], v[144:147], v[96:111]
    ds_read_b64_tr_b16 v[134:135], v5 offset:25600
    ds_read_b64_tr_b16 v[136:137], v4 offset:26624
    ds_read_b64_tr_b16 v[138:139], v4 offset:27648
    s_waitcnt vmcnt(9)
    v_max3_u32 v8, v64, v65, v66
    v_max3_u32 v9, v67, v68, v69
    v_mfma_f32_32x32x16_bf16 v[112:127], v[60:63], v[156:159], v[112:127]
    s_add_u32 s101, s57, 100352
    buffer_load_dwordx4 v[44:47], v3, s[32:35], s101 offen offset:512 sc1
    ds_read_b64_tr_b16 v[140:141], v5 offset:26624
    ds_read_b64_tr_b16 v[142:143], v5 offset:27648
    v_max3_u32 v8, v8, v70, v71
    v_max_u32 v8, v8, v9
    v_cmp_eq_u32 vcc, -1, v8
    v_mfma_f32_32x32x16_bf16 v[96:111], v[60:63], v[152:155], v[96:111]
    s_cbranch_vccnz rty_103
bk_104:
    s_waitcnt lgkmcnt(0)
    v_mfma_f32_32x32x16_bf16 v[112:127], v[64:67], v[132:135], v[112:127]
    s_add_u32 s101, s57, 114688
    buffer_load_dwordx4 v[48:51], v3, s[32:35], s101 offen offset:512 sc1
    ds_read_b64_tr_b16 v[144:145], v4 offset:28672
    ds_read_b64_tr_b16 v[146:147], v4 offset:29696
    ds_read_b64_tr_b16 v[148:149], v5 offset:28672
    v_mfma_f32_32x32x16_bf16 v[96:111], v[64:67], v[128:131], v[96:111]
    ds_read_b64_tr_b16 v[150:151], v5 offset:29696
    ds_read_b64_tr_b16 v[152:153], v4 offset:30720
    ds_read_b64_tr_b16 v[154:155], v4 offset:31744
    s_waitcnt vmcnt(9)
    v_max3_u32 v8, v72, v73, v74
    v_max3_u32 v9, v75, v76, v77
    v_mfma_f32_32x32x16_bf16 v[112:127], v[68:71], v[140:143], v[112:127]
    s_add_u32 s101, s57, 129024
    buffer_load_dwordx4 v[52:55], v3, s[32:35], s101 offen offset:512 sc1
    ds_read_b64_tr_b16 v[156:157], v5 offset:30720
    ds_read_b64_tr_b16 v[158:159], v5 offset:31744
    v_max3_u32 v8, v8, v78, v79
    v_max_u32 v8, v8, v9
    v_cmp_eq_u32 vcc, -1, v8
    v_mfma_f32_32x32x16_bf16 v[96:111], v[68:71], v[136:139], v[96:111]
    s_cbranch_vccnz rty_105
bk_106:
    s_waitcnt lgkmcnt(0)
    v_mfma_f32_32x32x16_bf16 v[112:127], v[72:75], v[148:151], v[112:127]
    s_add_u32 s101, s57, 143360
    buffer_load_dwordx4 v[56:59], v3, s[32:35], s101 offen offset:512 sc1
    v_mfma_f32_32x32x16_bf16 v[96:111], v[72:75], v[144:147], v[96:111]
    s_waitcnt vmcnt(9)
    v_max3_u32 v8, v80, v81, v82
    v_max3_u32 v9, v83, v84, v85
    v_mfma_f32_32x32x16_bf16 v[112:127], v[76:79], v[156:159], v[112:127]
    s_add_u32 s101, s57, 157696
    buffer_load_dwordx4 v[60:63], v3, s[32:35], s101 offen offset:512 sc1
    v_max3_u32 v8, v8, v86, v87
    v_max_u32 v8, v8, v9
    v_cmp_eq_u32 vcc, -1, v8
    v_mfma_f32_32x32x16_bf16 v[96:111], v[76:79], v[152:155], v[96:111]
    s_cbranch_vccnz rty_107
bk_108:
    v_lshlrev_b32 v128, 16, v26
    v_mov_b32 v136, 0
    v_lshlrev_b32 v129, 16, v26
    v_mov_b32 v137, 0
    v_lshlrev_b32 v130, 16, v26
    v_mov_b32 v138, 0
    v_lshlrev_b32 v131, 16, v26
    v_mov_b32 v139, 0
    v_lshlrev_b32 v132, 16, v26
    v_mov_b32 v140, 0
    v_lshlrev_b32 v133, 16, v26
    v_mov_b32 v141, 0
    v_lshlrev_b32 v134, 16, v26
    v_mov_b32 v142, 0
    v_lshlrev_b32 v135, 16, v26
    v_mov_b32 v143, 0
    s_add_u32 s101, s57, 172032
    buffer_load_dwordx4 v[64:67], v3, s[32:35], s101 offen offset:512 sc1
    s_add_u32 s101, s57, 186368
    buffer_load_dwordx4 v[68:71], v3, s[32:35], s101 offen offset:512 sc1
    s_add_u32 s101, s57, 200704
    buffer_load_dwordx4 v[72:75], v3, s[32:35], s101 offen offset:512 sc1
    s_add_u32 s101, s57, 215040
    buffer_load_dwordx4 v[76:79], v3, s[32:35], s101 offen offset:512 sc1
    v_mfma_f32_32x32x16_bf16 v[144:159], v[80:83], v[164:167], 0
    v_mfma_f32_32x32x16_bf16 v[128:143], v[80:83], v[160:163], v[128:143]
    ds_write_b128 v12, v[112:115] offset:2048
    ds_write_b128 v12, v[116:119] offset:3072
    ds_write_b128 v13, v[120:123] offset:4096
    ds_write_b128 v13, v[124:127] offset:5120
    ds_write_b128 v11, v[104:107] offset:0
    ds_write_b128 v11, v[108:111] offset:1024
    s_waitcnt vmcnt(12)
    v_max3_u32 v8, v88, v89, v90
    v_max3_u32 v9, v91, v92, v93
    v_mfma_f32_32x32x16_bf16 v[144:159], v[84:87], v[172:175], v[144:159]
    v_max3_u32 v8, v8, v94, v95
    v_max_u32 v8, v8, v9
    v_cmp_eq_u32 vcc, -1, v8
    v_mfma_f32_32x32x16_bf16 v[128:143], v[84:87], v[168:171], v[128:143]
    s_cbranch_vccnz rty_109
bk_110:
    s_waitcnt lgkmcnt(0)
    s_barrier
    ds_read_b128 v[104:107], v10 offset:0
    ds_read_b128 v[108:111], v10 offset:1024
    ds_read_b128 v[112:115], v10 offset:2048
    ds_read_b128 v[116:119], v10 offset:3072
    v_mfma_f32_32x32x16_bf16 v[144:159], v[88:91], v[180:183], v[144:159]
    s_add_u32 s101, s57, 229376
    buffer_load_dwordx4 v[80:83], v3, s[32:35], s101 offen offset:512 sc1
    v_mfma_f32_32x32x16_bf16 v[128:143], v[88:91], v[176:179], v[128:143]
    ds_read_b128 v[120:123], v10 offset:4096
    ds_read_b128 v[124:127], v10 offset:5120
    s_waitcnt vmcnt(11)
    v_max3_u32 v8, v32, v33, v34
    v_max3_u32 v9, v35, v36, v37
    v_mfma_f32_32x32x16_bf16 v[144:159], v[92:95], v[188:191], v[144:159]
    s_add_u32 s101, s57, 243712
    buffer_load_dwordx4 v[84:87], v3, s[32:35], s101 offen offset:512 sc1
    s_waitcnt lgkmcnt(4)
    v_add_f32 v96, v96, v104
    v_add_f32 v97, v97, v105
    v_add_f32 v98, v98, v106
    v_max3_u32 v8, v8, v38, v39
    v_max_u32 v8, v8, v9
    v_cmp_eq_u32 vcc, -1, v8
    v_mfma_f32_32x32x16_bf16 v[128:143], v[92:95], v[184:187], v[128:143]
    s_cbranch_vccnz rty_111
bk_112:
    v_add_f32 v99, v99, v107
    v_add_f32 v100, v100, v108
    v_add_f32 v101, v101, v109
    v_add_f32 v102, v102, v110
    v_add_f32 v103, v103, v111
    s_waitcnt lgkmcnt(2)
    v_mfma_f32_32x32x16_bf16 v[144:159], v[32:35], v[196:199], v[144:159]
    s_add_u32 s101, s57, 258048
    buffer_load_dwordx4 v[88:91], v3, s[32:35], s101 offen offset:512 sc1
    v_mfma_f32_32x32x16_bf16 v[128:143], v[32:35], v[192:195], v[128:143]
    v_add_f32 v96, v96, v112
    v_add_f32 v97, v97, v113
    v_add_f32 v98, v98, v114
    v_add_f32 v99, v99, v115
    v_add_f32 v100, v100, v116
    v_add_f32 v101, v101, v117
    s_waitcnt vmcnt(11)
    v_max3_u32 v8, v40, v41, v42
    v_max3_u32 v9, v43, v44, v45
    v_mfma_f32_32x32x16_bf16 v[144:159], v[36:39], v[204:207], v[144:159]
    s_add_u32 s101, s57, 272384
    buffer_load_dwordx4 v[92:95], v3, s[32:35], s101 offen offset:512 sc1
    v_add_f32 v102, v102, v118
    v_add_f32 v103, v103, v119
    s_waitcnt lgkmcnt(0)
    v_add_f32 v96, v96, v120
    v_max3_u32 v8, v8, v46, v47
    v_max_u32 v8, v8, v9
    v_cmp_eq_u32 vcc, -1, v8
    v_mfma_f32_32x32x16_bf16 v[128:143], v[36:39], v[200:203], v[128:143]
    s_cbranch_vccnz rty_113
bk_114:
    v_add_f32 v97, v97, v121
    v_add_f32 v98, v98, v122
    v_add_f32 v99, v99, v123
    v_add_f32 v100, v100, v124
    v_add_f32 v101, v101, v125
    v_add_f32 v102, v102, v126
    v_mfma_f32_32x32x16_bf16 v[144:159], v[40:43], v[212:215], v[144:159]
    s_add_u32 s101, s57, 286720
    buffer_load_dwordx4 v[32:35], v3, s[32:35], s101 offen offset:512 sc1
    v_mfma_f32_32x32x16_bf16 v[128:143], v[40:43], v[208:211], v[128:143]
    v_add_f32 v103, v103, v127
    v_cvt_pk_bf16_f32 v104, v96, v97
    v_cvt_pk_bf16_f32 v105, v98, v99
    v_cvt_pk_bf16_f32 v106, v100, v101
    v_cvt_pk_bf16_f32 v107, v102, v103
    v_xor_b32 v15, 0, v7
    s_waitcnt vmcnt(11)
    v_max3_u32 v8, v48, v49, v50
    v_max3_u32 v9, v51, v52, v53
    v_mfma_f32_32x32x16_bf16 v[144:159], v[44:47], v[220:223], v[144:159]
    s_add_u32 s101, s57, 301056
    buffer_load_dwordx4 v[36:39], v3, s[32:35], s101 offen offset:512 sc1
    ds_write_b64 v15, v[104:105]
    v_xor_b32 v15, 16, v7
    ds_write_b64 v15, v[106:107]
    v_max3_u32 v8, v8, v54, v55
    v_max_u32 v8, v8, v9
    v_cmp_eq_u32 vcc, -1, v8
    v_mfma_f32_32x32x16_bf16 v[128:143], v[44:47], v[216:219], v[128:143]
    s_cbranch_vccnz rty_115
bk_116:
    v_mfma_f32_32x32x16_bf16 v[144:159], v[48:51], v[228:231], v[144:159]
    s_add_u32 s101, s57, 315392
    buffer_load_dwordx4 v[40:43], v3, s[32:35], s101 offen offset:512 sc1
    v_mfma_f32_32x32x16_bf16 v[128:143], v[48:51], v[224:227], v[128:143]
    s_waitcnt vmcnt(11)
    v_max3_u32 v8, v56, v57, v58
    v_max3_u32 v9, v59, v60, v61
    v_mfma_f32_32x32x16_bf16 v[144:159], v[52:55], v[236:239], v[144:159]
    s_add_u32 s101, s57, 329728
    buffer_load_dwordx4 v[44:47], v3, s[32:35], s101 offen offset:512 sc1
    v_max3_u32 v8, v8, v62, v63
    v_max_u32 v8, v8, v9
    v_cmp_eq_u32 vcc, -1, v8
    v_mfma_f32_32x32x16_bf16 v[128:143], v[52:55], v[232:235], v[128:143]
    s_cbranch_vccnz rty_117
bk_118:
    v_mfma_f32_32x32x16_bf16 v[144:159], v[56:59], v[244:247], v[144:159]
    s_add_u32 s101, s57, 344064
    buffer_load_dwordx4 v[48:51], v3, s[32:35], s101 offen offset:512 sc1
    ds_read_b64_tr_b16 v[96:97], v4 offset:0
    ds_read_b64_tr_b16 v[98:99], v4 offset:1024
    ds_read_b64_tr_b16 v[100:101], v5 offset:0
    v_mfma_f32_32x32x16_bf16 v[128:143], v[56:59], v[240:243], v[128:143]
    ds_read_b64_tr_b16 v[102:103], v5 offset:1024
    ds_read_b64_tr_b16 v[104:105], v4 offset:2048
    ds_read_b64_tr_b16 v[106:107], v4 offset:3072
    s_waitcnt vmcnt(11)
    v_max3_u32 v8, v64, v65, v66
    v_max3_u32 v9, v67, v68, v69
    v_mfma_f32_32x32x16_bf16 v[144:159], v[60:63], v[252:255], v[144:159]
    s_add_u32 s101, s57, 358400
    buffer_load_dwordx4 v[52:55], v3, s[32:35], s101 offen offset:512 sc1
    ds_read_b64_tr_b16 v[108:109], v5 offset:2048
    ds_read_b64_tr_b16 v[110:111], v5 offset:3072
    v_max3_u32 v8, v8, v70, v71
    v_max_u32 v8, v8, v9
    v_cmp_eq_u32 vcc, -1, v8
    v_mfma_f32_32x32x16_bf16 v[128:143], v[60:63], v[248:251], v[128:143]
    s_cbranch_vccnz rty_119
bk_120:
    s_waitcnt lgkmcnt(0)
    v_mfma_f32_32x32x16_bf16 v[144:159], v[64:67], v[100:103], v[144:159]
    s_add_u32 s101, s57, 372736
    buffer_load_dwordx4 v[56:59], v3, s[32:35], s101 offen offset:512 sc1
    ds_read_b64_tr_b16 v[112:113], v4 offset:4096
    ds_read_b64_tr_b16 v[114:115], v4 offset:5120
    ds_read_b64_tr_b16 v[116:117], v5 offset:4096
    v_mfma_f32_32x32x16_bf16 v[128:143], v[64:67], v[96:99], v[128:143]
    ds_read_b64_tr_b16 v[118:119], v5 offset:5120
    ds_read_b64_tr_b16 v[120:121], v4 offset:6144
    ds_read_b64_tr_b16 v[122:123], v4 offset:7168
    s_waitcnt vmcnt(11)
    v_max3_u32 v8, v72, v73, v74
    v_max3_u32 v9, v75, v76, v77
    v_mfma_f32_32x32x16_bf16 v[144:159], v[68:71], v[108:111], v[144:159]
    s_add_u32 s101, s57, 387072
    buffer_load_dwordx4 v[60:63], v3, s[32:35], s101 offen offset:512 sc1
    ds_read_b64_tr_b16 v[124:125], v5 offset:6144
    ds_read_b64_tr_b16 v[126:127], v5 offset:7168
    v_max3_u32 v8, v8, v78, v79
    v_max_u32 v8, v8, v9
    v_cmp_eq_u32 vcc, -1, v8
    v_mfma_f32_32x32x16_bf16 v[128:143], v[68:71], v[104:107], v[128:143]
    s_cbranch_vccnz rty_121
bk_122:
    s_waitcnt lgkmcnt(0)
    v_mfma_f32_32x32x16_bf16 v[144:159], v[72:75], v[116:119], v[144:159]
    ds_read_b64_tr_b16 v[96:97], v4 offset:8192
    ds_read_b64_tr_b16 v[98:99], v4 offset:9216
    ds_read_b64_tr_b16 v[100:101], v5 offset:8192
    v_mfma_f32_32x32x16_bf16 v[128:143], v[72:75], v[112:115], v[128:143]
    ds_read_b64_tr_b16 v[102:103], v5 offset:9216
    ds_read_b64_tr_b16 v[104:105], v4 offset:10240
    ds_read_b64_tr_b16 v[106:107], v4 offset:11264
    s_waitcnt vmcnt(10)
    v_max3_u32 v8, v80, v81, v82
    v_max3_u32 v9, v83, v84, v85
    v_mfma_f32_32x32x16_bf16 v[144:159], v[76:79], v[124:127], v[144:159]
    ds_read_b64_tr_b16 v[108:109], v5 offset:10240
    ds_read_b64_tr_b16 v[110:111], v5 offset:11264
    v_max3_u32 v8, v8, v86, v87
    v_max_u32 v8, v8, v9
    v_cmp_eq_u32 vcc, -1, v8
    v_mfma_f32_32x32x16_bf16 v[128:143], v[76:79], v[120:123], v[128:143]
    s_cbranch_vccnz rty_123
bk_124:
    s_waitcnt lgkmcnt(0)
    v_mfma_f32_32x32x16_bf16 v[144:159], v[80:83], v[100:103], v[144:159]
    s_mov_b32 s58, 0xa00000
    buffer_load_dwordx4 v[16:19], v24, s[32:35], s58 offen sc1
    buffer_load_dwordx4 v[20:23], v25, s[32:35], s58 offen sc1
    ds_read_b64_tr_b16 v[112:113], v4 offset:12288
    ds_read_b64_tr_b16 v[114:115], v4 offset:13312
    ds_read_b64_tr_b16 v[116:117], v5 offset:12288
    v_mfma_f32_32x32x16_bf16 v[128:143], v[80:83], v[96:99], v[128:143]
    ds_read_b64_tr_b16 v[118:119], v5 offset:13312
    ds_read_b64_tr_b16 v[120:121], v4 offset:14336
    ds_read_b64_tr_b16 v[122:123], v4 offset:15360
    s_waitcnt vmcnt(10)
    v_max3_u32 v8, v88, v89, v90
    v_max3_u32 v9, v91, v92, v93
    v_mfma_f32_32x32x16_bf16 v[144:159], v[84:87], v[108:111], v[144:159]
    ds_read_b64_tr_b16 v[124:125], v5 offset:14336
    ds_read_b64_tr_b16 v[126:127], v5 offset:15360
    v_max3_u32 v8, v8, v94, v95
    v_max_u32 v8, v8, v9
    v_cmp_eq_u32 vcc, -1, v8
    v_mfma_f32_32x32x16_bf16 v[128:143], v[84:87], v[104:107], v[128:143]
    s_cbranch_vccnz rty_125
bk_126:
    v_lshlrev_b32 v27, 4, v0
    v_mov_b32 v28, -1
    v_mov_b32 v29, -1
    v_mov_b32 v30, -1
    v_mov_b32 v31, -1
    s_lshl_b32 s98, s2, 13
    s_add_u32 s98, s98, 0x600000
    buffer_store_dwordx4 v[28:31], v27, s[32:35], s98 offen sc1
    s_waitcnt lgkmcnt(0)
    v_mfma_f32_32x32x16_bf16 v[144:159], v[88:91], v[116:119], v[144:159]
    ds_read_b64_tr_b16 v[96:97], v4 offset:16384
    ds_read_b64_tr_b16 v[98:99], v4 offset:17408
    ds_read_b64_tr_b16 v[100:101], v5 offset:16384
    v_mfma_f32_32x32x16_bf16 v[128:143], v[88:91], v[112:115], v[128:143]
    ds_read_b64_tr_b16 v[102:103], v5 offset:17408
    ds_read_b64_tr_b16 v[104:105], v4 offset:18432
    ds_read_b64_tr_b16 v[106:107], v4 offset:19456
    s_waitcnt vmcnt(9)
    v_max3_u32 v8, v32, v33, v34
    v_max3_u32 v9, v35, v36, v37
    v_mfma_f32_32x32x16_bf16 v[144:159], v[92:95], v[124:127], v[144:159]
    ds_read_b64_tr_b16 v[108:109], v5 offset:18432
    ds_read_b64_tr_b16 v[110:111], v5 offset:19456
    v_max3_u32 v8, v8, v38, v39
    v_max_u32 v8, v8, v9
    v_cmp_eq_u32 vcc, -1, v8
    v_mfma_f32_32x32x16_bf16 v[128:143], v[92:95], v[120:123], v[128:143]
    s_cbranch_vccnz rty_127
bk_128:
    s_barrier
    s_lshl_b32 s98, s2, 13
    s_add_u32 s98, s98, 0x601000
    buffer_store_dwordx4 v[28:31], v27, s[32:35], s98 offen sc1
    s_lshl_b32 s98, s2, 13
    s_add_u32 s98, s98, 0x1200000
    buffer_store_dwordx4 v[28:31], v27, s[32:35], s98 offen sc1
    s_waitcnt lgkmcnt(0)
    v_mfma_f32_32x32x16_bf16 v[144:159], v[32:35], v[100:103], v[144:159]
    ds_read_b64_tr_b16 v[112:113], v4 offset:20480
    ds_read_b64_tr_b16 v[114:115], v4 offset:21504
    ds_read_b64_tr_b16 v[116:117], v5 offset:20480
    v_mfma_f32_32x32x16_bf16 v[128:143], v[32:35], v[96:99], v[128:143]
    ds_read_b64_tr_b16 v[118:119], v5 offset:21504
    ds_read_b64_tr_b16 v[120:121], v4 offset:22528
    ds_read_b64_tr_b16 v[122:123], v4 offset:23552
    s_waitcnt vmcnt(9)
    v_max3_u32 v8, v40, v41, v42
    v_max3_u32 v9, v43, v44, v45
    v_mfma_f32_32x32x16_bf16 v[144:159], v[36:39], v[108:111], v[144:159]
    ds_read_b64_tr_b16 v[124:125], v5 offset:22528
    ds_read_b64_tr_b16 v[126:127], v5 offset:23552
    v_max3_u32 v8, v8, v46, v47
    v_max_u32 v8, v8, v9
    v_cmp_eq_u32 vcc, -1, v8
    v_mfma_f32_32x32x16_bf16 v[128:143], v[36:39], v[104:107], v[128:143]
    s_cbranch_vccnz rty_129
bk_130:
    s_lshl_b32 s98, s2, 13
    s_add_u32 s98, s98, 0x1201000
    buffer_store_dwordx4 v[28:31], v27, s[32:35], s98 offen sc1
    s_lshl_b32 s98, s2, 13
    s_add_u32 s98, s98, 0x1600000
    buffer_store_dwordx4 v[28:31], v27, s[32:35], s98 offen sc1
    s_waitcnt lgkmcnt(0)
    v_mfma_f32_32x32x16_bf16 v[144:159], v[40:43], v[116:119], v[144:159]
    ds_read_b64_tr_b16 v[96:97], v4 offset:24576
    ds_read_b64_tr_b16 v[98:99], v4 offset:25600
    ds_read_b64_tr_b16 v[100:101], v5 offset:24576
    v_mfma_f32_32x32x16_bf16 v[128:143], v[40:43], v[112:115], v[128:143]
    ds_read_b64_tr_b16 v[102:103], v5 offset:25600
    ds_read_b64_tr_b16 v[104:105], v4 offset:26624
    ds_read_b64_tr_b16 v[106:107], v4 offset:27648
    s_waitcnt vmcnt(9)
    v_max3_u32 v8, v48, v49, v50
    v_max3_u32 v9, v51, v52, v53
    v_mfma_f32_32x32x16_bf16 v[144:159], v[44:47], v[124:127], v[144:159]
    ds_read_b64_tr_b16 v[108:109], v5 offset:26624
    ds_read_b64_tr_b16 v[110:111], v5 offset:27648
    v_max3_u32 v8, v8, v54, v55
    v_max_u32 v8, v8, v9
    v_cmp_eq_u32 vcc, -1, v8
    v_mfma_f32_32x32x16_bf16 v[128:143], v[44:47], v[120:123], v[128:143]
    s_cbranch_vccnz rty_131
bk_132:
    s_lshl_b32 s98, s2, 13
    s_add_u32 s98, s98, 0x1601000
    buffer_store_dwordx4 v[28:31], v27, s[32:35], s98 offen sc1
    s_lshl_b32 s98, s2, 13
    s_add_u32 s98, s98, 0xe00000
    buffer_store_dwordx4 v[28:31], v27, s[32:35], s98 offen sc1
    s_waitcnt lgkmcnt(0)
    v_mfma_f32_32x32x16_bf16 v[144:159], v[48:51], v[100:103], v[144:159]
    ds_read_b64_tr_b16 v[112:113], v4 offset:28672
    ds_read_b64_tr_b16 v[114:115], v4 offset:29696
    ds_read_b64_tr_b16 v[116:117], v5 offset:28672
    v_mfma_f32_32x32x16_bf16 v[128:143], v[48:51], v[96:99], v[128:143]
    ds_read_b64_tr_b16 v[118:119], v5 offset:29696
    ds_read_b64_tr_b16 v[120:121], v4 offset:30720
    ds_read_b64_tr_b16 v[122:123], v4 offset:31744
    s_waitcnt vmcnt(9)
    v_max3_u32 v8, v56, v57, v58
    v_max3_u32 v9, v59, v60, v61
    v_mfma_f32_32x32x16_bf16 v[144:159], v[52:55], v[108:111], v[144:159]
    ds_read_b64_tr_b16 v[124:125], v5 offset:30720
    ds_read_b64_tr_b16 v[126:127], v5 offset:31744
    v_max3_u32 v8, v8, v62, v63
    v_max_u32 v8, v8, v9
    v_cmp_eq_u32 vcc, -1, v8
    v_mfma_f32_32x32x16_bf16 v[128:143], v[52:55], v[104:107], v[128:143]
    s_cbranch_vccnz rty_133
bk_134:
    s_lshl_b32 s98, s2, 13
    s_add_u32 s98, s98, 0xe01000
    buffer_store_dwordx4 v[28:31], v27, s[32:35], s98 offen sc1
    s_waitcnt lgkmcnt(0)
    v_mfma_f32_32x32x16_bf16 v[144:159], v[56:59], v[116:119], v[144:159]
    v_mfma_f32_32x32x16_bf16 v[128:143], v[56:59], v[112:115], v[128:143]
    v_mfma_f32_32x32x16_bf16 v[144:159], v[60:63], v[124:127], v[144:159]
    v_mfma_f32_32x32x16_bf16 v[128:143], v[60:63], v[120:123], v[128:143]
    s_nop 10
    ds_write_b128 v12, v[144:147] offset:2048
    ds_write_b128 v12, v[148:151] offset:3072
    ds_write_b128 v13, v[152:155] offset:4096
    ds_write_b128 v13, v[156:159] offset:5120
    ds_write_b128 v11, v[136:139] offset:0
    ds_write_b128 v11, v[140:143] offset:1024
    s_waitcnt lgkmcnt(0)
    s_waitcnt vmcnt(8)
xrty_136:
    v_max3_u32 v8, v16, v17, v18
    v_max3_u32 v8, v8, v19, v20
    v_max3_u32 v8, v8, v21, v22
    v_max_u32 v8, v8, v23
    v_cmp_eq_u32 vcc, -1, v8
    s_cbranch_vccz xok_135
    s_cmp_eq_u32 s55, 0
    s_cbranch_scc1 xok_135
    s_sub_u32 s55, s55, 1
    buffer_load_dwordx4 v[16:19], v24, s[32:35], s58 offen sc1
    buffer_load_dwordx4 v[20:23], v25, s[32:35], s58 offen sc1
    s_waitcnt vmcnt(0)
    s_branch xrty_136
xok_135:
    v_lshlrev_b32 v96, 16, v16
    v_and_b32 v97, 0xffff0000, v16
    v_lshlrev_b32 v98, 16, v17
    v_and_b32 v99, 0xffff0000, v17
    v_lshlrev_b32 v100, 16, v18
    v_and_b32 v101, 0xffff0000, v18
    v_lshlrev_b32 v102, 16, v19
    v_and_b32 v103, 0xffff0000, v19
    v_lshlrev_b32 v104, 16, v20
    v_and_b32 v105, 0xffff0000, v20
    v_lshlrev_b32 v106, 16, v21
    v_and_b32 v107, 0xffff0000, v21
    v_lshlrev_b32 v108, 16, v22
    v_and_b32 v109, 0xffff0000, v22
    v_lshlrev_b32 v110, 16, v23
    v_and_b32 v111, 0xffff0000, v23
    s_barrier
    ds_read_b128 v[136:139], v10 offset:0
    ds_read_b128 v[140:143], v10 offset:1024
    ds_read_b128 v[144:147], v10 offset:2048
    ds_read_b128 v[148:151], v10 offset:3072
    ds_read_b128 v[152:155], v10 offset:4096
    ds_read_b128 v[156:159], v10 offset:5120
    s_waitcnt lgkmcnt(4)
    v_pk_add_f32 v[128:129], v[128:129], v[136:137]
    v_pk_add_f32 v[130:131], v[130:131], v[138:139]
    v_pk_add_f32 v[132:133], v[132:133], v[140:141]
    v_pk_add_f32 v[134:135], v[134:135], v[142:143]
    s_waitcnt lgkmcnt(2)
    v_pk_add_f32 v[128:129], v[128:129], v[144:145]
    v_pk_add_f32 v[130:131], v[130:131], v[146:147]
    v_pk_add_f32 v[132:133], v[132:133], v[148:149]
    v_pk_add_f32 v[134:135], v[134:135], v[150:151]
    s_waitcnt lgkmcnt(0)
    v_pk_add_f32 v[128:129], v[128:129], v[152:153]
    v_pk_add_f32 v[130:131], v[130:131], v[154:155]
    v_pk_add_f32 v[132:133], v[132:133], v[156:157]
    v_pk_add_f32 v[134:135], v[134:135], v[158:159]
    v_cvt_pk_bf16_f32 v136, v128, v129
    v_cvt_pk_bf16_f32 v137, v130, v131
    v_cvt_pk_bf16_f32 v138, v132, v133
    v_cvt_pk_bf16_f32 v139, v134, v135
    v_xor_b32 v15, 64, v7
    ds_write_b64 v15, v[136:137]
    v_xor_b32 v15, 80, v7
    ds_write_b64 v15, v[138:139]
    s_mov_b32 s58, 0xc00000
    s_waitcnt lgkmcnt(0)
    s_barrier
    ds_read_b128 v[48:51], v14
    ds_read_b128 v[52:55], v14 offset:1024
    s_waitcnt lgkmcnt(1)
    v_lshlrev_b32 v32, 16, v48
    v_and_b32 v33, 0xffff0000, v48
    v_lshlrev_b32 v34, 16, v49
    v_and_b32 v35, 0xffff0000, v49
    v_lshlrev_b32 v36, 16, v50
    v_and_b32 v37, 0xffff0000, v50
    v_lshlrev_b32 v38, 16, v51
    v_and_b32 v39, 0xffff0000, v51
    v_pk_add_f32 v[96:97], v[96:97], v[32:33]
    v_pk_add_f32 v[98:99], v[98:99], v[34:35]
    v_pk_add_f32 v[100:101], v[100:101], v[36:37]
    v_pk_add_f32 v[102:103], v[102:103], v[38:39]
    v_cvt_pk_bf16_f32 v56, v96, v97
    v_cvt_pk_bf16_f32 v57, v98, v99
    v_cvt_pk_bf16_f32 v58, v100, v101
    v_cvt_pk_bf16_f32 v59, v102, v103
    buffer_store_dwordx4 v[56:59], v24, s[32:35], s58 offen sc1
    s_waitcnt lgkmcnt(0)
    v_lshlrev_b32 v40, 16, v52
    v_and_b32 v41, 0xffff0000, v52
    v_lshlrev_b32 v42, 16, v53
    v_and_b32 v43, 0xffff0000, v53
    v_lshlrev_b32 v44, 16, v54
    v_and_b32 v45, 0xffff0000, v54
    v_lshlrev_b32 v46, 16, v55
    v_and_b32 v47, 0xffff0000, v55
    v_pk_add_f32 v[104:105], v[104:105], v[40:41]
    v_pk_add_f32 v[106:107], v[106:107], v[42:43]
    v_pk_add_f32 v[108:109], v[108:109], v[44:45]
    v_pk_add_f32 v[110:111], v[110:111], v[46:47]
    v_cvt_pk_bf16_f32 v60, v104, v105
    v_cvt_pk_bf16_f32 v61, v106, v107
    v_cvt_pk_bf16_f32 v62, v108, v109
    v_cvt_pk_bf16_f32 v63, v110, v111
    buffer_store_dwordx4 v[60:63], v25, s[32:35], s58 offen sc1
bdone_137:
L_layer1:
    s_mov_b32 s36, 0x3f1f9d07
    s_mov_b32 s37, 0x3f1f9d07
    s_mov_b32 s42, 0x3f48261c
    s_mov_b32 s43, 0x3f48261c
    s_mov_b32 s38, 0xbe63dc87
    s_mov_b32 s39, 0xbe63dc87
    s_mov_b32 s44, 0x3f7994e0
    s_mov_b32 s45, 0x3f7994e0
    s_mov_b32 s40, 0xbf66a5e5
    s_mov_b32 s41, 0xbf66a5e5
    s_mov_b32 s46, 0x3ede2602
    s_mov_b32 s47, 0x3ede2602
    s_lshr_b32 s56, s48, 3
    s_and_b32 s57, s48, 7
    s_lshl_b32 s57, s57, 3
    v_lshrrev_b32 v1, 5, v0
    v_add_u32 v1, s57, v1
    v_lshlrev_b32 v1, 5, v1
    v_add_u32 v1, s56, v1
    v_mul_u32_u24 v1, 896, v1
    v_and_b32 v2, 31, v0
    v_lshl_add_u32 v1, v2, 2, v1
    v_lshrrev_b32 v55, 6, v0
    v_and_b32 v56, 15, v0
    v_lshl_add_u32 v55, v55, 4, v56
    v_bfe_u32 v56, v0, 4, 2
    v_cvt_f32_u32 v48, v55
    v_cvt_f32_u32 v49, v56
    v_mul_f32 v48, 0x3c800000, v48
    v_mul_f32 v49, 4.0, v49
    v_mul_f32 v50, 0x41500000, v48
    v_mul_f32 v49, v49, v48
    v_cos_f32 v51, v49
    v_sin_f32 v52, v49
    v_add_f32 v49, v49, v48
    v_cos_f32 v53, v49
    v_sin_f32 v54, v49
    v_add_f32 v49, v49, v48
    v_cvt_pk_bf16_f32 v96, v51, v52
    v_cvt_pk_bf16_f32 v112, -v52, v51
    v_cos_f32 v51, v49
    v_sin_f32 v52, v49
    v_add_f32 v49, v49, v48
    v_cvt_pk_bf16_f32 v97, v53, v54
    v_cvt_pk_bf16_f32 v113, -v54, v53
    v_cos_f32 v53, v49
    v_sin_f32 v54, v49
    v_add_f32 v49, v49, v50
    v_cvt_pk_bf16_f32 v98, v51, v52
    v_cvt_pk_bf16_f32 v114, -v52, v51
    v_cos_f32 v51, v49
    v_sin_f32 v52, v49
    v_add_f32 v49, v49, v48
    v_cvt_pk_bf16_f32 v99, v53, v54
    v_cvt_pk_bf16_f32 v115, -v54, v53
    v_cos_f32 v53, v49
    v_sin_f32 v54, v49
    v_add_f32 v49, v49, v48
    v_cvt_pk_bf16_f32 v100, v51, v52
    v_cvt_pk_bf16_f32 v116, -v52, v51
    v_cos_f32 v51, v49
    v_sin_f32 v52, v49
    v_add_f32 v49, v49, v48
    v_cvt_pk_bf16_f32 v101, v53, v54
    v_cvt_pk_bf16_f32 v117, -v54, v53
    v_cos_f32 v53, v49
    v_sin_f32 v54, v49
    v_add_f32 v49, v49, v50
    v_cvt_pk_bf16_f32 v102, v51, v52
    v_cvt_pk_bf16_f32 v118, -v52, v51
    v_cos_f32 v51, v49
    v_sin_f32 v52, v49
    v_add_f32 v49, v49, v48
    v_cvt_pk_bf16_f32 v103, v53, v54
    v_cvt_pk_bf16_f32 v119, -v54, v53
    v_cos_f32 v53, v49
    v_sin_f32 v54, v49
    v_add_f32 v49, v49, v48
    v_cvt_pk_bf16_f32 v104, v51, v52
    v_cvt_pk_bf16_f32 v120, -v52, v51
    v_cos_f32 v51, v49
    v_sin_f32 v52, v49
    v_add_f32 v49, v49, v48
    v_cvt_pk_bf16_f32 v105, v53, v54
    v_cvt_pk_bf16_f32 v121, -v54, v53
    v_cos_f32 v53, v49
    v_sin_f32 v54, v49
    v_add_f32 v49, v49, v50
    v_cvt_pk_bf16_f32 v106, v51, v52
    v_cvt_pk_bf16_f32 v122, -v52, v51
    v_cos_f32 v51, v49
    v_sin_f32 v52, v49
    v_add_f32 v49, v49, v48
    v_cvt_pk_bf16_f32 v107, v53, v54
    v_cvt_pk_bf16_f32 v123, -v54, v53
    v_cos_f32 v53, v49
    v_sin_f32 v54, v49
    v_add_f32 v49, v49, v48
    v_cvt_pk_bf16_f32 v108, v51, v52
    v_cvt_pk_bf16_f32 v124, -v52, v51
    v_cos_f32 v51, v49
    v_sin_f32 v52, v49
    v_add_f32 v49, v49, v48
    v_cvt_pk_bf16_f32 v109, v53, v54
    v_cvt_pk_bf16_f32 v125, -v54, v53
    v_cos_f32 v53, v49
    v_sin_f32 v54, v49
    v_cvt_pk_bf16_f32 v110, v51, v52
    v_cvt_pk_bf16_f32 v126, -v52, v51
    v_cvt_pk_bf16_f32 v111, v53, v54
    v_cvt_pk_bf16_f32 v127, -v54, v53
    v_cvt_f32_u32 v14, v2
    v_mul_f32 v14, 0x3b924925, v14
    v_add_f32 v15, 0x3b124925, v14
    v_cos_f32 v20, v14
    v_cos_f32 v21, v15
    v_sin_f32 v26, v14
    v_sin_f32 v27, v15
    v_mul_f32 v16, 0x40000000, v14
    v_mul_f32 v17, 0x40000000, v15
    v_cos_f32 v22, v16
    v_cos_f32 v23, v17
    v_sin_f32 v28, v16
    v_sin_f32 v29, v17
    v_mul_f32 v16, 0x40400000, v14
    v_mul_f32 v17, 0x40400000, v15
    v_cos_f32 v24, v16
    v_cos_f32 v25, v17
    v_sin_f32 v30, v16
    v_sin_f32 v31, v17
    v_lshrrev_b32 v3, 5, v0
    v_mul_u32_u24 v3, 272, v3
    v_lshl_add_u32 v3, v2, 3, v3
    v_add_u32 v3, 0x20000, v3
    v_bfe_u32 v13, v0, 4, 2
    v_and_b32 v12, 15, v0
    v_mul_u32_u24 v18, 272, v12
    v_lshl_add_u32 v18, v13, 4, v18
    v_add_u32 v18, 0x20000, v18
    v_lshrrev_b32 v19, 1, v13
    v_lshl_add_u32 v19, v19, 6, v12
    v_lshrrev_b32 v14, 6, v0
    v_lshl_add_u32 v19, v14, 4, v19
    v_lshlrev_b32 v19, 5, v19
    v_and_b32 v14, 1, v13
    v_lshl_add_u32 v19, v14, 4, v19
    s_barrier
    s_mov_b32 s57, 0xc00000
poll_138:
    buffer_load_dword v4, v1, s[32:35], s57 offen offset:0 sc1
    buffer_load_dword v5, v1, s[32:35], s57 offen offset:128 sc1
    buffer_load_dword v6, v1, s[32:35], s57 offen offset:256 sc1
    buffer_load_dword v7, v1, s[32:35], s57 offen offset:384 sc1
    buffer_load_dword v8, v1, s[32:35], s57 offen offset:512 sc1
    buffer_load_dword v9, v1, s[32:35], s57 offen offset:640 sc1
    buffer_load_dword v10, v1, s[32:35], s57 offen offset:768 sc1
    s_waitcnt vmcnt(0)
    v_max3_u32 v11, v4, v5, v6
    v_max3_u32 v11, v11, v7, v8
    v_max3_u32 v11, v11, v9, v10
    v_cmp_eq_u32 vcc, -1, v11
    s_cbranch_vccz pollok_139
    s_cmp_eq_u32 s55, 0
    s_cbranch_scc1 pollok_139
    s_sub_u32 s55, s55, 1
    s_mov_b64 exec, vcc
    s_sleep 2
    s_branch poll_138
pollok_139:
    s_mov_b64 exec, -1
    v_lshlrev_b32 v32, 16, v4
    v_and_b32 v33, 0xffff0000, v4
    v_lshlrev_b32 v34, 16, v5
    v_and_b32 v35, 0xffff0000, v5
    v_lshlrev_b32 v36, 16, v6
    v_and_b32 v37, 0xffff0000, v6
    v_lshlrev_b32 v38, 16, v7
    v_and_b32 v39, 0xffff0000, v7
    v_lshlrev_b32 v40, 16, v8
    v_and_b32 v41, 0xffff0000, v8
    v_lshlrev_b32 v42, 16, v9
    v_and_b32 v43, 0xffff0000, v9
    v_lshlrev_b32 v44, 16, v10
    v_and_b32 v45, 0xffff0000, v10
    v_pk_add_f32 v[48:49], v[34:35], v[44:45]
    v_pk_add_f32 v[46:47], v[32:33], v[34:35]
    v_pk_mul_f32 v[60:61], v[32:33], v[32:33]
    v_pk_add_f32 v[54:55], v[34:35], v[44:45] neg_lo:[0,1] neg_hi:[0,1]
    v_pk_add_f32 v[50:51], v[36:37], v[42:43]
    v_pk_add_f32 v[46:47], v[46:47], v[36:37]
    v_pk_fma_f32 v[60:61], v[34:35], v[34:35], v[60:61]
    v_pk_add_f32 v[56:57], v[36:37], v[42:43] neg_lo:[0,1] neg_hi:[0,1]
    v_pk_add_f32 v[52:53], v[38:39], v[40:41]
    v_pk_add_f32 v[58:59], v[38:39], v[40:41] neg_lo:[0,1] neg_hi:[0,1]
    v_pk_add_f32 v[46:47], v[46:47], v[38:39]
    v_pk_fma_f32 v[60:61], v[36:37], v[36:37], v[60:61]
    v_pk_fma_f32 v[80:81], v[48:49], s[36:37], v[32:33]
    v_pk_fma_f32 v[80:81], v[50:51], s[38:39], v[80:81]
    v_pk_fma_f32 v[60:61], v[38:39], v[38:39], v[60:61]
    v_pk_fma_f32 v[80:81], v[52:53], s[40:41], v[80:81]
    v_pk_add_f32 v[46:47], v[46:47], v[40:41]
    v_pk_mul_f32 v[82:83], v[54:55], s[42:43]
    v_pk_fma_f32 v[82:83], v[56:57], s[44:45], v[82:83]
    v_pk_fma_f32 v[60:61], v[40:41], v[40:41], v[60:61]
    v_pk_fma_f32 v[82:83], v[58:59], s[46:47], v[82:83]
    v_pk_add_f32 v[46:47], v[46:47], v[42:43]
    v_pk_mul_f32 v[64:65], v[82:83], v[26:27]
    v_pk_mul_f32 v[70:71], v[82:83], v[20:21]
    v_pk_add_f32 v[46:47], v[46:47], v[44:45]
    v_pk_fma_f32 v[60:61], v[42:43], v[42:43], v[60:61]
    v_pk_fma_f32 v[64:65], v[80:81], v[20:21], v[64:65] neg_lo:[0,0,1] neg_hi:[0,0,1]
    v_pk_fma_f32 v[70:71], v[80:81], v[26:27], v[70:71]
    v_pk_fma_f32 v[60:61], v[44:45], v[44:45], v[60:61]
    v_pk_fma_f32 v[76:77], v[48:49], s[38:39], v[32:33]
    v_add_f32 v46, v46, v47
    v_pk_fma_f32 v[76:77], v[50:51], s[40:41], v[76:77]
    v_pk_fma_f32 v[76:77], v[52:53], s[36:37], v[76:77]
    v_add_f32 v60, v60, v61
    v_pk_mul_f32 v[78:79], v[54:55], s[44:45]
    v_add_f32_dpp v46, v46, v46 quad_perm:[1,0,3,2] row_mask:0xf bank_mask:0xf
    v_pk_fma_f32 v[78:79], v[56:57], s[46:47], v[78:79] neg_lo:[1,0,0] neg_hi:[1,0,0]
    v_add_f32_dpp v60, v60, v60 quad_perm:[1,0,3,2] row_mask:0xf bank_mask:0xf
    v_pk_fma_f32 v[78:79], v[58:59], s[42:43], v[78:79] neg_lo:[1,0,0] neg_hi:[1,0,0]
    v_pk_mul_f32 v[66:67], v[78:79], v[28:29]
    v_add_f32_dpp v46, v46, v46 quad_perm:[2,3,0,1] row_mask:0xf bank_mask:0xf
    v_pk_mul_f32 v[72:73], v[78:79], v[22:23]
    v_add_f32_dpp v60, v60, v60 quad_perm:[2,3,0,1] row_mask:0xf bank_mask:0xf
    v_pk_fma_f32 v[66:67], v[76:77], v[22:23], v[66:67] neg_lo:[0,0,1] neg_hi:[0,0,1]
    v_pk_fma_f32 v[72:73], v[76:77], v[28:29], v[72:73]
    v_add_f32_dpp v46, v46, v46 row_half_mirror row_mask:0xf bank_mask:0xf
    v_pk_fma_f32 v[80:81], v[48:49], s[40:41], v[32:33]
    v_add_f32_dpp v60, v60, v60 row_half_mirror row_mask:0xf bank_mask:0xf
    v_pk_fma_f32 v[80:81], v[50:51], s[36:37], v[80:81]
    v_add_f32_dpp v46, v46, v46 row_mirror row_mask:0xf bank_mask:0xf
    v_pk_fma_f32 v[80:81], v[52:53], s[38:39], v[80:81]
    v_add_f32_dpp v60, v60, v60 row_mirror row_mask:0xf bank_mask:0xf
    v_pk_mul_f32 v[82:83], v[54:55], s[46:47]
    v_pk_fma_f32 v[82:83], v[56:57], s[42:43], v[82:83] neg_lo:[1,0,0] neg_hi:[1,0,0]
    v_mov_b32 v4, v46
    v_pk_fma_f32 v[82:83], v[58:59], s[44:45], v[82:83]
    v_mov_b32 v5, v60
    v_pk_mul_f32 v[68:69], v[82:83], v[30:31]
    v_pk_mul_f32 v[74:75], v[82:83], v[24:25]
    v_permlane16_swap_b32 v46, v4
    v_permlane16_swap_b32 v60, v5
    v_pk_fma_f32 v[68:69], v[80:81], v[24:25], v[68:69] neg_lo:[0,0,1] neg_hi:[0,0,1]
    v_pk_fma_f32 v[74:75], v[80:81], v[30:31], v[74:75]
    v_pk_add_f32 v[6:7], v[32:33], v[48:49]
    v_add_f32 v46, v46, v4
    v_add_f32 v60, v60, v5
    v_pk_add_f32 v[8:9], v[50:51], v[52:53]
    v_pk_add_f32 v[6:7], v[6:7], v[8:9]
    v_mul_f32 v46, 0x3b124925, v46
    v_mul_f32 v60, 0x3b124925, v60
    v_fma_f32 v60, -v46, v46, v60
    v_max_f32 v60, 0, v60
    v_add_f32 v60, 0x3727c5ac, v60
    v_rsq_f32 v60, v60
    v_mul_f32 v46, 0xc0e00000, v46
    v_mul_f32 v60, 0x35924925, v60
    v_pk_add_f32 v[6:7], v[6:7], v[46:47] op_sel_hi:[1,0]
    v_pk_mul_f32 v[64:65], v[64:65], v[60:61] op_sel_hi:[1,0]
    v_pk_mul_f32 v[66:67], v[66:67], v[60:61] op_sel_hi:[1,0]
    v_pk_mul_f32 v[68:69], v[68:69], v[60:61] op_sel_hi:[1,0]
    v_pk_mul_f32 v[70:71], v[70:71], v[60:61] op_sel_hi:[1,0]
    v_pk_mul_f32 v[72:73], v[72:73], v[60:61] op_sel_hi:[1,0]
    v_pk_mul_f32 v[74:75], v[74:75], v[60:61] op_sel_hi:[1,0]
    v_pk_mul_f32 v[6:7], v[6:7], v[60:61] op_sel_hi:[1,0]
    v_cvt_pk_bf16_f32 v34, v64, -v70
    v_cvt_pk_bf16_f32 v35, v65, -v71
    ds_write_b64 v3, v[34:35] offset:2176
    v_cvt_pk_bf16_f32 v36, v66, -v72
    v_cvt_pk_bf16_f32 v37, v67, -v73
    ds_write_b64 v3, v[36:37] offset:4352
    v_cvt_pk_bf16_f32 v38, v68, -v74
    v_cvt_pk_bf16_f32 v39, v69, -v75
    ds_write_b64 v3, v[38:39] offset:6528
    v_cvt_pk_bf16_f32 v32, v6, 0
    v_cvt_pk_bf16_f32 v33, v7, 0
    ds_write_b64 v3, v[32:33]
    s_lshl_b32 s56, s48, 13
    s_add_u32 s56, s56, 0x200000
    s_add_u32 s57, s56, 4096
    s_waitcnt lgkmcnt(0)
    s_barrier
    ds_read_b128 v[64:67], v18 offset:0
    ds_read_b128 v[68:71], v18 offset:64
    ds_read_b128 v[72:75], v18 offset:128
    ds_read_b128 v[76:79], v18 offset:192
    ds_read_b128 v[80:83], v18 offset:4352
    ds_read_b128 v[84:87], v18 offset:4416
    ds_read_b128 v[88:91], v18 offset:4480
    ds_read_b128 v[92:95], v18 offset:4544
    s_waitcnt lgkmcnt(7)
    v_mfma_f32_16x16x32_bf16 v[32:35], v[64:67], v[96:99], 0
    v_mfma_f32_16x16x32_bf16 v[40:43], v[64:67], v[112:115], 0
    s_waitcnt lgkmcnt(6)
    v_mfma_f32_16x16x32_bf16 v[32:35], v[68:71], v[100:103], v[32:35]
    v_mfma_f32_16x16x32_bf16 v[40:43], v[68:71], v[116:119], v[40:43]
    s_waitcnt lgkmcnt(5)
    v_mfma_f32_16x16x32_bf16 v[32:35], v[72:75], v[104:107], v[32:35]
    v_mfma_f32_16x16x32_bf16 v[40:43], v[72:75], v[120:123], v[40:43]
    s_waitcnt lgkmcnt(4)
    v_mfma_f32_16x16x32_bf16 v[32:35], v[76:79], v[108:111], v[32:35]
    v_mfma_f32_16x16x32_bf16 v[40:43], v[76:79], v[124:127], v[40:43]
    s_waitcnt lgkmcnt(3)
    v_mfma_f32_16x16x32_bf16 v[36:39], v[80:83], v[96:99], 0
    v_mfma_f32_16x16x32_bf16 v[44:47], v[80:83], v[112:115], 0
    s_waitcnt lgkmcnt(2)
    v_mfma_f32_16x16x32_bf16 v[36:39], v[84:87], v[100:103], v[36:39]
    v_mfma_f32_16x16x32_bf16 v[44:47], v[84:87], v[116:119], v[44:47]
    s_waitcnt lgkmcnt(1)
    v_mfma_f32_16x16x32_bf16 v[36:39], v[88:91], v[104:107], v[36:39]
    v_mfma_f32_16x16x32_bf16 v[44:47], v[88:91], v[120:123], v[44:47]
    v_cvt_pk_bf16_f32 v48, v32, v40
    v_cvt_pk_bf16_f32 v49, v33, v41
    v_cvt_pk_bf16_f32 v50, v34, v42
    v_cvt_pk_bf16_f32 v51, v35, v43
    buffer_store_dwordx4 v[48:51], v19, s[32:35], s56 offen sc1
    s_waitcnt lgkmcnt(0)
    v_mfma_f32_16x16x32_bf16 v[36:39], v[92:95], v[108:111], v[36:39]
    v_mfma_f32_16x16x32_bf16 v[44:47], v[92:95], v[124:127], v[44:47]
    s_nop 7
    v_cvt_pk_bf16_f32 v52, v36, v44
    v_cvt_pk_bf16_f32 v53, v37, v45
    v_cvt_pk_bf16_f32 v54, v38, v46
    v_cvt_pk_bf16_f32 v55, v39, v47
    buffer_store_dwordx4 v[52:55], v19, s[32:35], s57 offen sc1
    v_and_b32 v2, 15, v0
    v_bfe_u32 v3, v0, 4, 2
    v_lshrrev_b32 v4, 6, v0
    v_lshrrev_b32 v5, 1, v4
    v_lshl_add_u32 v5, v5, 4, v2
    v_lshlrev_b32 v5, 3, v5
    v_and_b32 v6, 1, v4
    v_lshl_add_u32 v5, v6, 2, v5
    v_lshrrev_b32 v6, 1, v3
    v_add_u32 v5, v5, v6
    v_lshlrev_b32 v5, 13, v5
    v_and_b32 v7, 1, v3
    v_lshl_add_u32 v5, v7, 4, v5
    v_lshl_add_u32 v56, v4, 4, v2
    v_lshl_add_u32 v6, v56, 2, v6
    v_lshlrev_b32 v6, 13, v6
    v_lshl_add_u32 v7, v7, 4, v6
    v_lshlrev_b32 v6, 8, v2
    v_lshl_add_u32 v6, v4, 6, v6
    v_lshl_add_u32 v6, v3, 4, v6
    s_lshl_b32 s58, s2, 13
    s_add_u32 s58, s58, 0x1800000
    s_add_u32 s59, s58, 4096
    v_lshlrev_b32 v57, 4, v0
    s_lshr_b32 s58, s48, 6
    s_lshl_b32 s58, s58, 11
    s_and_b32 s59, s48, 63
    s_lshl_b32 s59, s59, 5
    s_add_u32 s58, s58, s59
    s_add_u32 s58, s58, 0x800000
    s_add_u32 s59, s58, 16384
    buffer_load_dwordx4 v[8:11], v7, s[32:35], s58 offen sc1
    buffer_load_dwordx4 v[12:15], v7, s[32:35], s59 offen sc1
    v_cvt_f32_u32 v57, v56
    v_cvt_f32_u32 v58, v3
    v_mul_f32 v57, 0x3a000000, v57
    v_mul_f32 v58, 4.0, v58
    v_mul_f32 v59, 0x41500000, v57
    v_mul_f32 v58, v58, v57
    v_cos_f32 v60, v58
    v_sin_f32 v61, v58
    v_add_f32 v58, v58, v57
    v_cvt_pk_f16_f32 v16, v60, -v61
    v_cos_f32 v60, v58
    v_sin_f32 v61, v58
    v_add_f32 v58, v58, v57
    v_cvt_pk_f16_f32 v17, v60, -v61
    v_cos_f32 v60, v58
    v_sin_f32 v61, v58
    v_add_f32 v58, v58, v57
    v_cvt_pk_f16_f32 v18, v60, -v61
    v_cos_f32 v60, v58
    v_sin_f32 v61, v58
    v_add_f32 v58, v58, v59
    v_cvt_pk_f16_f32 v19, v60, -v61
    v_cos_f32 v60, v58
    v_sin_f32 v61, v58
    v_add_f32 v58, v58, v57
    v_cvt_pk_f16_f32 v20, v60, -v61
    v_cos_f32 v60, v58
    v_sin_f32 v61, v58
    v_add_f32 v58, v58, v57
    v_cvt_pk_f16_f32 v21, v60, -v61
    v_cos_f32 v60, v58
    v_sin_f32 v61, v58
    v_add_f32 v58, v58, v57
    v_cvt_pk_f16_f32 v22, v60, -v61
    v_cos_f32 v60, v58
    v_sin_f32 v61, v58
    s_nop 0
    v_cvt_pk_f16_f32 v23, v60, -v61
    v_lshlrev_b32 v56, 4, v4
    v_lshl_add_u32 v56, v3, 2, v56
    v_cvt_f32_u32 v56, v56
    v_add_u32 v47, 16, v2
    v_cvt_f32_u32 v57, v2
    v_mul_f32 v57, 0x3a000000, v57
    v_mul_f32 v58, v56, v57
    v_cos_f32 v60, v58
    v_sin_f32 v61, v58
    v_add_f32 v58, v58, v57
    v_cvt_pk_f16_f32 v24, v60, v61
    v_cos_f32 v60, v58
    v_sin_f32 v61, v58
    v_add_f32 v58, v58, v57
    v_cvt_pk_f16_f32 v25, v60, v61
    v_cos_f32 v60, v58
    v_sin_f32 v61, v58
    v_add_f32 v58, v58, v57
    v_cvt_pk_f16_f32 v26, v60, v61
    v_cos_f32 v60, v58
    v_sin_f32 v61, v58
    s_nop 0
    v_cvt_pk_f16_f32 v27, v60, v61
    v_cvt_f32_u32 v57, v47
    v_mul_f32 v57, 0x3a000000, v57
    v_mul_f32 v58, v56, v57
    v_cos_f32 v60, v58
    v_sin_f32 v61, v58
    v_add_f32 v58, v58, v57
    v_cvt_pk_f16_f32 v28, v60, v61
    v_cos_f32 v60, v58
    v_sin_f32 v61, v58
    v_add_f32 v58, v58, v57
    v_cvt_pk_f16_f32 v29, v60, v61
    v_cos_f32 v60, v58
    v_sin_f32 v61, v58
    v_add_f32 v58, v58, v57
    v_cvt_pk_f16_f32 v30, v60, v61
    v_cos_f32 v60, v58
    v_sin_f32 v61, v58
    s_nop 0
    v_cvt_pk_f16_f32 v31, v60, v61
    v_and_b32 v55, 15, v0
    v_bfe_u32 v56, v0, 4, 2
    v_add_u32 v57, 16, v55
    v_cvt_f32_u32 v48, v55
    v_cvt_f32_u32 v49, v56
    v_mul_f32 v48, 0x3d000000, v48
    v_mul_f32 v49, 4.0, v49
    v_mul_f32 v50, 0x41500000, v48
    v_mul_f32 v49, v49, v48
    v_cos_f32 v51, v49
    v_sin_f32 v52, v49
    v_add_f32 v49, v49, v48
    v_cos_f32 v53, v49
    v_sin_f32 v54, v49
    v_add_f32 v49, v49, v48
    v_cvt_pk_bf16_f32 v128, v51, v52
    v_cvt_pk_bf16_f32 v144, -v52, v51
    v_cos_f32 v51, v49
    v_sin_f32 v52, v49
    v_add_f32 v49, v49, v48
    v_cvt_pk_bf16_f32 v129, v53, v54
    v_cvt_pk_bf16_f32 v145, -v54, v53
    v_cos_f32 v53, v49
    v_sin_f32 v54, v49
    v_add_f32 v49, v49, v50
    v_cvt_pk_bf16_f32 v130, v51, v52
    v_cvt_pk_bf16_f32 v146, -v52, v51
    v_cos_f32 v51, v49
    v_sin_f32 v52, v49
    v_add_f32 v49, v49, v48
    v_cvt_pk_bf16_f32 v131, v53, v54
    v_cvt_pk_bf16_f32 v147, -v54, v53
    v_cos_f32 v53, v49
    v_sin_f32 v54, v49
    v_add_f32 v49, v49, v48
    v_cvt_pk_bf16_f32 v132, v51, v52
    v_cvt_pk_bf16_f32 v148, -v52, v51
    v_cos_f32 v51, v49
    v_sin_f32 v52, v49
    v_add_f32 v49, v49, v48
    v_cvt_pk_bf16_f32 v133, v53, v54
    v_cvt_pk_bf16_f32 v149, -v54, v53
    v_cos_f32 v53, v49
    v_sin_f32 v54, v49
    v_cvt_pk_bf16_f32 v134, v51, v52
    v_cvt_pk_bf16_f32 v150, -v52, v51
    v_cvt_pk_bf16_f32 v135, v53, v54
    v_cvt_pk_bf16_f32 v151, -v54, v53
    v_cvt_f32_u32 v48, v57
    v_cvt_f32_u32 v49, v56
    v_mul_f32 v48, 0x3d000000, v48
    v_mul_f32 v49, 4.0, v49
    v_mul_f32 v50, 0x41500000, v48
    v_mul_f32 v49, v49, v48
    v_cos_f32 v51, v49
    v_sin_f32 v52, v49
    v_add_f32 v49, v49, v48
    v_cos_f32 v53, v49
    v_sin_f32 v54, v49
    v_add_f32 v49, v49, v48
    v_cvt_pk_bf16_f32 v136, v51, v52
    v_cvt_pk_bf16_f32 v152, -v52, v51
    v_cos_f32 v51, v49
    v_sin_f32 v52, v49
    v_add_f32 v49, v49, v48
    v_cvt_pk_bf16_f32 v137, v53, v54
    v_cvt_pk_bf16_f32 v153, -v54, v53
    v_cos_f32 v53, v49
    v_sin_f32 v54, v49
    v_add_f32 v49, v49, v50
    v_cvt_pk_bf16_f32 v138, v51, v52
    v_cvt_pk_bf16_f32 v154, -v52, v51
    v_cos_f32 v51, v49
    v_sin_f32 v52, v49
    v_add_f32 v49, v49, v48
    v_cvt_pk_bf16_f32 v139, v53, v54
    v_cvt_pk_bf16_f32 v155, -v54, v53
    v_cos_f32 v53, v49
    v_sin_f32 v54, v49
    v_add_f32 v49, v49, v48
    v_cvt_pk_bf16_f32 v140, v51, v52
    v_cvt_pk_bf16_f32 v156, -v52, v51
    v_cos_f32 v51, v49
    v_sin_f32 v52, v49
    v_add_f32 v49, v49, v48
    v_cvt_pk_bf16_f32 v141, v53, v54
    v_cvt_pk_bf16_f32 v157, -v54, v53
    v_cos_f32 v53, v49
    v_sin_f32 v54, v49
    v_cvt_pk_bf16_f32 v142, v51, v52
    v_cvt_pk_bf16_f32 v158, -v52, v51
    v_cvt_pk_bf16_f32 v143, v53, v54
    v_cvt_pk_bf16_f32 v159, -v54, v53
    s_barrier
    s_lshl_b32 s56, s48, 5
    s_add_u32 s56, s56, 0x200000
    s_add_u32 s57, s56, 16384
    v_lshlrev_b32 v62, 4, v0
    v_lshl_add_u32 v62, v4, 10, v62
    v_add_u32 v62, 0x20000, v62
    v_and_b32 v63, 63, v0
    v_lshlrev_b32 v63, 4, v63
    v_add_u32 v63, 0x20000, v63
poll_140:
    buffer_load_dwordx4 v[32:35], v5, s[32:35], s56 offen sc1
    buffer_load_dwordx4 v[36:39], v5, s[32:35], s57 offen sc1
    s_waitcnt vmcnt(0)
    v_max3_u32 v40, v32, v33, v34
    v_max3_u32 v40, v40, v35, v36
    v_max3_u32 v40, v40, v37, v38
    v_max_u32 v40, v40, v39
    v_cmp_eq_u32 vcc, -1, v40
    s_cbranch_vccz pollok_141
    s_cmp_eq_u32 s55, 0
    s_cbranch_scc1 pollok_141
    s_sub_u32 s55, s55, 1
    s_mov_b64 exec, vcc
    s_sleep 2
    s_branch poll_140
pollok_141:
    s_mov_b64 exec, -1
    ds_write_b128 v62, v[32:35]
    ds_write_b128 v62, v[36:39] offset:1024
    s_waitcnt lgkmcnt(0)
    s_barrier
    ds_read_b128 v[64:67], v63 offset:0
    ds_read_b128 v[68:71], v63 offset:1024
    ds_read_b128 v[72:75], v63 offset:2048
    ds_read_b128 v[76:79], v63 offset:3072
    ds_read_b128 v[80:83], v63 offset:4096
    ds_read_b128 v[84:87], v63 offset:5120
    ds_read_b128 v[88:91], v63 offset:6144
    ds_read_b128 v[92:95], v63 offset:7168
    s_waitcnt lgkmcnt(7)
    v_mfma_f32_16x16x32_bf16 v[32:35], v[64:67], v[96:99], 0
    v_mfma_f32_16x16x32_bf16 v[40:43], v[64:67], v[112:115], 0
    s_waitcnt lgkmcnt(6)
    v_mfma_f32_16x16x32_bf16 v[32:35], v[68:71], v[100:103], v[32:35]
    v_mfma_f32_16x16x32_bf16 v[40:43], v[68:71], v[116:119], v[40:43]
    s_waitcnt lgkmcnt(5)
    v_mfma_f32_16x16x32_bf16 v[32:35], v[72:75], v[104:107], v[32:35]
    v_mfma_f32_16x16x32_bf16 v[40:43], v[72:75], v[120:123], v[40:43]
    s_waitcnt lgkmcnt(4)
    v_mfma_f32_16x16x32_bf16 v[32:35], v[76:79], v[108:111], v[32:35]
    v_mfma_f32_16x16x32_bf16 v[40:43], v[76:79], v[124:127], v[40:43]
    s_waitcnt lgkmcnt(3)
    v_mfma_f32_16x16x32_bf16 v[36:39], v[80:83], v[96:99], 0
    v_mfma_f32_16x16x32_bf16 v[44:47], v[80:83], v[112:115], 0
    s_waitcnt lgkmcnt(2)
    v_mfma_f32_16x16x32_bf16 v[36:39], v[84:87], v[100:103], v[36:39]
    s_nop 2
    v_fma_mix_f32 v56, v40, v16, 0 op_sel:[0,1,0] op_sel_hi:[0,1,0]
    v_fma_mix_f32 v57, v40, v16, 0 op_sel:[0,0,0] op_sel_hi:[0,1,0]
    s_nop 0
    v_fma_mix_f32 v40, v32, v16, v57 op_sel:[0,1,0] op_sel_hi:[0,1,0]
    v_mfma_f32_16x16x32_bf16 v[44:47], v[84:87], v[116:119], v[44:47]
    v_fma_mix_f32 v32, v32, v16, -v56 op_sel:[0,0,0] op_sel_hi:[0,1,0]
    s_nop 0
    v_cvt_pk_bf16_f32 v48, v32, v40
    v_fma_mix_f32 v58, v41, v17, 0 op_sel:[0,1,0] op_sel_hi:[0,1,0]
    s_waitcnt lgkmcnt(1)
    v_mfma_f32_16x16x32_bf16 v[36:39], v[88:91], v[104:107], v[36:39]
    v_fma_mix_f32 v59, v41, v17, 0 op_sel:[0,0,0] op_sel_hi:[0,1,0]
    s_nop 0
    v_fma_mix_f32 v41, v33, v17, v59 op_sel:[0,1,0] op_sel_hi:[0,1,0]
    v_fma_mix_f32 v33, v33, v17, -v58 op_sel:[0,0,0] op_sel_hi:[0,1,0]
    s_nop 0
    v_cvt_pk_bf16_f32 v49, v33, v41
    v_mfma_f32_16x16x32_bf16 v[44:47], v[88:91], v[120:123], v[44:47]
    v_fma_mix_f32 v56, v42, v18, 0 op_sel:[0,1,0] op_sel_hi:[0,1,0]
    v_fma_mix_f32 v57, v42, v18, 0 op_sel:[0,0,0] op_sel_hi:[0,1,0]
    s_nop 0
    v_fma_mix_f32 v42, v34, v18, v57 op_sel:[0,1,0] op_sel_hi:[0,1,0]
    s_waitcnt lgkmcnt(0)
    v_mfma_f32_16x16x32_bf16 v[36:39], v[92:95], v[108:111], v[36:39]
    v_fma_mix_f32 v34, v34, v18, -v56 op_sel:[0,0,0] op_sel_hi:[0,1,0]
    s_nop 0
    v_cvt_pk_bf16_f32 v50, v34, v42
    v_fma_mix_f32 v58, v43, v19, 0 op_sel:[0,1,0] op_sel_hi:[0,1,0]
    v_mfma_f32_16x16x32_bf16 v[44:47], v[92:95], v[124:127], v[44:47]
    v_fma_mix_f32 v59, v43, v19, 0 op_sel:[0,0,0] op_sel_hi:[0,1,0]
    s_nop 0
    v_fma_mix_f32 v43, v35, v19, v59 op_sel:[0,1,0] op_sel_hi:[0,1,0]
    v_fma_mix_f32 v35, v35, v19, -v58 op_sel:[0,0,0] op_sel_hi:[0,1,0]
    s_nop 0
    v_cvt_pk_bf16_f32 v51, v35, v43
    s_nop 1
    v_mfma_f32_16x16x32_bf16 v[64:67], v[128:131], v[48:51], 0
    v_fma_mix_f32 v56, v44, v20, 0 op_sel:[0,1,0] op_sel_hi:[0,1,0]
    v_fma_mix_f32 v57, v44, v20, 0 op_sel:[0,0,0] op_sel_hi:[0,1,0]
    s_nop 0
    v_fma_mix_f32 v44, v36, v20, v57 op_sel:[0,1,0] op_sel_hi:[0,1,0]
    v_fma_mix_f32 v36, v36, v20, -v56 op_sel:[0,0,0] op_sel_hi:[0,1,0]
    s_nop 0
    v_cvt_pk_bf16_f32 v52, v36, v44
    v_mfma_f32_16x16x32_bf16 v[72:75], v[144:147], v[48:51], 0
    v_fma_mix_f32 v58, v45, v21, 0 op_sel:[0,1,0] op_sel_hi:[0,1,0]
    v_fma_mix_f32 v59, v45, v21, 0 op_sel:[0,0,0] op_sel_hi:[0,1,0]
    s_nop 0
    v_fma_mix_f32 v45, v37, v21, v59 op_sel:[0,1,0] op_sel_hi:[0,1,0]
    v_fma_mix_f32 v37, v37, v21, -v58 op_sel:[0,0,0] op_sel_hi:[0,1,0]
    s_nop 0
    v_cvt_pk_bf16_f32 v53, v37, v45
    v_mfma_f32_16x16x32_bf16 v[68:71], v[136:139], v[48:51], 0
    v_fma_mix_f32 v56, v46, v22, 0 op_sel:[0,1,0] op_sel_hi:[0,1,0]
    v_fma_mix_f32 v57, v46, v22, 0 op_sel:[0,0,0] op_sel_hi:[0,1,0]
    s_nop 0
    v_fma_mix_f32 v46, v38, v22, v57 op_sel:[0,1,0] op_sel_hi:[0,1,0]
    v_fma_mix_f32 v38, v38, v22, -v56 op_sel:[0,0,0] op_sel_hi:[0,1,0]
    s_nop 0
    v_cvt_pk_bf16_f32 v54, v38, v46
    v_mfma_f32_16x16x32_bf16 v[76:79], v[152:155], v[48:51], 0
    v_fma_mix_f32 v58, v47, v23, 0 op_sel:[0,1,0] op_sel_hi:[0,1,0]
    v_fma_mix_f32 v59, v47, v23, 0 op_sel:[0,0,0] op_sel_hi:[0,1,0]
    s_nop 0
    v_fma_mix_f32 v47, v39, v23, v59 op_sel:[0,1,0] op_sel_hi:[0,1,0]
    v_fma_mix_f32 v39, v39, v23, -v58 op_sel:[0,0,0] op_sel_hi:[0,1,0]
    s_nop 0
    v_cvt_pk_bf16_f32 v55, v39, v47
    s_waitcnt vmcnt(2)
    s_nop 0
    v_mfma_f32_16x16x32_bf16 v[64:67], v[132:135], v[52:55], v[64:67]
    v_lshlrev_b32 v80, 16, v8
    v_and_b32 v88, 0xffff0000, v8
    v_lshlrev_b32 v81, 16, v9
    v_and_b32 v89, 0xffff0000, v9
    v_mfma_f32_16x16x32_bf16 v[72:75], v[148:151], v[52:55], v[72:75]
    v_lshlrev_b32 v82, 16, v10
    v_and_b32 v90, 0xffff0000, v10
    v_lshlrev_b32 v83, 16, v11
    v_and_b32 v91, 0xffff0000, v11
    v_mfma_f32_16x16x32_bf16 v[68:71], v[140:143], v[52:55], v[68:71]
    v_lshlrev_b32 v84, 16, v12
    v_and_b32 v92, 0xffff0000, v12
    v_lshlrev_b32 v85, 16, v13
    v_and_b32 v93, 0xffff0000, v13
    v_mfma_f32_16x16x32_bf16 v[76:79], v[156:159], v[52:55], v[76:79]
    v_lshlrev_b32 v86, 16, v14
    v_and_b32 v94, 0xffff0000, v14
    v_lshlrev_b32 v87, 16, v15
    v_and_b32 v95, 0xffff0000, v15
    v_pk_mul_f32 v[56:57], v[72:73], v[88:89]
    v_pk_mul_f32 v[58:59], v[72:73], v[80:81]
    v_pk_fma_f32 v[56:57], v[64:65], v[80:81], v[56:57] neg_lo:[0,0,1] neg_hi:[0,0,1]
    v_pk_fma_f32 v[58:59], v[64:65], v[88:89], v[58:59]
    v_cvt_pk_bf16_f32 v48, v58, v56
    v_cvt_pk_bf16_f32 v49, v59, v57
    v_pk_mul_f32 v[56:57], v[74:75], v[90:91]
    v_pk_mul_f32 v[58:59], v[74:75], v[82:83]
    v_pk_fma_f32 v[56:57], v[66:67], v[82:83], v[56:57] neg_lo:[0,0,1] neg_hi:[0,0,1]
    v_pk_fma_f32 v[58:59], v[66:67], v[90:91], v[58:59]
    v_cvt_pk_bf16_f32 v50, v58, v56
    v_cvt_pk_bf16_f32 v51, v59, v57
    s_nop 1
    v_mfma_f32_16x16x32_bf16 v[40:43], v[48:51], v[128:131], 0
    v_pk_mul_f32 v[56:57], v[76:77], v[92:93]
    v_pk_mul_f32 v[58:59], v[76:77], v[84:85]
    v_pk_fma_f32 v[56:57], v[68:69], v[84:85], v[56:57] neg_lo:[0,0,1] neg_hi:[0,0,1]
    v_mfma_f32_16x16x32_bf16 v[32:35], v[48:51], v[144:147], 0
    v_pk_fma_f32 v[58:59], v[68:69], v[92:93], v[58:59]
    v_cvt_pk_bf16_f32 v52, v58, v56
    v_cvt_pk_bf16_f32 v53, v59, v57
    v_mfma_f32_16x16x32_bf16 v[44:47], v[48:51], v[136:139], 0
    v_pk_mul_f32 v[56:57], v[78:79], v[94:95]
    v_pk_mul_f32 v[58:59], v[78:79], v[86:87]
    v_pk_fma_f32 v[56:57], v[70:71], v[86:87], v[56:57] neg_lo:[0,0,1] neg_hi:[0,0,1]
    v_mfma_f32_16x16x32_bf16 v[36:39], v[48:51], v[152:155], 0
    v_pk_fma_f32 v[58:59], v[70:71], v[94:95], v[58:59]
    v_cvt_pk_bf16_f32 v54, v58, v56
    v_cvt_pk_bf16_f32 v55, v59, v57
    s_nop 1
    v_mfma_f32_16x16x32_bf16 v[40:43], v[52:55], v[132:135], v[40:43]
    v_lshlrev_b32 v62, 4, v0
    v_mfma_f32_16x16x32_bf16 v[32:35], v[52:55], v[148:151], v[32:35]
    v_add_u32 v62, 0x22000, v62
    v_mfma_f32_16x16x32_bf16 v[44:47], v[52:55], v[140:143], v[44:47]
    s_lshl_b32 s56, s48, 13
    v_mfma_f32_16x16x32_bf16 v[36:39], v[52:55], v[156:159], v[36:39]
    s_add_u32 s56, s56, 0x600000
    s_add_u32 s57, s56, 4096
    v_fma_mix_f32 v64, v40, v24, 0 op_sel:[0,1,0] op_sel_hi:[0,1,0]
    v_fma_mix_f32 v65, v40, v24, 0 op_sel:[0,0,0] op_sel_hi:[0,1,0]
    s_nop 0
    v_fma_mix_f32 v40, v32, v24, v65 op_sel:[0,1,0] op_sel_hi:[0,1,0]
    v_fma_mix_f32 v32, v32, v24, -v64 op_sel:[0,0,0] op_sel_hi:[0,1,0]
    s_nop 0
    v_cvt_pk_bf16_f32 v48, v40, v32
    v_fma_mix_f32 v66, v41, v25, 0 op_sel:[0,1,0] op_sel_hi:[0,1,0]
    v_fma_mix_f32 v67, v41, v25, 0 op_sel:[0,0,0] op_sel_hi:[0,1,0]
    s_nop 0
    v_fma_mix_f32 v41, v33, v25, v67 op_sel:[0,1,0] op_sel_hi:[0,1,0]
    v_fma_mix_f32 v33, v33, v25, -v66 op_sel:[0,0,0] op_sel_hi:[0,1,0]
    s_nop 0
    v_cvt_pk_bf16_f32 v49, v41, v33
    v_fma_mix_f32 v64, v42, v26, 0 op_sel:[0,1,0] op_sel_hi:[0,1,0]
    v_fma_mix_f32 v65, v42, v26, 0 op_sel:[0,0,0] op_sel_hi:[0,1,0]
    s_nop 0
    v_fma_mix_f32 v42, v34, v26, v65 op_sel:[0,1,0] op_sel_hi:[0,1,0]
    v_fma_mix_f32 v34, v34, v26, -v64 op_sel:[0,0,0] op_sel_hi:[0,1,0]
    s_nop 0
    v_cvt_pk_bf16_f32 v50, v42, v34
    v_fma_mix_f32 v66, v43, v27, 0 op_sel:[0,1,0] op_sel_hi:[0,1,0]
    v_fma_mix_f32 v67, v43, v27, 0 op_sel:[0,0,0] op_sel_hi:[0,1,0]
    s_nop 0
    v_fma_mix_f32 v43, v35, v27, v67 op_sel:[0,1,0] op_sel_hi:[0,1,0]
    v_fma_mix_f32 v35, v35, v27, -v66 op_sel:[0,0,0] op_sel_hi:[0,1,0]
    s_nop 0
    v_cvt_pk_bf16_f32 v51, v43, v35
    ds_write_b128 v62, v[48:51] offset:0
    v_fma_mix_f32 v64, v44, v28, 0 op_sel:[0,1,0] op_sel_hi:[0,1,0]
    v_fma_mix_f32 v65, v44, v28, 0 op_sel:[0,0,0] op_sel_hi:[0,1,0]
    s_nop 0
    v_fma_mix_f32 v44, v36, v28, v65 op_sel:[0,1,0] op_sel_hi:[0,1,0]
    v_fma_mix_f32 v36, v36, v28, -v64 op_sel:[0,0,0] op_sel_hi:[0,1,0]
    s_nop 0
    v_cvt_pk_bf16_f32 v52, v44, v36
    v_fma_mix_f32 v66, v45, v29, 0 op_sel:[0,1,0] op_sel_hi:[0,1,0]
    v_fma_mix_f32 v67, v45, v29, 0 op_sel:[0,0,0] op_sel_hi:[0,1,0]
    s_nop 0
    v_fma_mix_f32 v45, v37, v29, v67 op_sel:[0,1,0] op_sel_hi:[0,1,0]
    v_fma_mix_f32 v37, v37, v29, -v66 op_sel:[0,0,0] op_sel_hi:[0,1,0]
    s_nop 0
    v_cvt_pk_bf16_f32 v53, v45, v37
    v_fma_mix_f32 v64, v46, v30, 0 op_sel:[0,1,0] op_sel_hi:[0,1,0]
    v_fma_mix_f32 v65, v46, v30, 0 op_sel:[0,0,0] op_sel_hi:[0,1,0]
    s_nop 0
    v_fma_mix_f32 v46, v38, v30, v65 op_sel:[0,1,0] op_sel_hi:[0,1,0]
    v_fma_mix_f32 v38, v38, v30, -v64 op_sel:[0,0,0] op_sel_hi:[0,1,0]
    s_nop 0
    v_cvt_pk_bf16_f32 v54, v46, v38
    v_fma_mix_f32 v66, v47, v31, 0 op_sel:[0,1,0] op_sel_hi:[0,1,0]
    v_fma_mix_f32 v67, v47, v31, 0 op_sel:[0,0,0] op_sel_hi:[0,1,0]
    s_nop 0
    v_fma_mix_f32 v47, v39, v31, v67 op_sel:[0,1,0] op_sel_hi:[0,1,0]
    v_fma_mix_f32 v39, v39, v31, -v66 op_sel:[0,0,0] op_sel_hi:[0,1,0]
    s_nop 0
    v_cvt_pk_bf16_f32 v55, v47, v39
    ds_write_b128 v62, v[52:55] offset:4096
    s_waitcnt lgkmcnt(0)
    s_barrier
    ds_read_b128 v[64:67], v63 offset:8192
    ds_read_b128 v[68:71], v63 offset:9216
    ds_read_b128 v[72:75], v63 offset:10240
    ds_read_b128 v[76:79], v63 offset:11264
    ds_read_b128 v[80:83], v63 offset:12288
    ds_read_b128 v[84:87], v63 offset:13312
    ds_read_b128 v[88:91], v63 offset:14336
    ds_read_b128 v[92:95], v63 offset:15360
    s_waitcnt lgkmcnt(7)
    v_mfma_f32_16x16x32_bf16 v[40:43], v[96:99], v[64:67], 0
    v_mfma_f32_16x16x32_bf16 v[32:35], v[112:115], v[64:67], 0
    s_waitcnt lgkmcnt(6)
    v_mfma_f32_16x16x32_bf16 v[40:43], v[100:103], v[68:71], v[40:43]
    v_mfma_f32_16x16x32_bf16 v[32:35], v[116:119], v[68:71], v[32:35]
    s_waitcnt lgkmcnt(5)
    v_mfma_f32_16x16x32_bf16 v[40:43], v[104:107], v[72:75], v[40:43]
    v_mfma_f32_16x16x32_bf16 v[32:35], v[120:123], v[72:75], v[32:35]
    s_waitcnt lgkmcnt(4)
    v_mfma_f32_16x16x32_bf16 v[40:43], v[108:111], v[76:79], v[40:43]
    v_mfma_f32_16x16x32_bf16 v[32:35], v[124:127], v[76:79], v[32:35]
    s_waitcnt lgkmcnt(3)
    v_mfma_f32_16x16x32_bf16 v[44:47], v[96:99], v[80:83], 0
    v_mfma_f32_16x16x32_bf16 v[36:39], v[112:115], v[80:83], 0
    s_waitcnt lgkmcnt(2)
    v_mfma_f32_16x16x32_bf16 v[44:47], v[100:103], v[84:87], v[44:47]
    v_mfma_f32_16x16x32_bf16 v[36:39], v[116:119], v[84:87], v[36:39]
    s_waitcnt lgkmcnt(1)
    v_mfma_f32_16x16x32_bf16 v[44:47], v[104:107], v[88:91], v[44:47]
    v_cvt_pk_bf16_f32 v48, v40, v32
    v_mfma_f32_16x16x32_bf16 v[36:39], v[120:123], v[88:91], v[36:39]
    v_cvt_pk_bf16_f32 v49, v41, v33
    s_waitcnt lgkmcnt(0)
    v_mfma_f32_16x16x32_bf16 v[44:47], v[108:111], v[92:95], v[44:47]
    v_cvt_pk_bf16_f32 v50, v42, v34
    v_mfma_f32_16x16x32_bf16 v[36:39], v[124:127], v[92:95], v[36:39]
    v_cvt_pk_bf16_f32 v51, v43, v35
    buffer_store_dwordx4 v[48:51], v6, s[32:35], s56 offen sc1
    s_nop 5
    v_cvt_pk_bf16_f32 v52, v44, v36
    v_cvt_pk_bf16_f32 v53, v45, v37
    v_cvt_pk_bf16_f32 v54, v46, v38
    v_cvt_pk_bf16_f32 v55, v47, v39
    buffer_store_dwordx4 v[52:55], v6, s[32:35], s57 offen sc1
    s_lshr_b32 s56, s48, 3
    s_and_b32 s57, s48, 7
    s_lshl_b32 s57, s57, 3
    v_lshrrev_b32 v1, 5, v0
    v_add_u32 v1, s57, v1
    v_lshlrev_b32 v1, 5, v1
    v_add_u32 v1, s56, v1
    v_mul_u32_u24 v1, 896, v1
    v_and_b32 v2, 31, v0
    v_lshl_add_u32 v1, v2, 2, v1
    v_lshlrev_b32 v3, 13, v0
    v_lshrrev_b32 v11, 6, v0
    v_and_b32 v12, 15, v0
    v_mul_u32_u24 v15, 272, v12
    v_lshl_add_u32 v12, v11, 4, v12
    v_bfe_u32 v13, v0, 4, 2
    v_lshl_add_u32 v15, v13, 4, v15
    v_add_u32 v15, 0x20000, v15
    v_lshrrev_b32 v14, 1, v11
    v_lshlrev_b32 v14, 4, v14
    v_and_b32 v30, 1, v11
    v_lshl_add_u32 v14, v30, 1, v14
    v_mul_u32_u24 v14, 272, v14
    v_and_b32 v30, 63, v0
    v_lshl_add_u32 v14, v30, 2, v14
    v_add_u32 v14, 0x20000, v14
    v_cvt_f32_u32 v30, v12
    v_mul_f32 v31, 0x3b124925, v30
    v_cos_f32 v24, v31
    v_sin_f32 v25, v31
    v_mul_f32 v31, 0x3b924925, v30
    v_cos_f32 v26, v31
    v_sin_f32 v27, v31
    v_mul_f32 v31, 0x3bdb6db7, v30
    v_cos_f32 v28, v31
    v_sin_f32 v29, v31
    v_add_f32 v24, v24, v24
    v_add_f32 v25, v25, v25
    v_add_f32 v26, v26, v26
    v_add_f32 v27, v27, v27
    v_add_f32 v28, v28, v28
    v_add_f32 v29, v29, v29
    v_mul_u32_u24 v62, 3712, v13
    v_lshl_add_u32 v62, v12, 2, v62
    v_add_u32 v62, 0x22200, v62
    v_lshrrev_b32 v31, 5, v0
    v_mul_u32_u24 v30, 928, v31
    v_lshl_add_u32 v30, v2, 2, v30
    v_add_u32 v30, 0x25c00, v30
    v_mul_u32_u24 v63, 1856, v31
    v_lshl_add_u32 v63, v2, 3, v63
    v_add_u32 v63, 0x22200, v63
    v_bfe_u32 v31, v0, 2, 2
    v_mul_u32_u24 v31, 928, v31
    v_and_b32 v12, 3, v0
    v_lshl_add_u32 v31, v12, 3, v31
    v_lshl_add_u32 v31, v13, 5, v31
    v_lshl_add_u32 v31, v11, 7, v31
    v_add_u32 v31, 0x25c00, v31
    v_lshlrev_b32 v12, 4, v0
    s_barrier
    s_mov_b32 s57, 0xc00000
    buffer_load_dword v4, v1, s[32:35], s57 offen offset:0 sc1
    buffer_load_dword v5, v1, s[32:35], s57 offen offset:128 sc1
    buffer_load_dword v6, v1, s[32:35], s57 offen offset:256 sc1
    buffer_load_dword v7, v1, s[32:35], s57 offen offset:384 sc1
    buffer_load_dword v8, v1, s[32:35], s57 offen offset:512 sc1
    buffer_load_dword v9, v1, s[32:35], s57 offen offset:640 sc1
    buffer_load_dword v10, v1, s[32:35], s57 offen offset:768 sc1
    s_lshl_b32 s56, s48, 5
    s_add_u32 s56, s56, 0x600000
    s_sleep 10
poll_142:
    buffer_load_dwordx4 v[16:19], v3, s[32:35], s56 offen sc1
    buffer_load_dwordx4 v[20:23], v3, s[32:35], s56 offen offset:16 sc1
    s_waitcnt vmcnt(0)
    v_max3_u32 v32, v16, v17, v18
    v_max3_u32 v32, v32, v19, v20
    v_max3_u32 v32, v32, v21, v22
    v_max_u32 v32, v32, v23
    v_cmp_eq_u32 vcc, -1, v32
    s_cbranch_vccz pollok_143
    s_cmp_eq_u32 s55, 0
    s_cbranch_scc1 pollok_143
    s_sub_u32 s55, s55, 1
    s_mov_b64 exec, vcc
    s_sleep 2
    s_branch poll_142
pollok_143:
    s_mov_b64 exec, -1
    ds_write_b32 v14, v16 offset:0
    ds_write_b32 v14, v17 offset:272
    ds_write_b32 v14, v18 offset:1088
    ds_write_b32 v14, v19 offset:1360
    ds_write_b32 v14, v20 offset:2176
    ds_write_b32 v14, v21 offset:2448
    ds_write_b32 v14, v22 offset:3264
    ds_write_b32 v14, v23 offset:3536
    s_waitcnt lgkmcnt(0)
    s_barrier
    ds_read_b128 v[64:67], v15 offset:0
    ds_read_b128 v[68:71], v15 offset:64
    ds_read_b128 v[72:75], v15 offset:128
    ds_read_b128 v[76:79], v15 offset:192
    ds_read_b128 v[80:83], v15 offset:4352
    ds_read_b128 v[84:87], v15 offset:4416
    ds_read_b128 v[88:91], v15 offset:4480
    ds_read_b128 v[92:95], v15 offset:4544
    v_lshlrev_b32 v128, 16, v4
    v_and_b32 v129, 0xffff0000, v4
    v_lshlrev_b32 v130, 16, v5
    v_and_b32 v131, 0xffff0000, v5
    v_lshlrev_b32 v132, 16, v6
    v_and_b32 v133, 0xffff0000, v6
    v_lshlrev_b32 v134, 16, v7
    v_and_b32 v135, 0xffff0000, v7
    v_lshlrev_b32 v136, 16, v8
    v_and_b32 v137, 0xffff0000, v8
    v_lshlrev_b32 v138, 16, v9
    v_and_b32 v139, 0xffff0000, v9
    v_lshlrev_b32 v140, 16, v10
    v_and_b32 v141, 0xffff0000, v10
    s_waitcnt lgkmcnt(7)
    v_mfma_f32_16x16x32_bf16 v[40:43], v[64:67], v[96:99], 0
    v_mfma_f32_16x16x32_bf16 v[32:35], v[64:67], v[112:115], 0
    s_waitcnt lgkmcnt(6)
    v_mfma_f32_16x16x32_bf16 v[40:43], v[68:71], v[100:103], v[40:43]
    v_mfma_f32_16x16x32_bf16 v[32:35], v[68:71], v[116:119], v[32:35]
    s_waitcnt lgkmcnt(5)
    v_mfma_f32_16x16x32_bf16 v[40:43], v[72:75], v[104:107], v[40:43]
    v_mfma_f32_16x16x32_bf16 v[32:35], v[72:75], v[120:123], v[32:35]
    s_waitcnt lgkmcnt(4)
    v_mfma_f32_16x16x32_bf16 v[40:43], v[76:79], v[108:111], v[40:43]
    v_mfma_f32_16x16x32_bf16 v[32:35], v[76:79], v[124:127], v[32:35]
    s_waitcnt lgkmcnt(3)
    v_mfma_f32_16x16x32_bf16 v[44:47], v[80:83], v[96:99], 0
    v_mfma_f32_16x16x32_bf16 v[36:39], v[80:83], v[112:115], 0
    s_waitcnt lgkmcnt(2)
    v_mfma_f32_16x16x32_bf16 v[44:47], v[84:87], v[100:103], v[44:47]
    v_mfma_f32_16x16x32_bf16 v[36:39], v[84:87], v[116:119], v[36:39]
    s_waitcnt lgkmcnt(1)
    v_mfma_f32_16x16x32_bf16 v[44:47], v[88:91], v[104:107], v[44:47]
    v_mfma_f32_16x16x32_bf16 v[36:39], v[88:91], v[120:123], v[36:39]
    v_pk_mul_f32 v[48:49], v[42:43], v[24:25] op_sel:[0,1] op_sel_hi:[1,1]
    v_pk_mul_f32 v[54:55], v[42:43], v[24:25] op_sel:[0,0] op_sel_hi:[1,0]
    v_pk_fma_f32 v[48:49], v[34:35], v[24:25], v[48:49] op_sel:[0,0,0] op_sel_hi:[1,0,1] neg_lo:[0,0,1] neg_hi:[0,0,1]
    v_pk_fma_f32 v[54:55], v[34:35], v[24:25], v[54:55] op_sel:[0,1,0] op_sel_hi:[1,1,1]
    s_waitcnt lgkmcnt(0)
    v_mfma_f32_16x16x32_bf16 v[44:47], v[92:95], v[108:111], v[44:47]
    v_mfma_f32_16x16x32_bf16 v[36:39], v[92:95], v[124:127], v[36:39]
    v_pk_fma_f32 v[16:17], v[48:49], s[36:37], v[32:33]
    v_pk_mul_f32 v[18:19], v[54:55], s[42:43]
    v_pk_fma_f32 v[20:21], v[48:49], s[38:39], v[32:33]
    v_pk_mul_f32 v[22:23], v[54:55], s[44:45]
    v_pk_fma_f32 v[68:69], v[48:49], s[40:41], v[32:33]
    v_pk_mul_f32 v[70:71], v[54:55], s[46:47]
    v_pk_add_f32 v[60:61], v[32:33], v[48:49]
    v_pk_mul_f32 v[50:51], v[44:45], v[26:27] op_sel:[0,1] op_sel_hi:[1,1]
    v_pk_mul_f32 v[56:57], v[44:45], v[26:27] op_sel:[0,0] op_sel_hi:[1,0]
    v_pk_fma_f32 v[50:51], v[36:37], v[26:27], v[50:51] op_sel:[0,0,0] op_sel_hi:[1,0,1] neg_lo:[0,0,1] neg_hi:[0,0,1]
    v_pk_fma_f32 v[56:57], v[36:37], v[26:27], v[56:57] op_sel:[0,1,0] op_sel_hi:[1,1,1]
    v_pk_mul_f32 v[52:53], v[46:47], v[28:29] op_sel:[0,1] op_sel_hi:[1,1]
    v_pk_mul_f32 v[58:59], v[46:47], v[28:29] op_sel:[0,0] op_sel_hi:[1,0]
    v_pk_fma_f32 v[52:53], v[38:39], v[28:29], v[52:53] op_sel:[0,0,0] op_sel_hi:[1,0,1] neg_lo:[0,0,1] neg_hi:[0,0,1]
    v_pk_fma_f32 v[58:59], v[38:39], v[28:29], v[58:59] op_sel:[0,1,0] op_sel_hi:[1,1,1]
    v_pk_add_f32 v[66:67], v[50:51], v[52:53]
    v_pk_add_f32 v[64:65], v[60:61], v[66:67]
    ds_write_b32 v62, v64 offset:0
    ds_write_b32 v62, v65 offset:1856
    v_pk_fma_f32 v[16:17], v[50:51], s[38:39], v[16:17]
    v_pk_fma_f32 v[18:19], v[56:57], s[44:45], v[18:19]
    v_pk_fma_f32 v[16:17], v[52:53], s[40:41], v[16:17]
    v_pk_fma_f32 v[18:19], v[58:59], s[46:47], v[18:19]
    v_pk_add_f32 v[44:45], v[16:17], v[18:19] neg_lo:[0,1] neg_hi:[0,1]
    v_pk_add_f32 v[46:47], v[16:17], v[18:19]
    ds_write_b32 v62, v44 offset:256
    ds_write_b32 v62, v45 offset:2112
    ds_write_b32 v62, v46 offset:1536
    ds_write_b32 v62, v47 offset:3392
    v_pk_fma_f32 v[20:21], v[50:51], s[40:41], v[20:21]
    v_pk_fma_f32 v[22:23], v[56:57], s[46:47], v[22:23] neg_lo:[1,0,0] neg_hi:[1,0,0]
    v_pk_fma_f32 v[20:21], v[52:53], s[36:37], v[20:21]
    v_pk_fma_f32 v[22:23], v[58:59], s[42:43], v[22:23] neg_lo:[1,0,0] neg_hi:[1,0,0]
    v_pk_add_f32 v[40:41], v[20:21], v[22:23] neg_lo:[0,1] neg_hi:[0,1]
    v_pk_add_f32 v[42:43], v[20:21], v[22:23]
    ds_write_b32 v62, v40 offset:512
    ds_write_b32 v62, v41 offset:2368
    ds_write_b32 v62, v42 offset:1280
    ds_write_b32 v62, v43 offset:3136
    v_pk_fma_f32 v[68:69], v[50:51], s[36:37], v[68:69]
    v_pk_fma_f32 v[70:71], v[56:57], s[42:43], v[70:71] neg_lo:[1,0,0] neg_hi:[1,0,0]
    v_pk_fma_f32 v[68:69], v[52:53], s[38:39], v[68:69]
    v_pk_fma_f32 v[70:71], v[58:59], s[44:45], v[70:71]
    v_pk_add_f32 v[44:45], v[68:69], v[70:71] neg_lo:[0,1] neg_hi:[0,1]
    v_pk_add_f32 v[46:47], v[68:69], v[70:71]
    ds_write_b32 v62, v44 offset:768
    ds_write_b32 v62, v45 offset:2624
    ds_write_b32 v62, v46 offset:1024
    ds_write_b32 v62, v47 offset:2880
    s_waitcnt lgkmcnt(0)
    s_barrier
    ds_read_b64 v[64:65], v63 offset:0
    ds_read_b64 v[66:67], v63 offset:256
    ds_read_b64 v[68:69], v63 offset:512
    ds_read_b64 v[70:71], v63 offset:768
    ds_read_b64 v[72:73], v63 offset:1024
    ds_read_b64 v[74:75], v63 offset:1280
    ds_read_b64 v[76:77], v63 offset:1536
    s_waitcnt lgkmcnt(6)
    v_pk_add_f32 v[128:129], v[128:129], v[64:65]
    s_waitcnt lgkmcnt(5)
    v_pk_add_f32 v[130:131], v[130:131], v[66:67]
    s_waitcnt lgkmcnt(4)
    v_pk_add_f32 v[132:133], v[132:133], v[68:69]
    s_waitcnt lgkmcnt(3)
    v_pk_add_f32 v[134:135], v[134:135], v[70:71]
    s_waitcnt lgkmcnt(2)
    v_pk_add_f32 v[136:137], v[136:137], v[72:73]
    s_waitcnt lgkmcnt(1)
    v_pk_add_f32 v[138:139], v[138:139], v[74:75]
    s_waitcnt lgkmcnt(0)
    v_pk_add_f32 v[140:141], v[140:141], v[76:77]
    v_subrev_u32 v52, 23552, v30
    v_mov_b32 v53, 0x2edbe6ff
    s_mov_b32 s58, 0x3f800054
    v_pk_add_f32 v[46:47], v[128:129], v[130:131]
    v_pk_mul_f32 v[48:49], v[128:129], v[128:129]
    v_cvt_pk_bf16_f32 v4, v128, v129
    v_pk_add_f32 v[46:47], v[46:47], v[132:133]
    v_pk_fma_f32 v[48:49], v[130:131], v[130:131], v[48:49]
    ds_write_b32 v52, v4 offset:0
    v_pk_add_f32 v[46:47], v[46:47], v[134:135]
    v_pk_fma_f32 v[48:49], v[132:133], v[132:133], v[48:49]
    v_cvt_pk_bf16_f32 v5, v130, v131
    v_pk_add_f32 v[46:47], v[46:47], v[136:137]
    v_pk_fma_f32 v[48:49], v[134:135], v[134:135], v[48:49]
    ds_write_b32 v52, v5 offset:128
    v_pk_add_f32 v[46:47], v[46:47], v[138:139]
    v_pk_fma_f32 v[48:49], v[136:137], v[136:137], v[48:49]
    v_cvt_pk_bf16_f32 v6, v132, v133
    v_pk_add_f32 v[46:47], v[46:47], v[140:141]
    v_pk_fma_f32 v[48:49], v[138:139], v[138:139], v[48:49]
    ds_write_b32 v52, v6 offset:256
    v_add_f32 v46, v46, v47
    v_pk_fma_f32 v[48:49], v[140:141], v[140:141], v[48:49]
    v_cvt_pk_bf16_f32 v7, v134, v135
    v_add_f32_dpp v46, v46, v46 quad_perm:[1,0,3,2] row_mask:0xf bank_mask:0xf
    v_add_f32 v48, v48, v49
    ds_write_b32 v52, v7 offset:384
    v_add_f32_dpp v46, v46, v46 quad_perm:[2,3,0,1] row_mask:0xf bank_mask:0xf
    v_add_f32_dpp v48, v48, v48 quad_perm:[1,0,3,2] row_mask:0xf bank_mask:0xf
    v_cvt_pk_bf16_f32 v8, v136, v137
    v_add_f32_dpp v46, v46, v46 row_half_mirror row_mask:0xf bank_mask:0xf
    v_add_f32_dpp v48, v48, v48 quad_perm:[2,3,0,1] row_mask:0xf bank_mask:0xf
    ds_write_b32 v52, v8 offset:512
    v_add_f32_dpp v46, v46, v46 row_mirror row_mask:0xf bank_mask:0xf
    v_add_f32_dpp v48, v48, v48 row_half_mirror row_mask:0xf bank_mask:0xf
    v_cvt_pk_bf16_f32 v9, v138, v139
    v_mov_b32 v50, v46
    v_add_f32_dpp v48, v48, v48 row_mirror row_mask:0xf bank_mask:0xf
    ds_write_b32 v52, v9 offset:640
    v_permlane16_swap_b32 v46, v50
    v_mov_b32 v51, v48
    v_cvt_pk_bf16_f32 v10, v140, v141
    v_add_f32 v46, v46, v50
    v_permlane16_swap_b32 v48, v51
    ds_write_b32 v52, v10 offset:768
    v_add_f32 v48, v48, v51
    v_mul_f32 v46, 0x3b124925, v46
    v_mul_f32 v48, 0x3b124925, v48
    v_fma_f32 v48, -v46, v46, v48
    v_max_f32 v48, 0, v48
    v_fma_f32 v48, v48, s58, v53
    v_rsq_f32 v48, v48
    s_mul_i32 s56, s48, 7168
    s_add_u32 s56, s56, 0x1200000
    v_mul_f32 v46, v46, v48
    v_pk_fma_f32 v[128:129], v[128:129], v[48:49], v[46:47] op_sel_hi:[1,0,0] neg_lo:[0,0,1] neg_hi:[0,0,1]
    v_pk_fma_f32 v[130:131], v[130:131], v[48:49], v[46:47] op_sel_hi:[1,0,0] neg_lo:[0,0,1] neg_hi:[0,0,1]
    v_pk_fma_f32 v[132:133], v[132:133], v[48:49], v[46:47] op_sel_hi:[1,0,0] neg_lo:[0,0,1] neg_hi:[0,0,1]
    v_pk_fma_f32 v[134:135], v[134:135], v[48:49], v[46:47] op_sel_hi:[1,0,0] neg_lo:[0,0,1] neg_hi:[0,0,1]
    v_pk_fma_f32 v[136:137], v[136:137], v[48:49], v[46:47] op_sel_hi:[1,0,0] neg_lo:[0,0,1] neg_hi:[0,0,1]
    v_pk_fma_f32 v[138:139], v[138:139], v[48:49], v[46:47] op_sel_hi:[1,0,0] neg_lo:[0,0,1] neg_hi:[0,0,1]
    v_pk_fma_f32 v[140:141], v[140:141], v[48:49], v[46:47] op_sel_hi:[1,0,0] neg_lo:[0,0,1] neg_hi:[0,0,1]
    v_cvt_pk_bf16_f32 v64, v128, v129
    ds_write_b32 v30, v64 offset:0
    v_cvt_pk_bf16_f32 v65, v130, v131
    ds_write_b32 v30, v65 offset:128
    v_cvt_pk_bf16_f32 v66, v132, v133
    ds_write_b32 v30, v66 offset:256
    v_cvt_pk_bf16_f32 v67, v134, v135
    ds_write_b32 v30, v67 offset:384
    v_cvt_pk_bf16_f32 v68, v136, v137
    ds_write_b32 v30, v68 offset:512
    v_cvt_pk_bf16_f32 v69, v138, v139
    ds_write_b32 v30, v69 offset:640
    v_cvt_pk_bf16_f32 v70, v140, v141
    ds_write_b32 v30, v70 offset:768
    s_add_u32 s57, s56, 4096
    s_waitcnt lgkmcnt(0)
    s_barrier
    ds_read_b64_tr_b16 v[20:21], v31
    ds_read_b64_tr_b16 v[22:23], v31 offset:3712
    ds_read_b64_tr_b16 v[24:25], v31 offset:512
    ds_read_b64_tr_b16 v[26:27], v31 offset:4224
    v_cmp_gt_u32 vcc, 192, v0
    v_mov_b32 v13, 0x80000000
    s_nop 0
    v_cndmask_b32 v13, v13, v12, vcc
    v_and_b32 v14, 63, v0
    v_lshlrev_b32 v15, 4, v14
    s_mul_i32 s58, s49, 1856
    s_add_u32 s58, s58, 0x20000
    v_add_u32 v16, s58, v15
    ds_read_b128 v[32:35], v16
    ds_read_b128 v[36:39], v16 offset:928
    v_readfirstlane_b32 s58, v1
    v_mov_b32 v17, 0x80000000
    s_waitcnt lgkmcnt(4)
    buffer_store_dwordx4 v[20:23], v12, s[32:35], s56 offen sc1
    v_cmp_gt_u32 vcc, 56, v14
    s_add_u32 s58, s58, 0xe00000
    s_add_u32 s59, s58, 28672
    v_cndmask_b32 v15, v17, v15, vcc
    s_waitcnt lgkmcnt(2)
    buffer_store_dwordx4 v[24:27], v13, s[32:35], s57 offen sc1
    s_waitcnt lgkmcnt(0)
    buffer_store_dwordx4 v[32:35], v15, s[32:35], s58 offen sc1
    buffer_store_dwordx4 v[36:39], v15, s[32:35], s59 offen sc1
    v_bfe_u32 v8, v0, 5, 1
    v_mul_u32_u24 v8, 448, v8
    s_mul_i32 s98, s50, 64
    v_add_u32 v8, s98, v8
    v_and_b32 v9, 31, v0
    v_add_lshl_u32 v2, v8, v9, 4
    v_lshrrev_b32 v3, 2, v0
    v_and_b32 v3, 16, v3
    v_xor_b32 v9, v9, v3
    v_add_lshl_u32 v3, v8, v9, 4
    v_and_b32 v8, 63, v0
    v_lshlrev_b32 v8, 4, v8
    v_add_u32 v6, 0x20000, v8
    v_bfe_u32 v8, v0, 2, 2
    v_bfe_u32 v9, v0, 5, 1
    v_mul_u32_u24 v9, 4, v9
    v_add_u32 v9, v9, v8
    v_lshlrev_b32 v4, 7, v9
    v_lshrrev_b32 v8, 4, v0
    v_xor_b32 v8, v8, v0
    v_bfe_u32 v8, v8, 3, 1
    v_lshl_add_u32 v4, v8, 6, v4
    v_bfe_u32 v8, v0, 4, 1
    v_lshl_add_u32 v4, v8, 5, v4
    v_and_b32 v8, 3, v0
    v_lshl_add_u32 v4, v8, 3, v4
    v_add_u32 v4, s60, v4
    v_xor_b32 v5, 64, v4
    s_barrier
    s_mul_i32 s56, s49, 458752
    s_add_u32 s56, s56, 0x1200000
    s_mul_i32 s57, s49, 401408
    s_add_u32 s57, s57, 0x1600000
    s_lshr_b32 s58, s49, 1
    s_lshl_b32 s58, s58, 5
    s_lshl_b32 s59, s52, 6
    s_add_u32 s58, s58, s59
    v_and_b32 v9, 31, v0
    v_add_lshl_u32 v9, v9, s58, 1
    v_and_b32 v9, 0xfff, v9
    global_load_ushort v26, v9, s[18:19]
    s_cmp_lg_u32 s53, 0
    s_cbranch_scc1 b1skip_144
    s_lshl_b32 s58, s49, 5
    s_lshl_b32 s59, s51, 7
    s_add_u32 s58, s58, s59
    v_bfe_u32 v9, v0, 5, 1
    v_lshlrev_b32 v9, 3, v9
    v_add_u32 v9, s58, v9
    global_load_dwordx2 v[28:29], v9, s[14:15]
    global_load_dwordx2 v[30:31], v9, s[14:15] offset:16
    s_lshl_b32 s44, s51, 2
    s_add_u32 s44, s44, s49
    s_mul_i32 s44, s44, 14336
    s_add_u32 s44, s44, 0x1600000
    s_mov_b32 s42, 0xbdd2d3e8
    s_mov_b32 s43, s42
    s_sleep 12
    s_add_u32 s101, s56, 0
    buffer_load_dwordx4 v[32:35], v2, s[32:35], s101 offen offset:0 sc1
    s_add_u32 s101, s56, 14336
    buffer_load_dwordx4 v[36:39], v2, s[32:35], s101 offen offset:0 sc1
    s_add_u32 s101, s56, 28672
    buffer_load_dwordx4 v[40:43], v2, s[32:35], s101 offen offset:0 sc1
    s_add_u32 s101, s56, 43008
    buffer_load_dwordx4 v[44:47], v2, s[32:35], s101 offen offset:0 sc1
    s_add_u32 s101, s56, 57344
    buffer_load_dwordx4 v[48:51], v2, s[32:35], s101 offen offset:0 sc1
    s_add_u32 s101, s56, 71680
    buffer_load_dwordx4 v[52:55], v2, s[32:35], s101 offen offset:0 sc1
    s_add_u32 s101, s56, 86016
    buffer_load_dwordx4 v[56:59], v2, s[32:35], s101 offen offset:0 sc1
    s_add_u32 s101, s56, 100352
    buffer_load_dwordx4 v[60:63], v2, s[32:35], s101 offen offset:0 sc1
    s_add_u32 s101, s56, 114688
    buffer_load_dwordx4 v[64:67], v2, s[32:35], s101 offen offset:0 sc1
    s_add_u32 s101, s56, 129024
    buffer_load_dwordx4 v[68:71], v2, s[32:35], s101 offen offset:0 sc1
    s_add_u32 s101, s56, 143360
    buffer_load_dwordx4 v[72:75], v2, s[32:35], s101 offen offset:0 sc1
    s_add_u32 s101, s56, 157696
    buffer_load_dwordx4 v[76:79], v2, s[32:35], s101 offen offset:0 sc1
    s_waitcnt vmcnt(12)
    v_lshlrev_b32 v16, 16, v28
    v_and_b32 v17, 0xffff0000, v28
    v_lshlrev_b32 v18, 16, v29
    v_and_b32 v19, 0xffff0000, v29
    v_lshlrev_b32 v20, 16, v30
    v_and_b32 v21, 0xffff0000, v30
    v_lshlrev_b32 v22, 16, v31
    v_and_b32 v23, 0xffff0000, v31
    v_mov_b32 v27, 0xc0135761
    v_mov_b32 v96, v16
    v_mov_b32 v104, 0
    v_mov_b32 v97, v17
    v_mov_b32 v105, 0
    v_mov_b32 v98, v18
    v_mov_b32 v106, 0
    v_mov_b32 v99, v19
    v_mov_b32 v107, 0
    v_mov_b32 v100, v20
    v_mov_b32 v108, 0
    v_mov_b32 v101, v21
    v_mov_b32 v109, 0
    v_mov_b32 v102, v22
    v_mov_b32 v110, 0
    v_mov_b32 v103, v23
    v_mov_b32 v111, 0
    s_waitcnt vmcnt(10)
    v_max3_u32 v8, v32, v33, v34
    v_max3_u32 v8, v8, v35, v36
    v_max3_u32 v8, v8, v37, v38
    v_max_u32 v8, v8, v39
    v_cmp_eq_u32 vcc, -1, v8
    s_cbranch_vccnz rty_147
bk_148:
    v_mfma_f32_32x32x16_bf16 v[112:127], a[4:7], v[32:35], 0
    s_add_u32 s101, s56, 172032
    buffer_load_dwordx4 v[80:83], v2, s[32:35], s101 offen offset:0 sc1
    v_mfma_f32_32x32x16_bf16 v[96:111], a[0:3], v[32:35], v[96:111]
    s_waitcnt vmcnt(9)
    v_max3_u32 v8, v40, v41, v42
    v_max3_u32 v9, v43, v44, v45
    v_mfma_f32_32x32x16_bf16 v[112:127], a[12:15], v[36:39], v[112:127]
    s_add_u32 s101, s56, 186368
    buffer_load_dwordx4 v[84:87], v2, s[32:35], s101 offen offset:0 sc1
    v_max3_u32 v8, v8, v46, v47
    v_max_u32 v8, v8, v9
    v_cmp_eq_u32 vcc, -1, v8
    v_mfma_f32_32x32x16_bf16 v[96:111], a[8:11], v[36:39], v[96:111]
    s_cbranch_vccnz rty_149
bk_150:
    v_mfma_f32_32x32x16_bf16 v[112:127], a[20:23], v[40:43], v[112:127]
    s_add_u32 s101, s56, 200704
    buffer_load_dwordx4 v[88:91], v2, s[32:35], s101 offen offset:0 sc1
    v_mfma_f32_32x32x16_bf16 v[96:111], a[16:19], v[40:43], v[96:111]
    s_waitcnt vmcnt(9)
    v_max3_u32 v8, v48, v49, v50
    v_max3_u32 v9, v51, v52, v53
    v_mfma_f32_32x32x16_bf16 v[112:127], a[28:31], v[44:47], v[112:127]
    s_add_u32 s101, s56, 215040
    buffer_load_dwordx4 v[92:95], v2, s[32:35], s101 offen offset:0 sc1
    v_max3_u32 v8, v8, v54, v55
    v_max_u32 v8, v8, v9
    v_cmp_eq_u32 vcc, -1, v8
    v_mfma_f32_32x32x16_bf16 v[96:111], a[24:27], v[44:47], v[96:111]
    s_cbranch_vccnz rty_151
bk_152:
    v_mfma_f32_32x32x16_bf16 v[112:127], a[36:39], v[48:51], v[112:127]
    s_add_u32 s101, s56, 229376
    buffer_load_dwordx4 v[32:35], v2, s[32:35], s101 offen offset:0 sc1
    v_mfma_f32_32x32x16_bf16 v[96:111], a[32:35], v[48:51], v[96:111]
    s_waitcnt vmcnt(9)
    v_max3_u32 v8, v56, v57, v58
    v_max3_u32 v9, v59, v60, v61
    v_mfma_f32_32x32x16_bf16 v[112:127], a[44:47], v[52:55], v[112:127]
    s_add_u32 s101, s56, 243712
    buffer_load_dwordx4 v[36:39], v2, s[32:35], s101 offen offset:0 sc1
    v_max3_u32 v8, v8, v62, v63
    v_max_u32 v8, v8, v9
    v_cmp_eq_u32 vcc, -1, v8
    v_mfma_f32_32x32x16_bf16 v[96:111], a[40:43], v[52:55], v[96:111]
    s_cbranch_vccnz rty_153
bk_154:
    v_mfma_f32_32x32x16_bf16 v[112:127], a[52:55], v[56:59], v[112:127]
    s_add_u32 s101, s56, 258048
    buffer_load_dwordx4 v[40:43], v2, s[32:35], s101 offen offset:0 sc1
    v_mfma_f32_32x32x16_bf16 v[96:111], a[48:51], v[56:59], v[96:111]
    s_waitcnt vmcnt(9)
    v_max3_u32 v8, v64, v65, v66
    v_max3_u32 v9, v67, v68, v69
    v_mfma_f32_32x32x16_bf16 v[112:127], a[60:63], v[60:63], v[112:127]
    s_add_u32 s101, s56, 272384
    buffer_load_dwordx4 v[44:47], v2, s[32:35], s101 offen offset:0 sc1
    v_max3_u32 v8, v8, v70, v71
    v_max_u32 v8, v8, v9
    v_cmp_eq_u32 vcc, -1, v8
    v_mfma_f32_32x32x16_bf16 v[96:111], a[56:59], v[60:63], v[96:111]
    s_cbranch_vccnz rty_155
bk_156:
    v_mfma_f32_32x32x16_bf16 v[112:127], a[68:71], v[64:67], v[112:127]
    s_add_u32 s101, s56, 286720
    buffer_load_dwordx4 v[48:51], v2, s[32:35], s101 offen offset:0 sc1
    v_mfma_f32_32x32x16_bf16 v[96:111], a[64:67], v[64:67], v[96:111]
    s_waitcnt vmcnt(9)
    v_max3_u32 v8, v72, v73, v74
    v_max3_u32 v9, v75, v76, v77
    v_mfma_f32_32x32x16_bf16 v[112:127], a[76:79], v[68:71], v[112:127]
    s_add_u32 s101, s56, 301056
    buffer_load_dwordx4 v[52:55], v2, s[32:35], s101 offen offset:0 sc1
    v_max3_u32 v8, v8, v78, v79
    v_max_u32 v8, v8, v9
    v_cmp_eq_u32 vcc, -1, v8
    v_mfma_f32_32x32x16_bf16 v[96:111], a[72:75], v[68:71], v[96:111]
    s_cbranch_vccnz rty_157
bk_158:
    v_mfma_f32_32x32x16_bf16 v[112:127], a[84:87], v[72:75], v[112:127]
    s_add_u32 s101, s56, 315392
    buffer_load_dwordx4 v[56:59], v2, s[32:35], s101 offen offset:0 sc1
    v_mfma_f32_32x32x16_bf16 v[96:111], a[80:83], v[72:75], v[96:111]
    s_waitcnt vmcnt(9)
    v_max3_u32 v8, v80, v81, v82
    v_max3_u32 v9, v83, v84, v85
    v_mfma_f32_32x32x16_bf16 v[112:127], a[92:95], v[76:79], v[112:127]
    s_add_u32 s101, s56, 329728
    buffer_load_dwordx4 v[60:63], v2, s[32:35], s101 offen offset:0 sc1
    v_max3_u32 v8, v8, v86, v87
    v_max_u32 v8, v8, v9
    v_cmp_eq_u32 vcc, -1, v8
    v_mfma_f32_32x32x16_bf16 v[96:111], a[88:91], v[76:79], v[96:111]
    s_cbranch_vccnz rty_159
bk_160:
    v_mfma_f32_32x32x16_bf16 v[112:127], a[100:103], v[80:83], v[112:127]
    s_add_u32 s101, s56, 344064
    buffer_load_dwordx4 v[64:67], v2, s[32:35], s101 offen offset:0 sc1
    v_mfma_f32_32x32x16_bf16 v[96:111], a[96:99], v[80:83], v[96:111]
    s_waitcnt vmcnt(9)
    v_max3_u32 v8, v88, v89, v90
    v_max3_u32 v9, v91, v92, v93
    v_mfma_f32_32x32x16_bf16 v[112:127], a[108:111], v[84:87], v[112:127]
    s_add_u32 s101, s56, 358400
    buffer_load_dwordx4 v[68:71], v2, s[32:35], s101 offen offset:0 sc1
    v_max3_u32 v8, v8, v94, v95
    v_max_u32 v8, v8, v9
    v_cmp_eq_u32 vcc, -1, v8
    v_mfma_f32_32x32x16_bf16 v[96:111], a[104:107], v[84:87], v[96:111]
    s_cbranch_vccnz rty_161
bk_162:
    v_mfma_f32_32x32x16_bf16 v[112:127], a[116:119], v[88:91], v[112:127]
    s_add_u32 s101, s56, 372736
    buffer_load_dwordx4 v[72:75], v2, s[32:35], s101 offen offset:0 sc1
    v_mfma_f32_32x32x16_bf16 v[96:111], a[112:115], v[88:91], v[96:111]
    s_waitcnt vmcnt(9)
    v_max3_u32 v8, v32, v33, v34
    v_max3_u32 v9, v35, v36, v37
    v_mfma_f32_32x32x16_bf16 v[112:127], a[124:127], v[92:95], v[112:127]
    s_add_u32 s101, s56, 387072
    buffer_load_dwordx4 v[76:79], v2, s[32:35], s101 offen offset:0 sc1
    v_max3_u32 v8, v8, v38, v39
    v_max_u32 v8, v8, v9
    v_cmp_eq_u32 vcc, -1, v8
    v_mfma_f32_32x32x16_bf16 v[96:111], a[120:123], v[92:95], v[96:111]
    s_cbranch_vccnz rty_163
bk_164:
    v_mfma_f32_32x32x16_bf16 v[112:127], a[132:135], v[32:35], v[112:127]
    s_add_u32 s101, s56, 401408
    buffer_load_dwordx4 v[80:83], v2, s[32:35], s101 offen offset:0 sc1
    v_mfma_f32_32x32x16_bf16 v[96:111], a[128:131], v[32:35], v[96:111]
    s_waitcnt vmcnt(9)
    v_max3_u32 v8, v40, v41, v42
    v_max3_u32 v9, v43, v44, v45
    v_mfma_f32_32x32x16_bf16 v[112:127], a[140:143], v[36:39], v[112:127]
    s_add_u32 s101, s56, 415744
    buffer_load_dwordx4 v[84:87], v2, s[32:35], s101 offen offset:0 sc1
    v_max3_u32 v8, v8, v46, v47
    v_max_u32 v8, v8, v9
    v_cmp_eq_u32 vcc, -1, v8
    v_mfma_f32_32x32x16_bf16 v[96:111], a[136:139], v[36:39], v[96:111]
    s_cbranch_vccnz rty_165
bk_166:
    v_mfma_f32_32x32x16_bf16 v[112:127], a[148:151], v[40:43], v[112:127]
    s_add_u32 s101, s56, 430080
    buffer_load_dwordx4 v[88:91], v2, s[32:35], s101 offen offset:0 sc1
    v_mfma_f32_32x32x16_bf16 v[96:111], a[144:147], v[40:43], v[96:111]
    s_waitcnt vmcnt(9)
    v_max3_u32 v8, v48, v49, v50
    v_max3_u32 v9, v51, v52, v53
    v_mfma_f32_32x32x16_bf16 v[112:127], a[156:159], v[44:47], v[112:127]
    s_add_u32 s101, s56, 444416
    buffer_load_dwordx4 v[92:95], v2, s[32:35], s101 offen offset:0 sc1
    v_max3_u32 v8, v8, v54, v55
    v_max_u32 v8, v8, v9
    v_cmp_eq_u32 vcc, -1, v8
    v_mfma_f32_32x32x16_bf16 v[96:111], a[152:155], v[44:47], v[96:111]
    s_cbranch_vccnz rty_167
bk_168:
    v_mfma_f32_32x32x16_bf16 v[112:127], a[164:167], v[48:51], v[112:127]
    s_add_u32 s101, s56, 0
    buffer_load_dwordx4 v[32:35], v2, s[32:35], s101 offen offset:512 sc1
    v_mfma_f32_32x32x16_bf16 v[96:111], a[160:163], v[48:51], v[96:111]
    s_waitcnt vmcnt(9)
    v_max3_u32 v8, v56, v57, v58
    v_max3_u32 v9, v59, v60, v61
    v_mfma_f32_32x32x16_bf16 v[112:127], a[172:175], v[52:55], v[112:127]
    s_add_u32 s101, s56, 14336
    buffer_load_dwordx4 v[36:39], v2, s[32:35], s101 offen offset:512 sc1
    v_max3_u32 v8, v8, v62, v63
    v_max_u32 v8, v8, v9
    v_cmp_eq_u32 vcc, -1, v8
    v_mfma_f32_32x32x16_bf16 v[96:111], a[168:171], v[52:55], v[96:111]
    s_cbranch_vccnz rty_169
bk_170:
    v_mfma_f32_32x32x16_bf16 v[112:127], a[180:183], v[56:59], v[112:127]
    s_add_u32 s101, s56, 28672
    buffer_load_dwordx4 v[40:43], v2, s[32:35], s101 offen offset:512 sc1
    v_mfma_f32_32x32x16_bf16 v[96:111], a[176:179], v[56:59], v[96:111]
    s_waitcnt vmcnt(9)
    v_max3_u32 v8, v64, v65, v66
    v_max3_u32 v9, v67, v68, v69
    v_mfma_f32_32x32x16_bf16 v[112:127], a[188:191], v[60:63], v[112:127]
    s_add_u32 s101, s56, 43008
    buffer_load_dwordx4 v[44:47], v2, s[32:35], s101 offen offset:512 sc1
    v_max3_u32 v8, v8, v70, v71
    v_max_u32 v8, v8, v9
    v_cmp_eq_u32 vcc, -1, v8
    v_mfma_f32_32x32x16_bf16 v[96:111], a[184:187], v[60:63], v[96:111]
    s_cbranch_vccnz rty_171
bk_172:
    v_mfma_f32_32x32x16_bf16 v[112:127], a[196:199], v[64:67], v[112:127]
    s_add_u32 s101, s56, 57344
    buffer_load_dwordx4 v[48:51], v2, s[32:35], s101 offen offset:512 sc1
    v_mfma_f32_32x32x16_bf16 v[96:111], a[192:195], v[64:67], v[96:111]
    s_waitcnt vmcnt(9)
    v_max3_u32 v8, v72, v73, v74
    v_max3_u32 v9, v75, v76, v77
    v_mfma_f32_32x32x16_bf16 v[112:127], a[204:207], v[68:71], v[112:127]
    s_add_u32 s101, s56, 71680
    buffer_load_dwordx4 v[52:55], v2, s[32:35], s101 offen offset:512 sc1
    v_max3_u32 v8, v8, v78, v79
    v_max_u32 v8, v8, v9
    v_cmp_eq_u32 vcc, -1, v8
    v_mfma_f32_32x32x16_bf16 v[96:111], a[200:203], v[68:71], v[96:111]
    s_cbranch_vccnz rty_173
bk_174:
    v_mfma_f32_32x32x16_bf16 v[112:127], a[212:215], v[72:75], v[112:127]
    s_add_u32 s101, s56, 86016
    buffer_load_dwordx4 v[56:59], v2, s[32:35], s101 offen offset:512 sc1
    v_mfma_f32_32x32x16_bf16 v[96:111], a[208:211], v[72:75], v[96:111]
    s_waitcnt vmcnt(9)
    v_max3_u32 v8, v80, v81, v82
    v_max3_u32 v9, v83, v84, v85
    v_mfma_f32_32x32x16_bf16 v[112:127], a[220:223], v[76:79], v[112:127]
    s_add_u32 s101, s56, 100352
    buffer_load_dwordx4 v[60:63], v2, s[32:35], s101 offen offset:512 sc1
    v_max3_u32 v8, v8, v86, v87
    v_max_u32 v8, v8, v9
    v_cmp_eq_u32 vcc, -1, v8
    v_mfma_f32_32x32x16_bf16 v[96:111], a[216:219], v[76:79], v[96:111]
    s_cbranch_vccnz rty_175
bk_176:
    s_xor_b32 s98, s49, 0
    s_mul_i32 s98, s98, 6144
    v_add_u32 v10, s98, v6
    s_xor_b32 s98, s49, 1
    s_mul_i32 s98, s98, 6144
    v_add_u32 v11, s98, v6
    s_xor_b32 s98, s49, 2
    s_mul_i32 s98, s98, 6144
    v_add_u32 v12, s98, v6
    s_xor_b32 s98, s49, 3
    s_mul_i32 s98, s98, 6144
    v_add_u32 v13, s98, v6
    v_mfma_f32_32x32x16_bf16 v[112:127], a[228:231], v[80:83], v[112:127]
    s_add_u32 s101, s56, 114688
    buffer_load_dwordx4 v[64:67], v2, s[32:35], s101 offen offset:512 sc1
    v_mfma_f32_32x32x16_bf16 v[96:111], a[224:227], v[80:83], v[96:111]
    s_waitcnt vmcnt(9)
    v_max3_u32 v8, v88, v89, v90
    v_max3_u32 v9, v91, v92, v93
    v_mfma_f32_32x32x16_bf16 v[112:127], a[236:239], v[84:87], v[112:127]
    s_add_u32 s101, s56, 129024
    buffer_load_dwordx4 v[68:71], v2, s[32:35], s101 offen offset:512 sc1
    v_max3_u32 v8, v8, v94, v95
    v_max_u32 v8, v8, v9
    v_cmp_eq_u32 vcc, -1, v8
    v_mfma_f32_32x32x16_bf16 v[96:111], a[232:235], v[84:87], v[96:111]
    s_cbranch_vccnz rty_177
bk_178:
    v_mfma_f32_32x32x16_bf16 v[112:127], a[244:247], v[88:91], v[112:127]
    s_add_u32 s101, s56, 143360
    buffer_load_dwordx4 v[72:75], v2, s[32:35], s101 offen offset:512 sc1
    v_mfma_f32_32x32x16_bf16 v[96:111], a[240:243], v[88:91], v[96:111]
    s_waitcnt vmcnt(9)
    v_max3_u32 v8, v32, v33, v34
    v_max3_u32 v9, v35, v36, v37
    v_mfma_f32_32x32x16_bf16 v[112:127], a[252:255], v[92:95], v[112:127]
    s_add_u32 s101, s56, 157696
    buffer_load_dwordx4 v[76:79], v2, s[32:35], s101 offen offset:512 sc1
    v_max3_u32 v8, v8, v38, v39
    v_max_u32 v8, v8, v9
    v_cmp_eq_u32 vcc, -1, v8
    v_mfma_f32_32x32x16_bf16 v[96:111], a[248:251], v[92:95], v[96:111]
    s_cbranch_vccnz rty_179
bk_180:
    v_mov_b32 v128, v16
    v_mov_b32 v136, 0
    v_mov_b32 v129, v17
    v_mov_b32 v137, 0
    v_mov_b32 v130, v18
    v_mov_b32 v138, 0
    v_mov_b32 v131, v19
    v_mov_b32 v139, 0
    v_mov_b32 v132, v20
    v_mov_b32 v140, 0
    v_mov_b32 v133, v21
    v_mov_b32 v141, 0
    v_mov_b32 v134, v22
    v_mov_b32 v142, 0
    v_mov_b32 v135, v23
    v_mov_b32 v143, 0
    s_add_u32 s101, s56, 172032
    buffer_load_dwordx4 v[80:83], v2, s[32:35], s101 offen offset:512 sc1
    s_add_u32 s101, s56, 186368
    buffer_load_dwordx4 v[84:87], v2, s[32:35], s101 offen offset:512 sc1
    s_add_u32 s101, s56, 200704
    buffer_load_dwordx4 v[88:91], v2, s[32:35], s101 offen offset:512 sc1
    s_add_u32 s101, s56, 215040
    buffer_load_dwordx4 v[92:95], v2, s[32:35], s101 offen offset:512 sc1
    ds_write_b128 v12, v[112:115] offset:2048
    ds_write_b128 v12, v[116:119] offset:3072
    ds_write_b128 v13, v[120:123] offset:4096
    ds_write_b128 v13, v[124:127] offset:5120
    ds_write_b128 v11, v[104:107] offset:0
    ds_write_b128 v11, v[108:111] offset:1024
    s_waitcnt lgkmcnt(0)
    s_barrier
    ds_read_b128 v[104:107], v10 offset:0
    ds_read_b128 v[108:111], v10 offset:1024
    ds_read_b128 v[112:115], v10 offset:2048
    ds_read_b128 v[116:119], v10 offset:3072
    ds_read_b128 v[120:123], v10 offset:4096
    ds_read_b128 v[124:127], v10 offset:5120
    s_waitcnt lgkmcnt(4)
    v_pk_add_f32 v[96:97], v[96:97], v[104:105]
    v_pk_add_f32 v[98:99], v[98:99], v[106:107]
    v_pk_add_f32 v[100:101], v[100:101], v[108:109]
    v_pk_add_f32 v[102:103], v[102:103], v[110:111]
    s_waitcnt lgkmcnt(2)
    v_pk_add_f32 v[96:97], v[96:97], v[112:113]
    v_pk_add_f32 v[98:99], v[98:99], v[114:115]
    v_pk_add_f32 v[100:101], v[100:101], v[116:117]
    v_pk_add_f32 v[102:103], v[102:103], v[118:119]
    s_waitcnt lgkmcnt(0)
    v_pk_add_f32 v[96:97], v[96:97], v[120:121]
    v_pk_add_f32 v[98:99], v[98:99], v[122:123]
    v_pk_add_f32 v[100:101], v[100:101], v[124:125]
    v_pk_add_f32 v[102:103], v[102:103], v[126:127]
    v_pk_mul_f32 v[104:105], v[96:97], v[96:97]
    v_pk_mul_f32 v[106:107], v[98:99], v[98:99]
    v_pk_mul_f32 v[108:109], v[100:101], v[100:101]
    v_pk_mul_f32 v[110:111], v[102:103], v[102:103]
    v_pk_fma_f32 v[104:105], v[104:105], s[42:43], v[26:27] op_sel:[0,0,1] op_sel_hi:[1,1,1]
    v_pk_fma_f32 v[106:107], v[106:107], s[42:43], v[26:27] op_sel:[0,0,1] op_sel_hi:[1,1,1]
    v_pk_fma_f32 v[108:109], v[108:109], s[42:43], v[26:27] op_sel:[0,0,1] op_sel_hi:[1,1,1]
    v_pk_fma_f32 v[110:111], v[110:111], s[42:43], v[26:27] op_sel:[0,0,1] op_sel_hi:[1,1,1]
    v_pk_mul_f32 v[104:105], v[104:105], v[96:97]
    v_pk_mul_f32 v[106:107], v[106:107], v[98:99]
    v_pk_mul_f32 v[108:109], v[108:109], v[100:101]
    v_pk_mul_f32 v[110:111], v[110:111], v[102:103]
    v_exp_f32 v104, v104
    v_exp_f32 v105, v105
    v_exp_f32 v106, v106
    v_exp_f32 v107, v107
    v_exp_f32 v108, v108
    v_exp_f32 v109, v109
    v_exp_f32 v110, v110
    v_exp_f32 v111, v111
    v_pk_add_f32 v[104:105], v[104:105], 1.0 op_sel_hi:[1,0]
    v_pk_add_f32 v[106:107], v[106:107], 1.0 op_sel_hi:[1,0]
    v_pk_add_f32 v[108:109], v[108:109], 1.0 op_sel_hi:[1,0]
    v_pk_add_f32 v[110:111], v[110:111], 1.0 op_sel_hi:[1,0]
    v_rcp_f32 v104, v104
    v_rcp_f32 v105, v105
    v_rcp_f32 v106, v106
    v_rcp_f32 v107, v107
    v_rcp_f32 v108, v108
    v_rcp_f32 v109, v109
    v_rcp_f32 v110, v110
    v_rcp_f32 v111, v111
    v_pk_mul_f32 v[96:97], v[96:97], v[104:105]
    v_pk_mul_f32 v[98:99], v[98:99], v[106:107]
    v_pk_mul_f32 v[100:101], v[100:101], v[108:109]
    v_pk_mul_f32 v[102:103], v[102:103], v[110:111]
    v_cvt_pk_bf16_f32 v112, v96, v97
    v_cvt_pk_bf16_f32 v113, v98, v99
    v_cvt_pk_bf16_f32 v114, v100, v101
    v_cvt_pk_bf16_f32 v115, v102, v103
    buffer_store_dwordx4 v[112:115], v2, s[32:35], s44 offen offset:0 sc1
    v_mfma_f32_32x32x16_bf16 v[144:159], a[4:7], v[32:35], 0
    v_mfma_f32_32x32x16_bf16 v[128:143], a[0:3], v[32:35], v[128:143]
    s_waitcnt vmcnt(13)
    v_max3_u32 v8, v40, v41, v42
    v_max3_u32 v9, v43, v44, v45
    v_mfma_f32_32x32x16_bf16 v[144:159], a[12:15], v[36:39], v[144:159]
    v_max3_u32 v8, v8, v46, v47
    v_max_u32 v8, v8, v9
    v_cmp_eq_u32 vcc, -1, v8
    v_mfma_f32_32x32x16_bf16 v[128:143], a[8:11], v[36:39], v[128:143]
    s_cbranch_vccnz rty_181
bk_182:
    v_mfma_f32_32x32x16_bf16 v[144:159], a[20:23], v[40:43], v[144:159]
    s_add_u32 s101, s56, 229376
    buffer_load_dwordx4 v[32:35], v2, s[32:35], s101 offen offset:512 sc1
    v_mfma_f32_32x32x16_bf16 v[128:143], a[16:19], v[40:43], v[128:143]
    s_waitcnt vmcnt(12)
    v_max3_u32 v8, v48, v49, v50
    v_max3_u32 v9, v51, v52, v53
    v_mfma_f32_32x32x16_bf16 v[144:159], a[28:31], v[44:47], v[144:159]
    s_add_u32 s101, s56, 243712
    buffer_load_dwordx4 v[36:39], v2, s[32:35], s101 offen offset:512 sc1
    v_max3_u32 v8, v8, v54, v55
    v_max_u32 v8, v8, v9
    v_cmp_eq_u32 vcc, -1, v8
    v_mfma_f32_32x32x16_bf16 v[128:143], a[24:27], v[44:47], v[128:143]
    s_cbranch_vccnz rty_183
bk_184:
    v_mfma_f32_32x32x16_bf16 v[144:159], a[36:39], v[48:51], v[144:159]
    s_add_u32 s101, s56, 258048
    buffer_load_dwordx4 v[40:43], v2, s[32:35], s101 offen offset:512 sc1
    v_mfma_f32_32x32x16_bf16 v[128:143], a[32:35], v[48:51], v[128:143]
    s_waitcnt vmcnt(12)
    v_max3_u32 v8, v56, v57, v58
    v_max3_u32 v9, v59, v60, v61
    v_mfma_f32_32x32x16_bf16 v[144:159], a[44:47], v[52:55], v[144:159]
    s_add_u32 s101, s56, 272384
    buffer_load_dwordx4 v[44:47], v2, s[32:35], s101 offen offset:512 sc1
    v_max3_u32 v8, v8, v62, v63
    v_max_u32 v8, v8, v9
    v_cmp_eq_u32 vcc, -1, v8
    v_mfma_f32_32x32x16_bf16 v[128:143], a[40:43], v[52:55], v[128:143]
    s_cbranch_vccnz rty_185
bk_186:
    v_mfma_f32_32x32x16_bf16 v[144:159], a[52:55], v[56:59], v[144:159]
    s_add_u32 s101, s56, 286720
    buffer_load_dwordx4 v[48:51], v2, s[32:35], s101 offen offset:512 sc1
    v_mfma_f32_32x32x16_bf16 v[128:143], a[48:51], v[56:59], v[128:143]
    s_waitcnt vmcnt(12)
    v_max3_u32 v8, v64, v65, v66
    v_max3_u32 v9, v67, v68, v69
    v_mfma_f32_32x32x16_bf16 v[144:159], a[60:63], v[60:63], v[144:159]
    s_add_u32 s101, s56, 301056
    buffer_load_dwordx4 v[52:55], v2, s[32:35], s101 offen offset:512 sc1
    v_max3_u32 v8, v8, v70, v71
    v_max_u32 v8, v8, v9
    v_cmp_eq_u32 vcc, -1, v8
    v_mfma_f32_32x32x16_bf16 v[128:143], a[56:59], v[60:63], v[128:143]
    s_cbranch_vccnz rty_187
bk_188:
    v_mfma_f32_32x32x16_bf16 v[144:159], a[68:71], v[64:67], v[144:159]
    s_add_u32 s101, s56, 315392
    buffer_load_dwordx4 v[56:59], v2, s[32:35], s101 offen offset:512 sc1
    v_mfma_f32_32x32x16_bf16 v[128:143], a[64:67], v[64:67], v[128:143]
    s_waitcnt vmcnt(12)
    v_max3_u32 v8, v72, v73, v74
    v_max3_u32 v9, v75, v76, v77
    v_mfma_f32_32x32x16_bf16 v[144:159], a[76:79], v[68:71], v[144:159]
    s_add_u32 s101, s56, 329728
    buffer_load_dwordx4 v[60:63], v2, s[32:35], s101 offen offset:512 sc1
    v_max3_u32 v8, v8, v78, v79
    v_max_u32 v8, v8, v9
    v_cmp_eq_u32 vcc, -1, v8
    v_mfma_f32_32x32x16_bf16 v[128:143], a[72:75], v[68:71], v[128:143]
    s_cbranch_vccnz rty_189
bk_190:
    v_mfma_f32_32x32x16_bf16 v[144:159], a[84:87], v[72:75], v[144:159]
    s_add_u32 s101, s56, 344064
    buffer_load_dwordx4 v[64:67], v2, s[32:35], s101 offen offset:512 sc1
    v_mfma_f32_32x32x16_bf16 v[128:143], a[80:83], v[72:75], v[128:143]
    s_waitcnt vmcnt(12)
    v_max3_u32 v8, v80, v81, v82
    v_max3_u32 v9, v83, v84, v85
    v_mfma_f32_32x32x16_bf16 v[144:159], a[92:95], v[76:79], v[144:159]
    s_add_u32 s101, s56, 358400
    buffer_load_dwordx4 v[68:71], v2, s[32:35], s101 offen offset:512 sc1
    v_max3_u32 v8, v8, v86, v87
    v_max_u32 v8, v8, v9
    v_cmp_eq_u32 vcc, -1, v8
    v_mfma_f32_32x32x16_bf16 v[128:143], a[88:91], v[76:79], v[128:143]
    s_cbranch_vccnz rty_191
bk_192:
    v_mfma_f32_32x32x16_bf16 v[144:159], a[100:103], v[80:83], v[144:159]
    s_add_u32 s101, s56, 372736
    buffer_load_dwordx4 v[72:75], v2, s[32:35], s101 offen offset:512 sc1
    v_mfma_f32_32x32x16_bf16 v[128:143], a[96:99], v[80:83], v[128:143]
    s_waitcnt vmcnt(12)
    v_max3_u32 v8, v88, v89, v90
    v_max3_u32 v9, v91, v92, v93
    v_mfma_f32_32x32x16_bf16 v[144:159], a[108:111], v[84:87], v[144:159]
    s_add_u32 s101, s56, 387072
    buffer_load_dwordx4 v[76:79], v2, s[32:35], s101 offen offset:512 sc1
    v_max3_u32 v8, v8, v94, v95
    v_max_u32 v8, v8, v9
    v_cmp_eq_u32 vcc, -1, v8
    v_mfma_f32_32x32x16_bf16 v[128:143], a[104:107], v[84:87], v[128:143]
    s_cbranch_vccnz rty_193
bk_194:
    v_mfma_f32_32x32x16_bf16 v[144:159], a[116:119], v[88:91], v[144:159]
    s_add_u32 s101, s56, 401408
    buffer_load_dwordx4 v[80:83], v2, s[32:35], s101 offen offset:512 sc1
    v_mfma_f32_32x32x16_bf16 v[128:143], a[112:115], v[88:91], v[128:143]
    s_waitcnt vmcnt(11)
    v_max3_u32 v8, v32, v33, v34
    v_max3_u32 v9, v35, v36, v37
    v_mfma_f32_32x32x16_bf16 v[144:159], a[124:127], v[92:95], v[144:159]
    s_add_u32 s101, s56, 415744
    buffer_load_dwordx4 v[84:87], v2, s[32:35], s101 offen offset:512 sc1
    v_max3_u32 v8, v8, v38, v39
    v_max_u32 v8, v8, v9
    v_cmp_eq_u32 vcc, -1, v8
    v_mfma_f32_32x32x16_bf16 v[128:143], a[120:123], v[92:95], v[128:143]
    s_cbranch_vccnz rty_195
bk_196:
    v_mfma_f32_32x32x16_bf16 v[144:159], a[132:135], v[32:35], v[144:159]
    v_mfma_f32_32x32x16_bf16 v[128:143], a[128:131], v[32:35], v[128:143]
    s_waitcnt vmcnt(10)
    v_max3_u32 v8, v40, v41, v42
    v_max3_u32 v9, v43, v44, v45
    v_mfma_f32_32x32x16_bf16 v[144:159], a[140:143], v[36:39], v[144:159]
    v_max3_u32 v8, v8, v46, v47
    v_max_u32 v8, v8, v9
    v_cmp_eq_u32 vcc, -1, v8
    v_mfma_f32_32x32x16_bf16 v[128:143], a[136:139], v[36:39], v[128:143]
    s_cbranch_vccnz rty_197
bk_198:
    v_mfma_f32_32x32x16_bf16 v[144:159], a[148:151], v[40:43], v[144:159]
    s_add_u32 s101, s56, 430080
    buffer_load_dwordx4 v[88:91], v2, s[32:35], s101 offen offset:512 sc1
    v_mfma_f32_32x32x16_bf16 v[128:143], a[144:147], v[40:43], v[128:143]
    s_waitcnt vmcnt(9)
    v_max3_u32 v8, v48, v49, v50
    v_max3_u32 v9, v51, v52, v53
    v_mfma_f32_32x32x16_bf16 v[144:159], a[156:159], v[44:47], v[144:159]
    s_add_u32 s101, s56, 444416
    buffer_load_dwordx4 v[92:95], v2, s[32:35], s101 offen offset:512 sc1
    v_max3_u32 v8, v8, v54, v55
    v_max_u32 v8, v8, v9
    v_cmp_eq_u32 vcc, -1, v8
    v_mfma_f32_32x32x16_bf16 v[128:143], a[152:155], v[44:47], v[128:143]
    s_cbranch_vccnz rty_199
bk_200:
    v_mfma_f32_32x32x16_bf16 v[144:159], a[164:167], v[48:51], v[144:159]
    s_add_u32 s101, s57, 0
    buffer_load_dwordx4 v[32:35], v3, s[32:35], s101 offen offset:0 sc1
    v_mfma_f32_32x32x16_bf16 v[128:143], a[160:163], v[48:51], v[128:143]
    s_waitcnt vmcnt(9)
    v_max3_u32 v8, v56, v57, v58
    v_max3_u32 v9, v59, v60, v61
    v_mfma_f32_32x32x16_bf16 v[144:159], a[172:175], v[52:55], v[144:159]
    s_add_u32 s101, s57, 14336
    buffer_load_dwordx4 v[36:39], v3, s[32:35], s101 offen offset:0 sc1
    v_max3_u32 v8, v8, v62, v63
    v_max_u32 v8, v8, v9
    v_cmp_eq_u32 vcc, -1, v8
    v_mfma_f32_32x32x16_bf16 v[128:143], a[168:171], v[52:55], v[128:143]
    s_cbranch_vccnz rty_201
bk_202:
    v_mfma_f32_32x32x16_bf16 v[144:159], a[180:183], v[56:59], v[144:159]
    s_add_u32 s101, s57, 28672
    buffer_load_dwordx4 v[40:43], v3, s[32:35], s101 offen offset:0 sc1
    v_mfma_f32_32x32x16_bf16 v[128:143], a[176:179], v[56:59], v[128:143]
    s_waitcnt vmcnt(9)
    v_max3_u32 v8, v64, v65, v66
    v_max3_u32 v9, v67, v68, v69
    v_mfma_f32_32x32x16_bf16 v[144:159], a[188:191], v[60:63], v[144:159]
    s_add_u32 s101, s57, 43008
    buffer_load_dwordx4 v[44:47], v3, s[32:35], s101 offen offset:0 sc1
    v_max3_u32 v8, v8, v70, v71
    v_max_u32 v8, v8, v9
    v_cmp_eq_u32 vcc, -1, v8
    v_mfma_f32_32x32x16_bf16 v[128:143], a[184:187], v[60:63], v[128:143]
    s_cbranch_vccnz rty_203
bk_204:
    v_mfma_f32_32x32x16_bf16 v[144:159], a[196:199], v[64:67], v[144:159]
    s_add_u32 s101, s57, 57344
    buffer_load_dwordx4 v[48:51], v3, s[32:35], s101 offen offset:0 sc1
    v_mfma_f32_32x32x16_bf16 v[128:143], a[192:195], v[64:67], v[128:143]
    s_waitcnt vmcnt(9)
    v_max3_u32 v8, v72, v73, v74
    v_max3_u32 v9, v75, v76, v77
    v_mfma_f32_32x32x16_bf16 v[144:159], a[204:207], v[68:71], v[144:159]
    s_add_u32 s101, s57, 71680
    buffer_load_dwordx4 v[52:55], v3, s[32:35], s101 offen offset:0 sc1
    v_max3_u32 v8, v8, v78, v79
    v_max_u32 v8, v8, v9
    v_cmp_eq_u32 vcc, -1, v8
    v_mfma_f32_32x32x16_bf16 v[128:143], a[200:203], v[68:71], v[128:143]
    s_cbranch_vccnz rty_205
bk_206:
    s_barrier
    v_mfma_f32_32x32x16_bf16 v[144:159], a[212:215], v[72:75], v[144:159]
    s_add_u32 s101, s57, 86016
    buffer_load_dwordx4 v[56:59], v3, s[32:35], s101 offen offset:0 sc1
    v_mfma_f32_32x32x16_bf16 v[128:143], a[208:211], v[72:75], v[128:143]
    s_waitcnt vmcnt(9)
    v_max3_u32 v8, v80, v81, v82
    v_max3_u32 v9, v83, v84, v85
    v_mfma_f32_32x32x16_bf16 v[144:159], a[220:223], v[76:79], v[144:159]
    s_add_u32 s101, s57, 100352
    buffer_load_dwordx4 v[60:63], v3, s[32:35], s101 offen offset:0 sc1
    v_max3_u32 v8, v8, v86, v87
    v_max_u32 v8, v8, v9
    v_cmp_eq_u32 vcc, -1, v8
    v_mfma_f32_32x32x16_bf16 v[128:143], a[216:219], v[76:79], v[128:143]
    s_cbranch_vccnz rty_207
bk_208:
    v_mfma_f32_32x32x16_bf16 v[144:159], a[228:231], v[80:83], v[144:159]
    s_add_u32 s101, s57, 114688
    buffer_load_dwordx4 v[64:67], v3, s[32:35], s101 offen offset:0 sc1
    v_mfma_f32_32x32x16_bf16 v[128:143], a[224:227], v[80:83], v[128:143]
    s_waitcnt vmcnt(9)
    v_max3_u32 v8, v88, v89, v90
    v_max3_u32 v9, v91, v92, v93
    v_mfma_f32_32x32x16_bf16 v[144:159], a[236:239], v[84:87], v[144:159]
    s_add_u32 s101, s57, 129024
    buffer_load_dwordx4 v[68:71], v3, s[32:35], s101 offen offset:0 sc1
    v_max3_u32 v8, v8, v94, v95
    v_max_u32 v8, v8, v9
    v_cmp_eq_u32 vcc, -1, v8
    v_mfma_f32_32x32x16_bf16 v[128:143], a[232:235], v[84:87], v[128:143]
    s_cbranch_vccnz rty_209
bk_210:
    v_mfma_f32_32x32x16_bf16 v[144:159], a[244:247], v[88:91], v[144:159]
    s_add_u32 s101, s57, 143360
    buffer_load_dwordx4 v[72:75], v3, s[32:35], s101 offen offset:0 sc1
    v_mfma_f32_32x32x16_bf16 v[128:143], a[240:243], v[88:91], v[128:143]
    s_waitcnt vmcnt(9)
    v_max3_u32 v8, v32, v33, v34
    v_max3_u32 v9, v35, v36, v37
    v_mfma_f32_32x32x16_bf16 v[144:159], a[252:255], v[92:95], v[144:159]
    s_add_u32 s101, s57, 157696
    buffer_load_dwordx4 v[76:79], v3, s[32:35], s101 offen offset:0 sc1
    v_max3_u32 v8, v8, v38, v39
    v_max_u32 v8, v8, v9
    v_cmp_eq_u32 vcc, -1, v8
    v_mfma_f32_32x32x16_bf16 v[128:143], a[248:251], v[92:95], v[128:143]
    s_cbranch_vccnz rty_211
bk_212:
    v_lshlrev_b32 v96, 16, v26
    v_mov_b32 v104, 0
    v_lshlrev_b32 v97, 16, v26
    v_mov_b32 v105, 0
    v_lshlrev_b32 v98, 16, v26
    v_mov_b32 v106, 0
    v_lshlrev_b32 v99, 16, v26
    v_mov_b32 v107, 0
    v_lshlrev_b32 v100, 16, v26
    v_mov_b32 v108, 0
    v_lshlrev_b32 v101, 16, v26
    v_mov_b32 v109, 0
    v_lshlrev_b32 v102, 16, v26
    v_mov_b32 v110, 0
    v_lshlrev_b32 v103, 16, v26
    v_mov_b32 v111, 0
    ds_write_b128 v12, v[144:147] offset:2048
    ds_write_b128 v12, v[148:151] offset:3072
    ds_write_b128 v13, v[152:155] offset:4096
    ds_write_b128 v13, v[156:159] offset:5120
    ds_write_b128 v11, v[136:139] offset:0
    ds_write_b128 v11, v[140:143] offset:1024
    s_waitcnt lgkmcnt(0)
    s_barrier
    ds_read_b128 v[136:139], v10 offset:0
    ds_read_b128 v[140:143], v10 offset:1024
    ds_read_b128 v[144:147], v10 offset:2048
    ds_read_b128 v[148:151], v10 offset:3072
    ds_read_b128 v[152:155], v10 offset:4096
    ds_read_b128 v[156:159], v10 offset:5120
    s_waitcnt lgkmcnt(4)
    v_pk_add_f32 v[128:129], v[128:129], v[136:137]
    v_pk_add_f32 v[130:131], v[130:131], v[138:139]
    v_pk_add_f32 v[132:133], v[132:133], v[140:141]
    v_pk_add_f32 v[134:135], v[134:135], v[142:143]
    s_waitcnt lgkmcnt(2)
    v_pk_add_f32 v[128:129], v[128:129], v[144:145]
    v_pk_add_f32 v[130:131], v[130:131], v[146:147]
    v_pk_add_f32 v[132:133], v[132:133], v[148:149]
    v_pk_add_f32 v[134:135], v[134:135], v[150:151]
    s_waitcnt lgkmcnt(0)
    v_pk_add_f32 v[128:129], v[128:129], v[152:153]
    v_pk_add_f32 v[130:131], v[130:131], v[154:155]
    v_pk_add_f32 v[132:133], v[132:133], v[156:157]
    v_pk_add_f32 v[134:135], v[134:135], v[158:159]
    v_pk_mul_f32 v[136:137], v[128:129], v[128:129]
    v_pk_mul_f32 v[138:139], v[130:131], v[130:131]
    v_pk_mul_f32 v[140:141], v[132:133], v[132:133]
    v_pk_mul_f32 v[142:143], v[134:135], v[134:135]
    v_pk_fma_f32 v[136:137], v[136:137], s[42:43], v[26:27] op_sel:[0,0,1] op_sel_hi:[1,1,1]
    v_pk_fma_f32 v[138:139], v[138:139], s[42:43], v[26:27] op_sel:[0,0,1] op_sel_hi:[1,1,1]
    v_pk_fma_f32 v[140:141], v[140:141], s[42:43], v[26:27] op_sel:[0,0,1] op_sel_hi:[1,1,1]
    v_pk_fma_f32 v[142:143], v[142:143], s[42:43], v[26:27] op_sel:[0,0,1] op_sel_hi:[1,1,1]
    v_pk_mul_f32 v[136:137], v[136:137], v[128:129]
    v_pk_mul_f32 v[138:139], v[138:139], v[130:131]
    v_pk_mul_f32 v[140:141], v[140:141], v[132:133]
    v_pk_mul_f32 v[142:143], v[142:143], v[134:135]
    v_exp_f32 v136, v136
    v_exp_f32 v137, v137
    v_exp_f32 v138, v138
    v_exp_f32 v139, v139
    v_exp_f32 v140, v140
    v_exp_f32 v141, v141
    v_exp_f32 v142, v142
    v_exp_f32 v143, v143
    v_pk_add_f32 v[136:137], v[136:137], 1.0 op_sel_hi:[1,0]
    v_pk_add_f32 v[138:139], v[138:139], 1.0 op_sel_hi:[1,0]
    v_pk_add_f32 v[140:141], v[140:141], 1.0 op_sel_hi:[1,0]
    v_pk_add_f32 v[142:143], v[142:143], 1.0 op_sel_hi:[1,0]
    v_rcp_f32 v136, v136
    v_rcp_f32 v137, v137
    v_rcp_f32 v138, v138
    v_rcp_f32 v139, v139
    v_rcp_f32 v140, v140
    v_rcp_f32 v141, v141
    v_rcp_f32 v142, v142
    v_rcp_f32 v143, v143
    v_pk_mul_f32 v[128:129], v[128:129], v[136:137]
    v_pk_mul_f32 v[130:131], v[130:131], v[138:139]
    v_pk_mul_f32 v[132:133], v[132:133], v[140:141]
    v_pk_mul_f32 v[134:135], v[134:135], v[142:143]
    v_cvt_pk_bf16_f32 v144, v128, v129
    v_cvt_pk_bf16_f32 v145, v130, v131
    v_cvt_pk_bf16_f32 v146, v132, v133
    v_cvt_pk_bf16_f32 v147, v134, v135
    buffer_store_dwordx4 v[144:147], v2, s[32:35], s44 offen offset:512 sc1
b2e_146:
    v_mfma_f32_32x32x16_bf16 v[112:127], v[32:35], v[164:167], 0
    s_add_u32 s101, s57, 172032
    buffer_load_dwordx4 v[80:83], v3, s[32:35], s101 offen offset:0 sc1
    v_mfma_f32_32x32x16_bf16 v[96:111], v[32:35], v[160:163], v[96:111]
    s_waitcnt vmcnt(10)
    v_max3_u32 v8, v40, v41, v42
    v_max3_u32 v9, v43, v44, v45
    v_mfma_f32_32x32x16_bf16 v[112:127], v[36:39], v[172:175], v[112:127]
    s_add_u32 s101, s57, 186368
    buffer_load_dwordx4 v[84:87], v3, s[32:35], s101 offen offset:0 sc1
    v_max3_u32 v8, v8, v46, v47
    v_max_u32 v8, v8, v9
    v_cmp_eq_u32 vcc, -1, v8
    v_mfma_f32_32x32x16_bf16 v[96:111], v[36:39], v[168:171], v[96:111]
    s_cbranch_vccnz rty_213
bk_214:
    v_mfma_f32_32x32x16_bf16 v[112:127], v[40:43], v[180:183], v[112:127]
    s_add_u32 s101, s57, 200704
    buffer_load_dwordx4 v[88:91], v3, s[32:35], s101 offen offset:0 sc1
    v_mfma_f32_32x32x16_bf16 v[96:111], v[40:43], v[176:179], v[96:111]
    s_waitcnt vmcnt(10)
    v_max3_u32 v8, v48, v49, v50
    v_max3_u32 v9, v51, v52, v53
    v_mfma_f32_32x32x16_bf16 v[112:127], v[44:47], v[188:191], v[112:127]
    s_add_u32 s101, s57, 215040
    buffer_load_dwordx4 v[92:95], v3, s[32:35], s101 offen offset:0 sc1
    v_max3_u32 v8, v8, v54, v55
    v_max_u32 v8, v8, v9
    v_cmp_eq_u32 vcc, -1, v8
    v_mfma_f32_32x32x16_bf16 v[96:111], v[44:47], v[184:187], v[96:111]
    s_cbranch_vccnz rty_215
bk_216:
    v_mfma_f32_32x32x16_bf16 v[112:127], v[48:51], v[196:199], v[112:127]
    s_add_u32 s101, s57, 229376
    buffer_load_dwordx4 v[32:35], v3, s[32:35], s101 offen offset:0 sc1
    v_mfma_f32_32x32x16_bf16 v[96:111], v[48:51], v[192:195], v[96:111]
    s_waitcnt vmcnt(10)
    v_max3_u32 v8, v56, v57, v58
    v_max3_u32 v9, v59, v60, v61
    v_mfma_f32_32x32x16_bf16 v[112:127], v[52:55], v[204:207], v[112:127]
    s_add_u32 s101, s57, 243712
    buffer_load_dwordx4 v[36:39], v3, s[32:35], s101 offen offset:0 sc1
    v_max3_u32 v8, v8, v62, v63
    v_max_u32 v8, v8, v9
    v_cmp_eq_u32 vcc, -1, v8
    v_mfma_f32_32x32x16_bf16 v[96:111], v[52:55], v[200:203], v[96:111]
    s_cbranch_vccnz rty_217
bk_218:
    v_mfma_f32_32x32x16_bf16 v[112:127], v[56:59], v[212:215], v[112:127]
    s_add_u32 s101, s57, 258048
    buffer_load_dwordx4 v[40:43], v3, s[32:35], s101 offen offset:0 sc1
    v_mfma_f32_32x32x16_bf16 v[96:111], v[56:59], v[208:211], v[96:111]
    s_waitcnt vmcnt(10)
    v_max3_u32 v8, v64, v65, v66
    v_max3_u32 v9, v67, v68, v69
    v_mfma_f32_32x32x16_bf16 v[112:127], v[60:63], v[220:223], v[112:127]
    s_add_u32 s101, s57, 272384
    buffer_load_dwordx4 v[44:47], v3, s[32:35], s101 offen offset:0 sc1
    v_max3_u32 v8, v8, v70, v71
    v_max_u32 v8, v8, v9
    v_cmp_eq_u32 vcc, -1, v8
    v_mfma_f32_32x32x16_bf16 v[96:111], v[60:63], v[216:219], v[96:111]
    s_cbranch_vccnz rty_219
bk_220:
    s_barrier
    v_mfma_f32_32x32x16_bf16 v[112:127], v[64:67], v[228:231], v[112:127]
    s_add_u32 s101, s57, 286720
    buffer_load_dwordx4 v[48:51], v3, s[32:35], s101 offen offset:0 sc1
    v_mfma_f32_32x32x16_bf16 v[96:111], v[64:67], v[224:227], v[96:111]
    s_waitcnt vmcnt(10)
    v_max3_u32 v8, v72, v73, v74
    v_max3_u32 v9, v75, v76, v77
    v_mfma_f32_32x32x16_bf16 v[112:127], v[68:71], v[236:239], v[112:127]
    s_add_u32 s101, s57, 301056
    buffer_load_dwordx4 v[52:55], v3, s[32:35], s101 offen offset:0 sc1
    v_max3_u32 v8, v8, v78, v79
    v_max_u32 v8, v8, v9
    v_cmp_eq_u32 vcc, -1, v8
    v_mfma_f32_32x32x16_bf16 v[96:111], v[68:71], v[232:235], v[96:111]
    s_cbranch_vccnz rty_221
bk_222:
    v_mfma_f32_32x32x16_bf16 v[112:127], v[72:75], v[244:247], v[112:127]
    s_add_u32 s101, s57, 315392
    buffer_load_dwordx4 v[56:59], v3, s[32:35], s101 offen offset:0 sc1
    ds_read_b64_tr_b16 v[128:129], v4 offset:0
    ds_read_b64_tr_b16 v[130:131], v4 offset:1024
    ds_read_b64_tr_b16 v[132:133], v5 offset:0
    v_mfma_f32_32x32x16_bf16 v[96:111], v[72:75], v[240:243], v[96:111]
    ds_read_b64_tr_b16 v[134:135], v5 offset:1024
    ds_read_b64_tr_b16 v[136:137], v4 offset:2048
    ds_read_b64_tr_b16 v[138:139], v4 offset:3072
    s_waitcnt vmcnt(9)
    v_max3_u32 v8, v80, v81, v82
    v_max3_u32 v9, v83, v84, v85
    v_mfma_f32_32x32x16_bf16 v[112:127], v[76:79], v[252:255], v[112:127]
    s_add_u32 s101, s57, 329728
    buffer_load_dwordx4 v[60:63], v3, s[32:35], s101 offen offset:0 sc1
    ds_read_b64_tr_b16 v[140:141], v5 offset:2048
    ds_read_b64_tr_b16 v[142:143], v5 offset:3072
    v_max3_u32 v8, v8, v86, v87
    v_max_u32 v8, v8, v9
    v_cmp_eq_u32 vcc, -1, v8
    v_mfma_f32_32x32x16_bf16 v[96:111], v[76:79], v[248:251], v[96:111]
    s_cbranch_vccnz rty_223
bk_224:
    s_waitcnt lgkmcnt(0)
    v_mfma_f32_32x32x16_bf16 v[112:127], v[80:83], v[132:135], v[112:127]
    s_add_u32 s101, s57, 344064
    buffer_load_dwordx4 v[64:67], v3, s[32:35], s101 offen offset:0 sc1
    ds_read_b64_tr_b16 v[144:145], v4 offset:4096
    ds_read_b64_tr_b16 v[146:147], v4 offset:5120
    ds_read_b64_tr_b16 v[148:149], v5 offset:4096
    v_mfma_f32_32x32x16_bf16 v[96:111], v[80:83], v[128:131], v[96:111]
    ds_read_b64_tr_b16 v[150:151], v5 offset:5120
    ds_read_b64_tr_b16 v[152:153], v4 offset:6144
    ds_read_b64_tr_b16 v[154:155], v4 offset:7168
    s_waitcnt vmcnt(9)
    v_max3_u32 v8, v88, v89, v90
    v_max3_u32 v9, v91, v92, v93
    v_mfma_f32_32x32x16_bf16 v[112:127], v[84:87], v[140:143], v[112:127]
    s_add_u32 s101, s57, 358400
    buffer_load_dwordx4 v[68:71], v3, s[32:35], s101 offen offset:0 sc1
    ds_read_b64_tr_b16 v[156:157], v5 offset:6144
    ds_read_b64_tr_b16 v[158:159], v5 offset:7168
    v_max3_u32 v8, v8, v94, v95
    v_max_u32 v8, v8, v9
    v_cmp_eq_u32 vcc, -1, v8
    v_mfma_f32_32x32x16_bf16 v[96:111], v[84:87], v[136:139], v[96:111]
    s_cbranch_vccnz rty_225
bk_226:
    s_waitcnt lgkmcnt(0)
    v_mfma_f32_32x32x16_bf16 v[112:127], v[88:91], v[148:151], v[112:127]
    s_add_u32 s101, s57, 372736
    buffer_load_dwordx4 v[72:75], v3, s[32:35], s101 offen offset:0 sc1
    ds_read_b64_tr_b16 v[128:129], v4 offset:8192
    ds_read_b64_tr_b16 v[130:131], v4 offset:9216
    ds_read_b64_tr_b16 v[132:133], v5 offset:8192
    v_mfma_f32_32x32x16_bf16 v[96:111], v[88:91], v[144:147], v[96:111]
    ds_read_b64_tr_b16 v[134:135], v5 offset:9216
    ds_read_b64_tr_b16 v[136:137], v4 offset:10240
    ds_read_b64_tr_b16 v[138:139], v4 offset:11264
    s_waitcnt vmcnt(9)
    v_max3_u32 v8, v32, v33, v34
    v_max3_u32 v9, v35, v36, v37
    v_mfma_f32_32x32x16_bf16 v[112:127], v[92:95], v[156:159], v[112:127]
    s_add_u32 s101, s57, 387072
    buffer_load_dwordx4 v[76:79], v3, s[32:35], s101 offen offset:0 sc1
    ds_read_b64_tr_b16 v[140:141], v5 offset:10240
    ds_read_b64_tr_b16 v[142:143], v5 offset:11264
    v_max3_u32 v8, v8, v38, v39
    v_max_u32 v8, v8, v9
    v_cmp_eq_u32 vcc, -1, v8
    v_mfma_f32_32x32x16_bf16 v[96:111], v[92:95], v[152:155], v[96:111]
    s_cbranch_vccnz rty_227
bk_228:
    s_waitcnt lgkmcnt(0)
    v_mfma_f32_32x32x16_bf16 v[112:127], v[32:35], v[132:135], v[112:127]
    s_add_u32 s101, s57, 0
    buffer_load_dwordx4 v[80:83], v3, s[32:35], s101 offen offset:512 sc1
    ds_read_b64_tr_b16 v[144:145], v4 offset:12288
    ds_read_b64_tr_b16 v[146:147], v4 offset:13312
    ds_read_b64_tr_b16 v[148:149], v5 offset:12288
    v_mfma_f32_32x32x16_bf16 v[96:111], v[32:35], v[128:131], v[96:111]
    ds_read_b64_tr_b16 v[150:151], v5 offset:13312
    ds_read_b64_tr_b16 v[152:153], v4 offset:14336
    ds_read_b64_tr_b16 v[154:155], v4 offset:15360
    s_waitcnt vmcnt(9)
    v_max3_u32 v8, v40, v41, v42
    v_max3_u32 v9, v43, v44, v45
    v_mfma_f32_32x32x16_bf16 v[112:127], v[36:39], v[140:143], v[112:127]
    s_add_u32 s101, s57, 14336
    buffer_load_dwordx4 v[84:87], v3, s[32:35], s101 offen offset:512 sc1
    ds_read_b64_tr_b16 v[156:157], v5 offset:14336
    ds_read_b64_tr_b16 v[158:159], v5 offset:15360
    v_max3_u32 v8, v8, v46, v47
    v_max_u32 v8, v8, v9
    v_cmp_eq_u32 vcc, -1, v8
    v_mfma_f32_32x32x16_bf16 v[96:111], v[36:39], v[136:139], v[96:111]
    s_cbranch_vccnz rty_229
bk_230:
    s_waitcnt lgkmcnt(0)
    v_lshrrev_b32 v15, 6, v0
    v_bfe_u32 v9, v0, 3, 3
    v_lshl_add_u32 v9, v15, 4, v9
    s_lshl_b32 s59, s52, 6
    v_add_u32 v24, s59, v9
    v_mul_u32_u24 v24, 896, v24
    v_and_b32 v15, 7, v0
    v_lshl_add_u32 v24, v15, 4, v24
    s_mul_i32 s59, s50, 128
    v_add_u32 v24, s59, v24
    v_add_u32 v25, 7168, v24
    v_xor_b32 v15, v15, v9
    v_and_b32 v15, 7, v15
    v_lshlrev_b32 v14, 7, v9
    v_lshl_add_u32 v14, v15, 4, v14
    v_add_u32 v14, 0x26000, v14
    v_mfma_f32_32x32x16_bf16 v[112:127], v[40:43], v[148:151], v[112:127]
    s_add_u32 s101, s57, 28672
    buffer_load_dwordx4 v[88:91], v3, s[32:35], s101 offen offset:512 sc1
    ds_read_b64_tr_b16 v[128:129], v4 offset:16384
    ds_read_b64_tr_b16 v[130:131], v4 offset:17408
    ds_read_b64_tr_b16 v[132:133], v5 offset:16384
    v_mfma_f32_32x32x16_bf16 v[96:111], v[40:43], v[144:147], v[96:111]
    ds_read_b64_tr_b16 v[134:135], v5 offset:17408
    ds_read_b64_tr_b16 v[136:137], v4 offset:18432
    ds_read_b64_tr_b16 v[138:139], v4 offset:19456
    s_waitcnt vmcnt(9)
    v_max3_u32 v8, v48, v49, v50
    v_max3_u32 v9, v51, v52, v53
    v_mfma_f32_32x32x16_bf16 v[112:127], v[44:47], v[156:159], v[112:127]
    s_add_u32 s101, s57, 43008
    buffer_load_dwordx4 v[92:95], v3, s[32:35], s101 offen offset:512 sc1
    ds_read_b64_tr_b16 v[140:141], v5 offset:18432
    ds_read_b64_tr_b16 v[142:143], v5 offset:19456
    v_max3_u32 v8, v8, v54, v55
    v_max_u32 v8, v8, v9
    v_cmp_eq_u32 vcc, -1, v8
    v_mfma_f32_32x32x16_bf16 v[96:111], v[44:47], v[152:155], v[96:111]
    s_cbranch_vccnz rty_231
bk_232:
    s_waitcnt lgkmcnt(0)
    v_bfe_u32 v9, v0, 7, 1
    v_lshlrev_b32 v9, 5, v9
    v_and_b32 v15, 31, v0
    v_add_u32 v9, v9, v15
    v_bfe_u32 v15, v0, 6, 1
    v_lshlrev_b32 v15, 1, v15
    v_xor_b32 v15, v15, v9
    v_and_b32 v15, 7, v15
    v_lshlrev_b32 v7, 7, v9
    v_lshl_add_u32 v7, v15, 4, v7
    v_bfe_u32 v15, v0, 5, 1
    v_lshl_add_u32 v7, v15, 3, v7
    v_add_u32 v7, 0x26000, v7
    v_mfma_f32_32x32x16_bf16 v[112:127], v[48:51], v[132:135], v[112:127]
    s_add_u32 s101, s57, 57344
    buffer_load_dwordx4 v[32:35], v3, s[32:35], s101 offen offset:512 sc1
    ds_read_b64_tr_b16 v[144:145], v4 offset:20480
    ds_read_b64_tr_b16 v[146:147], v4 offset:21504
    ds_read_b64_tr_b16 v[148:149], v5 offset:20480
    v_mfma_f32_32x32x16_bf16 v[96:111], v[48:51], v[128:131], v[96:111]
    ds_read_b64_tr_b16 v[150:151], v5 offset:21504
    ds_read_b64_tr_b16 v[152:153], v4 offset:22528
    ds_read_b64_tr_b16 v[154:155], v4 offset:23552
    s_waitcnt vmcnt(9)
    v_max3_u32 v8, v56, v57, v58
    v_max3_u32 v9, v59, v60, v61
    v_mfma_f32_32x32x16_bf16 v[112:127], v[52:55], v[140:143], v[112:127]
    s_add_u32 s101, s57, 71680
    buffer_load_dwordx4 v[36:39], v3, s[32:35], s101 offen offset:512 sc1
    ds_read_b64_tr_b16 v[156:157], v5 offset:22528
    ds_read_b64_tr_b16 v[158:159], v5 offset:23552
    v_max3_u32 v8, v8, v62, v63
    v_max_u32 v8, v8, v9
    v_cmp_eq_u32 vcc, -1, v8
    v_mfma_f32_32x32x16_bf16 v[96:111], v[52:55], v[136:139], v[96:111]
    s_cbranch_vccnz rty_233
bk_234:
    s_waitcnt lgkmcnt(0)
    v_mfma_f32_32x32x16_bf16 v[112:127], v[56:59], v[148:151], v[112:127]
    s_add_u32 s101, s57, 86016
    buffer_load_dwordx4 v[40:43], v3, s[32:35], s101 offen offset:512 sc1
    ds_read_b64_tr_b16 v[128:129], v4 offset:24576
    ds_read_b64_tr_b16 v[130:131], v4 offset:25600
    ds_read_b64_tr_b16 v[132:133], v5 offset:24576
    v_mfma_f32_32x32x16_bf16 v[96:111], v[56:59], v[144:147], v[96:111]
    ds_read_b64_tr_b16 v[134:135], v5 offset:25600
    ds_read_b64_tr_b16 v[136:137], v4 offset:26624
    ds_read_b64_tr_b16 v[138:139], v4 offset:27648
    s_waitcnt vmcnt(9)
    v_max3_u32 v8, v64, v65, v66
    v_max3_u32 v9, v67, v68, v69
    v_mfma_f32_32x32x16_bf16 v[112:127], v[60:63], v[156:159], v[112:127]
    s_add_u32 s101, s57, 100352
    buffer_load_dwordx4 v[44:47], v3, s[32:35], s101 offen offset:512 sc1
    ds_read_b64_tr_b16 v[140:141], v5 offset:26624
    ds_read_b64_tr_b16 v[142:143], v5 offset:27648
    v_max3_u32 v8, v8, v70, v71
    v_max_u32 v8, v8, v9
    v_cmp_eq_u32 vcc, -1, v8
    v_mfma_f32_32x32x16_bf16 v[96:111], v[60:63], v[152:155], v[96:111]
    s_cbranch_vccnz rty_235
bk_236:
    s_waitcnt lgkmcnt(0)
    v_mfma_f32_32x32x16_bf16 v[112:127], v[64:67], v[132:135], v[112:127]
    s_add_u32 s101, s57, 114688
    buffer_load_dwordx4 v[48:51], v3, s[32:35], s101 offen offset:512 sc1
    ds_read_b64_tr_b16 v[144:145], v4 offset:28672
    ds_read_b64_tr_b16 v[146:147], v4 offset:29696
    ds_read_b64_tr_b16 v[148:149], v5 offset:28672
    v_mfma_f32_32x32x16_bf16 v[96:111], v[64:67], v[128:131], v[96:111]
    ds_read_b64_tr_b16 v[150:151], v5 offset:29696
    ds_read_b64_tr_b16 v[152:153], v4 offset:30720
    ds_read_b64_tr_b16 v[154:155], v4 offset:31744
    s_waitcnt vmcnt(9)
    v_max3_u32 v8, v72, v73, v74
    v_max3_u32 v9, v75, v76, v77
    v_mfma_f32_32x32x16_bf16 v[112:127], v[68:71], v[140:143], v[112:127]
    s_add_u32 s101, s57, 129024
    buffer_load_dwordx4 v[52:55], v3, s[32:35], s101 offen offset:512 sc1
    ds_read_b64_tr_b16 v[156:157], v5 offset:30720
    ds_read_b64_tr_b16 v[158:159], v5 offset:31744
    v_max3_u32 v8, v8, v78, v79
    v_max_u32 v8, v8, v9
    v_cmp_eq_u32 vcc, -1, v8
    v_mfma_f32_32x32x16_bf16 v[96:111], v[68:71], v[136:139], v[96:111]
    s_cbranch_vccnz rty_237
bk_238:
    s_waitcnt lgkmcnt(0)
    v_mfma_f32_32x32x16_bf16 v[112:127], v[72:75], v[148:151], v[112:127]
    s_add_u32 s101, s57, 143360
    buffer_load_dwordx4 v[56:59], v3, s[32:35], s101 offen offset:512 sc1
    v_mfma_f32_32x32x16_bf16 v[96:111], v[72:75], v[144:147], v[96:111]
    s_waitcnt vmcnt(9)
    v_max3_u32 v8, v80, v81, v82
    v_max3_u32 v9, v83, v84, v85
    v_mfma_f32_32x32x16_bf16 v[112:127], v[76:79], v[156:159], v[112:127]
    s_add_u32 s101, s57, 157696
    buffer_load_dwordx4 v[60:63], v3, s[32:35], s101 offen offset:512 sc1
    v_max3_u32 v8, v8, v86, v87
    v_max_u32 v8, v8, v9
    v_cmp_eq_u32 vcc, -1, v8
    v_mfma_f32_32x32x16_bf16 v[96:111], v[76:79], v[152:155], v[96:111]
    s_cbranch_vccnz rty_239
bk_240:
    v_lshlrev_b32 v128, 16, v26
    v_mov_b32 v136, 0
    v_lshlrev_b32 v129, 16, v26
    v_mov_b32 v137, 0
    v_lshlrev_b32 v130, 16, v26
    v_mov_b32 v138, 0
    v_lshlrev_b32 v131, 16, v26
    v_mov_b32 v139, 0
    v_lshlrev_b32 v132, 16, v26
    v_mov_b32 v140, 0
    v_lshlrev_b32 v133, 16, v26
    v_mov_b32 v141, 0
    v_lshlrev_b32 v134, 16, v26
    v_mov_b32 v142, 0
    v_lshlrev_b32 v135, 16, v26
    v_mov_b32 v143, 0
    s_add_u32 s101, s57, 172032
    buffer_load_dwordx4 v[64:67], v3, s[32:35], s101 offen offset:512 sc1
    s_add_u32 s101, s57, 186368
    buffer_load_dwordx4 v[68:71], v3, s[32:35], s101 offen offset:512 sc1
    s_add_u32 s101, s57, 200704
    buffer_load_dwordx4 v[72:75], v3, s[32:35], s101 offen offset:512 sc1
    s_add_u32 s101, s57, 215040
    buffer_load_dwordx4 v[76:79], v3, s[32:35], s101 offen offset:512 sc1
    v_mfma_f32_32x32x16_bf16 v[144:159], v[80:83], v[164:167], 0
    v_mfma_f32_32x32x16_bf16 v[128:143], v[80:83], v[160:163], v[128:143]
    ds_write_b128 v12, v[112:115] offset:2048
    ds_write_b128 v12, v[116:119] offset:3072
    ds_write_b128 v13, v[120:123] offset:4096
    ds_write_b128 v13, v[124:127] offset:5120
    ds_write_b128 v11, v[104:107] offset:0
    ds_write_b128 v11, v[108:111] offset:1024
    s_waitcnt vmcnt(12)
    v_max3_u32 v8, v88, v89, v90
    v_max3_u32 v9, v91, v92, v93
    v_mfma_f32_32x32x16_bf16 v[144:159], v[84:87], v[172:175], v[144:159]
    v_max3_u32 v8, v8, v94, v95
    v_max_u32 v8, v8, v9
    v_cmp_eq_u32 vcc, -1, v8
    v_mfma_f32_32x32x16_bf16 v[128:143], v[84:87], v[168:171], v[128:143]
    s_cbranch_vccnz rty_241
bk_242:
    s_waitcnt lgkmcnt(0)
    s_barrier
    ds_read_b128 v[104:107], v10 offset:0
    ds_read_b128 v[108:111], v10 offset:1024
    ds_read_b128 v[112:115], v10 offset:2048
    ds_read_b128 v[116:119], v10 offset:3072
    v_mfma_f32_32x32x16_bf16 v[144:159], v[88:91], v[180:183], v[144:159]
    s_add_u32 s101, s57, 229376
    buffer_load_dwordx4 v[80:83], v3, s[32:35], s101 offen offset:512 sc1
    v_mfma_f32_32x32x16_bf16 v[128:143], v[88:91], v[176:179], v[128:143]
    ds_read_b128 v[120:123], v10 offset:4096
    ds_read_b128 v[124:127], v10 offset:5120
    s_waitcnt vmcnt(11)
    v_max3_u32 v8, v32, v33, v34
    v_max3_u32 v9, v35, v36, v37
    v_mfma_f32_32x32x16_bf16 v[144:159], v[92:95], v[188:191], v[144:159]
    s_add_u32 s101, s57, 243712
    buffer_load_dwordx4 v[84:87], v3, s[32:35], s101 offen offset:512 sc1
    s_waitcnt lgkmcnt(4)
    v_add_f32 v96, v96, v104
    v_add_f32 v97, v97, v105
    v_add_f32 v98, v98, v106
    v_max3_u32 v8, v8, v38, v39
    v_max_u32 v8, v8, v9
    v_cmp_eq_u32 vcc, -1, v8
    v_mfma_f32_32x32x16_bf16 v[128:143], v[92:95], v[184:187], v[128:143]
    s_cbranch_vccnz rty_243
bk_244:
    v_add_f32 v99, v99, v107
    v_add_f32 v100, v100, v108
    v_add_f32 v101, v101, v109
    v_add_f32 v102, v102, v110
    v_add_f32 v103, v103, v111
    s_waitcnt lgkmcnt(2)
    v_mfma_f32_32x32x16_bf16 v[144:159], v[32:35], v[196:199], v[144:159]
    s_add_u32 s101, s57, 258048
    buffer_load_dwordx4 v[88:91], v3, s[32:35], s101 offen offset:512 sc1
    v_mfma_f32_32x32x16_bf16 v[128:143], v[32:35], v[192:195], v[128:143]
    v_add_f32 v96, v96, v112
    v_add_f32 v97, v97, v113
    v_add_f32 v98, v98, v114
    v_add_f32 v99, v99, v115
    v_add_f32 v100, v100, v116
    v_add_f32 v101, v101, v117
    s_waitcnt vmcnt(11)
    v_max3_u32 v8, v40, v41, v42
    v_max3_u32 v9, v43, v44, v45
    v_mfma_f32_32x32x16_bf16 v[144:159], v[36:39], v[204:207], v[144:159]
    s_add_u32 s101, s57, 272384
    buffer_load_dwordx4 v[92:95], v3, s[32:35], s101 offen offset:512 sc1
    v_add_f32 v102, v102, v118
    v_add_f32 v103, v103, v119
    s_waitcnt lgkmcnt(0)
    v_add_f32 v96, v96, v120
    v_max3_u32 v8, v8, v46, v47
    v_max_u32 v8, v8, v9
    v_cmp_eq_u32 vcc, -1, v8
    v_mfma_f32_32x32x16_bf16 v[128:143], v[36:39], v[200:203], v[128:143]
    s_cbranch_vccnz rty_245
bk_246:
    v_add_f32 v97, v97, v121
    v_add_f32 v98, v98, v122
    v_add_f32 v99, v99, v123
    v_add_f32 v100, v100, v124
    v_add_f32 v101, v101, v125
    v_add_f32 v102, v102, v126
    v_mfma_f32_32x32x16_bf16 v[144:159], v[40:43], v[212:215], v[144:159]
    s_add_u32 s101, s57, 286720
    buffer_load_dwordx4 v[32:35], v3, s[32:35], s101 offen offset:512 sc1
    v_mfma_f32_32x32x16_bf16 v[128:143], v[40:43], v[208:211], v[128:143]
    v_add_f32 v103, v103, v127
    v_cvt_pk_bf16_f32 v104, v96, v97
    v_cvt_pk_bf16_f32 v105, v98, v99
    v_cvt_pk_bf16_f32 v106, v100, v101
    v_cvt_pk_bf16_f32 v107, v102, v103
    v_xor_b32 v15, 0, v7
    s_waitcnt vmcnt(11)
    v_max3_u32 v8, v48, v49, v50
    v_max3_u32 v9, v51, v52, v53
    v_mfma_f32_32x32x16_bf16 v[144:159], v[44:47], v[220:223], v[144:159]
    s_add_u32 s101, s57, 301056
    buffer_load_dwordx4 v[36:39], v3, s[32:35], s101 offen offset:512 sc1
    ds_write_b64 v15, v[104:105]
    v_xor_b32 v15, 16, v7
    ds_write_b64 v15, v[106:107]
    v_max3_u32 v8, v8, v54, v55
    v_max_u32 v8, v8, v9
    v_cmp_eq_u32 vcc, -1, v8
    v_mfma_f32_32x32x16_bf16 v[128:143], v[44:47], v[216:219], v[128:143]
    s_cbranch_vccnz rty_247
bk_248:
    v_mfma_f32_32x32x16_bf16 v[144:159], v[48:51], v[228:231], v[144:159]
    s_add_u32 s101, s57, 315392
    buffer_load_dwordx4 v[40:43], v3, s[32:35], s101 offen offset:512 sc1
    v_mfma_f32_32x32x16_bf16 v[128:143], v[48:51], v[224:227], v[128:143]
    s_waitcnt vmcnt(11)
    v_max3_u32 v8, v56, v57, v58
    v_max3_u32 v9, v59, v60, v61
    v_mfma_f32_32x32x16_bf16 v[144:159], v[52:55], v[236:239], v[144:159]
    s_add_u32 s101, s57, 329728
    buffer_load_dwordx4 v[44:47], v3, s[32:35], s101 offen offset:512 sc1
    v_max3_u32 v8, v8, v62, v63
    v_max_u32 v8, v8, v9
    v_cmp_eq_u32 vcc, -1, v8
    v_mfma_f32_32x32x16_bf16 v[128:143], v[52:55], v[232:235], v[128:143]
    s_cbranch_vccnz rty_249
bk_250:
    v_mfma_f32_32x32x16_bf16 v[144:159], v[56:59], v[244:247], v[144:159]
    s_add_u32 s101, s57, 344064
    buffer_load_dwordx4 v[48:51], v3, s[32:35], s101 offen offset:512 sc1
    ds_read_b64_tr_b16 v[96:97], v4 offset:0
    ds_read_b64_tr_b16 v[98:99], v4 offset:1024
    ds_read_b64_tr_b16 v[100:101], v5 offset:0
    v_mfma_f32_32x32x16_bf16 v[128:143], v[56:59], v[240:243], v[128:143]
    ds_read_b64_tr_b16 v[102:103], v5 offset:1024
    ds_read_b64_tr_b16 v[104:105], v4 offset:2048
    ds_read_b64_tr_b16 v[106:107], v4 offset:3072
    s_waitcnt vmcnt(11)
    v_max3_u32 v8, v64, v65, v66
    v_max3_u32 v9, v67, v68, v69
    v_mfma_f32_32x32x16_bf16 v[144:159], v[60:63], v[252:255], v[144:159]
    s_add_u32 s101, s57, 358400
    buffer_load_dwordx4 v[52:55], v3, s[32:35], s101 offen offset:512 sc1
    ds_read_b64_tr_b16 v[108:109], v5 offset:2048
    ds_read_b64_tr_b16 v[110:111], v5 offset:3072
    v_max3_u32 v8, v8, v70, v71
    v_max_u32 v8, v8, v9
    v_cmp_eq_u32 vcc, -1, v8
    v_mfma_f32_32x32x16_bf16 v[128:143], v[60:63], v[248:251], v[128:143]
    s_cbranch_vccnz rty_251
bk_252:
    s_waitcnt lgkmcnt(0)
    v_mfma_f32_32x32x16_bf16 v[144:159], v[64:67], v[100:103], v[144:159]
    s_add_u32 s101, s57, 372736
    buffer_load_dwordx4 v[56:59], v3, s[32:35], s101 offen offset:512 sc1
    ds_read_b64_tr_b16 v[112:113], v4 offset:4096
    ds_read_b64_tr_b16 v[114:115], v4 offset:5120
    ds_read_b64_tr_b16 v[116:117], v5 offset:4096
    v_mfma_f32_32x32x16_bf16 v[128:143], v[64:67], v[96:99], v[128:143]
    ds_read_b64_tr_b16 v[118:119], v5 offset:5120
    ds_read_b64_tr_b16 v[120:121], v4 offset:6144
    ds_read_b64_tr_b16 v[122:123], v4 offset:7168
    s_waitcnt vmcnt(11)
    v_max3_u32 v8, v72, v73, v74
    v_max3_u32 v9, v75, v76, v77
    v_mfma_f32_32x32x16_bf16 v[144:159], v[68:71], v[108:111], v[144:159]
    s_add_u32 s101, s57, 387072
    buffer_load_dwordx4 v[60:63], v3, s[32:35], s101 offen offset:512 sc1
    ds_read_b64_tr_b16 v[124:125], v5 offset:6144
    ds_read_b64_tr_b16 v[126:127], v5 offset:7168
    v_max3_u32 v8, v8, v78, v79
    v_max_u32 v8, v8, v9
    v_cmp_eq_u32 vcc, -1, v8
    v_mfma_f32_32x32x16_bf16 v[128:143], v[68:71], v[104:107], v[128:143]
    s_cbranch_vccnz rty_253
bk_254:
    s_waitcnt lgkmcnt(0)
    v_mfma_f32_32x32x16_bf16 v[144:159], v[72:75], v[116:119], v[144:159]
    ds_read_b64_tr_b16 v[96:97], v4 offset:8192
    ds_read_b64_tr_b16 v[98:99], v4 offset:9216
    ds_read_b64_tr_b16 v[100:101], v5 offset:8192
    v_mfma_f32_32x32x16_bf16 v[128:143], v[72:75], v[112:115], v[128:143]
    ds_read_b64_tr_b16 v[102:103], v5 offset:9216
    ds_read_b64_tr_b16 v[104:105], v4 offset:10240
    ds_read_b64_tr_b16 v[106:107], v4 offset:11264
    s_waitcnt vmcnt(10)
    v_max3_u32 v8, v80, v81, v82
    v_max3_u32 v9, v83, v84, v85
    v_mfma_f32_32x32x16_bf16 v[144:159], v[76:79], v[124:127], v[144:159]
    ds_read_b64_tr_b16 v[108:109], v5 offset:10240
    ds_read_b64_tr_b16 v[110:111], v5 offset:11264
    v_max3_u32 v8, v8, v86, v87
    v_max_u32 v8, v8, v9
    v_cmp_eq_u32 vcc, -1, v8
    v_mfma_f32_32x32x16_bf16 v[128:143], v[76:79], v[120:123], v[128:143]
    s_cbranch_vccnz rty_255
bk_256:
    s_waitcnt lgkmcnt(0)
    v_mfma_f32_32x32x16_bf16 v[144:159], v[80:83], v[100:103], v[144:159]
    s_mov_b32 s58, 0xe00000
    buffer_load_dwordx4 v[16:19], v24, s[32:35], s58 offen sc1
    buffer_load_dwordx4 v[20:23], v25, s[32:35], s58 offen sc1
    ds_read_b64_tr_b16 v[112:113], v4 offset:12288
    ds_read_b64_tr_b16 v[114:115], v4 offset:13312
    ds_read_b64_tr_b16 v[116:117], v5 offset:12288
    v_mfma_f32_32x32x16_bf16 v[128:143], v[80:83], v[96:99], v[128:143]
    ds_read_b64_tr_b16 v[118:119], v5 offset:13312
    ds_read_b64_tr_b16 v[120:121], v4 offset:14336
    ds_read_b64_tr_b16 v[122:123], v4 offset:15360
    s_waitcnt vmcnt(10)
    v_max3_u32 v8, v88, v89, v90
    v_max3_u32 v9, v91, v92, v93
    v_mfma_f32_32x32x16_bf16 v[144:159], v[84:87], v[108:111], v[144:159]
    ds_read_b64_tr_b16 v[124:125], v5 offset:14336
    ds_read_b64_tr_b16 v[126:127], v5 offset:15360
    v_max3_u32 v8, v8, v94, v95
    v_max_u32 v8, v8, v9
    v_cmp_eq_u32 vcc, -1, v8
    v_mfma_f32_32x32x16_bf16 v[128:143], v[84:87], v[104:107], v[128:143]
    s_cbranch_vccnz rty_257
bk_258:
    s_waitcnt lgkmcnt(0)
    v_mfma_f32_32x32x16_bf16 v[144:159], v[88:91], v[116:119], v[144:159]
    ds_read_b64_tr_b16 v[96:97], v4 offset:16384
    ds_read_b64_tr_b16 v[98:99], v4 offset:17408
    ds_read_b64_tr_b16 v[100:101], v5 offset:16384
    v_mfma_f32_32x32x16_bf16 v[128:143], v[88:91], v[112:115], v[128:143]
    ds_read_b64_tr_b16 v[102:103], v5 offset:17408
    ds_read_b64_tr_b16 v[104:105], v4 offset:18432
    ds_read_b64_tr_b16 v[106:107], v4 offset:19456
    s_waitcnt vmcnt(8)
    v_max3_u32 v8, v32, v33, v34
    v_max3_u32 v9, v35, v36, v37
    v_mfma_f32_32x32x16_bf16 v[144:159], v[92:95], v[124:127], v[144:159]
    ds_read_b64_tr_b16 v[108:109], v5 offset:18432
    ds_read_b64_tr_b16 v[110:111], v5 offset:19456
    v_max3_u32 v8, v8, v38, v39
    v_max_u32 v8, v8, v9
    v_cmp_eq_u32 vcc, -1, v8
    v_mfma_f32_32x32x16_bf16 v[128:143], v[92:95], v[120:123], v[128:143]
    s_cbranch_vccnz rty_259
bk_260:
    s_barrier
    s_waitcnt lgkmcnt(0)
    v_mfma_f32_32x32x16_bf16 v[144:159], v[32:35], v[100:103], v[144:159]
    ds_read_b64_tr_b16 v[112:113], v4 offset:20480
    ds_read_b64_tr_b16 v[114:115], v4 offset:21504
    ds_read_b64_tr_b16 v[116:117], v5 offset:20480
    v_mfma_f32_32x32x16_bf16 v[128:143], v[32:35], v[96:99], v[128:143]
    ds_read_b64_tr_b16 v[118:119], v5 offset:21504
    ds_read_b64_tr_b16 v[120:121], v4 offset:22528
    ds_read_b64_tr_b16 v[122:123], v4 offset:23552
    s_waitcnt vmcnt(6)
    v_max3_u32 v8, v40, v41, v42
    v_max3_u32 v9, v43, v44, v45
    v_mfma_f32_32x32x16_bf16 v[144:159], v[36:39], v[108:111], v[144:159]
    ds_read_b64_tr_b16 v[124:125], v5 offset:22528
    ds_read_b64_tr_b16 v[126:127], v5 offset:23552
    v_max3_u32 v8, v8, v46, v47
    v_max_u32 v8, v8, v9
    v_cmp_eq_u32 vcc, -1, v8
    v_mfma_f32_32x32x16_bf16 v[128:143], v[36:39], v[104:107], v[128:143]
    s_cbranch_vccnz rty_261
bk_262:
    s_waitcnt lgkmcnt(0)
    v_mfma_f32_32x32x16_bf16 v[144:159], v[40:43], v[116:119], v[144:159]
    ds_read_b64_tr_b16 v[96:97], v4 offset:24576
    ds_read_b64_tr_b16 v[98:99], v4 offset:25600
    ds_read_b64_tr_b16 v[100:101], v5 offset:24576
    v_mfma_f32_32x32x16_bf16 v[128:143], v[40:43], v[112:115], v[128:143]
    ds_read_b64_tr_b16 v[102:103], v5 offset:25600
    ds_read_b64_tr_b16 v[104:105], v4 offset:26624
    ds_read_b64_tr_b16 v[106:107], v4 offset:27648
    s_waitcnt vmcnt(4)
    v_max3_u32 v8, v48, v49, v50
    v_max3_u32 v9, v51, v52, v53
    v_mfma_f32_32x32x16_bf16 v[144:159], v[44:47], v[124:127], v[144:159]
    ds_read_b64_tr_b16 v[108:109], v5 offset:26624
    ds_read_b64_tr_b16 v[110:111], v5 offset:27648
    v_max3_u32 v8, v8, v54, v55
    v_max_u32 v8, v8, v9
    v_cmp_eq_u32 vcc, -1, v8
    v_mfma_f32_32x32x16_bf16 v[128:143], v[44:47], v[120:123], v[128:143]
    s_cbranch_vccnz rty_263
bk_264:
    s_waitcnt lgkmcnt(0)
    v_mfma_f32_32x32x16_bf16 v[144:159], v[48:51], v[100:103], v[144:159]
    ds_read_b64_tr_b16 v[112:113], v4 offset:28672
    ds_read_b64_tr_b16 v[114:115], v4 offset:29696
    ds_read_b64_tr_b16 v[116:117], v5 offset:28672
    v_mfma_f32_32x32x16_bf16 v[128:143], v[48:51], v[96:99], v[128:143]
    ds_read_b64_tr_b16 v[118:119], v5 offset:29696
    ds_read_b64_tr_b16 v[120:121], v4 offset:30720
    ds_read_b64_tr_b16 v[122:123], v4 offset:31744
    s_waitcnt vmcnt(2)
    v_max3_u32 v8, v56, v57, v58
    v_max3_u32 v9, v59, v60, v61
    v_mfma_f32_32x32x16_bf16 v[144:159], v[52:55], v[108:111], v[144:159]
    ds_read_b64_tr_b16 v[124:125], v5 offset:30720
    ds_read_b64_tr_b16 v[126:127], v5 offset:31744
    v_max3_u32 v8, v8, v62, v63
    v_max_u32 v8, v8, v9
    v_cmp_eq_u32 vcc, -1, v8
    v_mfma_f32_32x32x16_bf16 v[128:143], v[52:55], v[104:107], v[128:143]
    s_cbranch_vccnz rty_265
bk_266:
    s_waitcnt lgkmcnt(0)
    v_mfma_f32_32x32x16_bf16 v[144:159], v[56:59], v[116:119], v[144:159]
    v_mfma_f32_32x32x16_bf16 v[128:143], v[56:59], v[112:115], v[128:143]
    v_mfma_f32_32x32x16_bf16 v[144:159], v[60:63], v[124:127], v[144:159]
    v_mfma_f32_32x32x16_bf16 v[128:143], v[60:63], v[120:123], v[128:143]
    s_mov_b32 s24, s20
    s_and_b32 s25, s21, 0xffff
    s_mov_b32 s26, 0x1c0000
    s_mov_b32 s27, 0x20000
    s_nop 6
    ds_write_b128 v12, v[144:147] offset:2048
    ds_write_b128 v12, v[148:151] offset:3072
    ds_write_b128 v13, v[152:155] offset:4096
    ds_write_b128 v13, v[156:159] offset:5120
    ds_write_b128 v11, v[136:139] offset:0
    ds_write_b128 v11, v[140:143] offset:1024
    s_waitcnt lgkmcnt(0)
    s_waitcnt vmcnt(0)
xrty_268:
    v_max3_u32 v8, v16, v17, v18
    v_max3_u32 v8, v8, v19, v20
    v_max3_u32 v8, v8, v21, v22
    v_max_u32 v8, v8, v23
    v_cmp_eq_u32 vcc, -1, v8
    s_cbranch_vccz xok_267
    s_cmp_eq_u32 s55, 0
    s_cbranch_scc1 xok_267
    s_sub_u32 s55, s55, 1
    buffer_load_dwordx4 v[16:19], v24, s[32:35], s58 offen sc1
    buffer_load_dwordx4 v[20:23], v25, s[32:35], s58 offen sc1
    s_waitcnt vmcnt(0)
    s_branch xrty_268
xok_267:
    v_lshlrev_b32 v96, 16, v16
    v_and_b32 v97, 0xffff0000, v16
    v_lshlrev_b32 v98, 16, v17
    v_and_b32 v99, 0xffff0000, v17
    v_lshlrev_b32 v100, 16, v18
    v_and_b32 v101, 0xffff0000, v18
    v_lshlrev_b32 v102, 16, v19
    v_and_b32 v103, 0xffff0000, v19
    v_lshlrev_b32 v104, 16, v20
    v_and_b32 v105, 0xffff0000, v20
    v_lshlrev_b32 v106, 16, v21
    v_and_b32 v107, 0xffff0000, v21
    v_lshlrev_b32 v108, 16, v22
    v_and_b32 v109, 0xffff0000, v22
    v_lshlrev_b32 v110, 16, v23
    v_and_b32 v111, 0xffff0000, v23
    s_barrier
    ds_read_b128 v[136:139], v10 offset:0
    ds_read_b128 v[140:143], v10 offset:1024
    ds_read_b128 v[144:147], v10 offset:2048
    ds_read_b128 v[148:151], v10 offset:3072
    ds_read_b128 v[152:155], v10 offset:4096
    ds_read_b128 v[156:159], v10 offset:5120
    s_waitcnt lgkmcnt(4)
    v_pk_add_f32 v[128:129], v[128:129], v[136:137]
    v_pk_add_f32 v[130:131], v[130:131], v[138:139]
    v_pk_add_f32 v[132:133], v[132:133], v[140:141]
    v_pk_add_f32 v[134:135], v[134:135], v[142:143]
    s_waitcnt lgkmcnt(2)
    v_pk_add_f32 v[128:129], v[128:129], v[144:145]
    v_pk_add_f32 v[130:131], v[130:131], v[146:147]
    v_pk_add_f32 v[132:133], v[132:133], v[148:149]
    v_pk_add_f32 v[134:135], v[134:135], v[150:151]
    s_waitcnt lgkmcnt(0)
    v_pk_add_f32 v[128:129], v[128:129], v[152:153]
    v_pk_add_f32 v[130:131], v[130:131], v[154:155]
    v_pk_add_f32 v[132:133], v[132:133], v[156:157]
    v_pk_add_f32 v[134:135], v[134:135], v[158:159]
    v_cvt_pk_bf16_f32 v136, v128, v129
    v_cvt_pk_bf16_f32 v137, v130, v131
    v_cvt_pk_bf16_f32 v138, v132, v133
    v_cvt_pk_bf16_f32 v139, v134, v135
    v_xor_b32 v15, 64, v7
    ds_write_b64 v15, v[136:137]
    v_xor_b32 v15, 80, v7
    ds_write_b64 v15, v[138:139]
    s_waitcnt lgkmcnt(0)
    s_barrier
    ds_read_b128 v[48:51], v14
    ds_read_b128 v[52:55], v14 offset:1024
    s_waitcnt lgkmcnt(1)
    v_lshlrev_b32 v32, 16, v48
    v_and_b32 v33, 0xffff0000, v48
    v_lshlrev_b32 v34, 16, v49
    v_and_b32 v35, 0xffff0000, v49
    v_lshlrev_b32 v36, 16, v50
    v_and_b32 v37, 0xffff0000, v50
    v_lshlrev_b32 v38, 16, v51
    v_and_b32 v39, 0xffff0000, v51
    v_pk_add_f32 v[96:97], v[96:97], v[32:33]
    v_pk_add_f32 v[98:99], v[98:99], v[34:35]
    v_pk_add_f32 v[100:101], v[100:101], v[36:37]
    v_pk_add_f32 v[102:103], v[102:103], v[38:39]
    v_cvt_pk_bf16_f32 v56, v96, v97
    v_cvt_pk_bf16_f32 v57, v98, v99
    v_cvt_pk_bf16_f32 v58, v100, v101
    v_cvt_pk_bf16_f32 v59, v102, v103
    buffer_store_dwordx4 v[56:59], v24, s[24:27], 0 offen
    s_waitcnt lgkmcnt(0)
    v_lshlrev_b32 v40, 16, v52
    v_and_b32 v41, 0xffff0000, v52
    v_lshlrev_b32 v42, 16, v53
    v_and_b32 v43, 0xffff0000, v53
    v_lshlrev_b32 v44, 16, v54
    v_and_b32 v45, 0xffff0000, v54
    v_lshlrev_b32 v46, 16, v55
    v_and_b32 v47, 0xffff0000, v55
    v_pk_add_f32 v[104:105], v[104:105], v[40:41]
    v_pk_add_f32 v[106:107], v[106:107], v[42:43]
    v_pk_add_f32 v[108:109], v[108:109], v[44:45]
    v_pk_add_f32 v[110:111], v[110:111], v[46:47]
    v_cvt_pk_bf16_f32 v60, v104, v105
    v_cvt_pk_bf16_f32 v61, v106, v107
    v_cvt_pk_bf16_f32 v62, v108, v109
    v_cvt_pk_bf16_f32 v63, v110, v111
    buffer_store_dwordx4 v[60:63], v25, s[24:27], 0 offen
bdone_269:
    s_endpgm
b1skip_12:
    s_waitcnt vmcnt(0)
    v_bfe_u32 v14, v0, 3, 3
    s_mov_b32 s98, 4096
    v_mul_lo_u32 v28, v14, s98
    v_bfe_u32 v14, v0, 4, 1
    v_lshlrev_b32 v14, 2, v14
    v_and_b32 v15, 7, v0
    v_xor_b32 v14, v14, v15
    v_lshl_add_u32 v28, v14, 4, v28
    s_lshl_b32 s98, s52, 7
    s_or_b32 s98, s98, s54
    v_add_u32 v28, s98, v28
    v_add_u32 v29, 0x7c00, v28
    v_add_u32 v30, 0xf800, v28
    v_add_u32 v31, 0x17400, v28
    ds_read_b64_tr_b16 v[160:161], v4 offset:0
    ds_read_b64_tr_b16 v[162:163], v4 offset:1024
    ds_read_b64_tr_b16 v[164:165], v5 offset:0
    ds_read_b64_tr_b16 v[166:167], v5 offset:1024
    ds_read_b64_tr_b16 v[168:169], v4 offset:2048
    ds_read_b64_tr_b16 v[170:171], v4 offset:3072
    ds_read_b64_tr_b16 v[172:173], v5 offset:2048
    ds_read_b64_tr_b16 v[174:175], v5 offset:3072
    ds_read_b64_tr_b16 v[176:177], v4 offset:4096
    ds_read_b64_tr_b16 v[178:179], v4 offset:5120
    ds_read_b64_tr_b16 v[180:181], v5 offset:4096
    ds_read_b64_tr_b16 v[182:183], v5 offset:5120
    ds_read_b64_tr_b16 v[184:185], v4 offset:6144
    ds_read_b64_tr_b16 v[186:187], v4 offset:7168
    ds_read_b64_tr_b16 v[188:189], v5 offset:6144
    ds_read_b64_tr_b16 v[190:191], v5 offset:7168
    ds_read_b64_tr_b16 v[192:193], v4 offset:8192
    ds_read_b64_tr_b16 v[194:195], v4 offset:9216
    ds_read_b64_tr_b16 v[196:197], v5 offset:8192
    ds_read_b64_tr_b16 v[198:199], v5 offset:9216
    ds_read_b64_tr_b16 v[200:201], v4 offset:10240
    ds_read_b64_tr_b16 v[202:203], v4 offset:11264
    ds_read_b64_tr_b16 v[204:205], v5 offset:10240
    ds_read_b64_tr_b16 v[206:207], v5 offset:11264
    ds_read_b64_tr_b16 v[208:209], v4 offset:12288
    ds_read_b64_tr_b16 v[210:211], v4 offset:13312
    ds_read_b64_tr_b16 v[212:213], v5 offset:12288
    ds_read_b64_tr_b16 v[214:215], v5 offset:13312
    ds_read_b64_tr_b16 v[216:217], v4 offset:14336
    ds_read_b64_tr_b16 v[218:219], v4 offset:15360
    ds_read_b64_tr_b16 v[220:221], v5 offset:14336
    ds_read_b64_tr_b16 v[222:223], v5 offset:15360
    ds_read_b64_tr_b16 v[224:225], v4 offset:16384
    ds_read_b64_tr_b16 v[226:227], v4 offset:17408
    ds_read_b64_tr_b16 v[228:229], v5 offset:16384
    ds_read_b64_tr_b16 v[230:231], v5 offset:17408
    ds_read_b64_tr_b16 v[232:233], v4 offset:18432
    ds_read_b64_tr_b16 v[234:235], v4 offset:19456
    ds_read_b64_tr_b16 v[236:237], v5 offset:18432
    ds_read_b64_tr_b16 v[238:239], v5 offset:19456
    ds_read_b64_tr_b16 v[240:241], v4 offset:20480
    ds_read_b64_tr_b16 v[242:243], v4 offset:21504
    ds_read_b64_tr_b16 v[244:245], v5 offset:20480
    ds_read_b64_tr_b16 v[246:247], v5 offset:21504
    ds_read_b64_tr_b16 v[248:249], v4 offset:22528
    ds_read_b64_tr_b16 v[250:251], v4 offset:23552
    ds_read_b64_tr_b16 v[252:253], v5 offset:22528
    ds_read_b64_tr_b16 v[254:255], v5 offset:23552
    s_waitcnt lgkmcnt(0)
    s_mov_b32 s63, s64
    s_lshl_b32 s61, s63, 12
    s_add_u32 s61, s61, s60
    s_add_u32 m0, s61, 0
    s_add_u32 s61, s63, 6
    s_cmp_ge_u32 s61, 14
    s_cselect_b32 s62, s17, s16
    s_add_u32 s62, s62, s61
    s_lshl_b32 s62, s62, 17
    buffer_load_dwordx4 v28, s[28:31], s62 offen offset:0 lds
    buffer_load_dwordx4 v29, s[28:31], s62 offen offset:1024 lds
    buffer_load_dwordx4 v30, s[28:31], s62 offen offset:2048 lds
    buffer_load_dwordx4 v31, s[28:31], s62 offen offset:3072 lds
    s_add_u32 s63, s63, 1
    s_cmp_eq_u32 s63, 8
    s_cselect_b32 s63, 0, s63
    s_lshl_b32 s61, s63, 12
    s_add_u32 s61, s61, s60
    s_add_u32 m0, s61, 0
    s_add_u32 s61, s63, 6
    s_cmp_ge_u32 s61, 14
    s_cselect_b32 s62, s17, s16
    s_add_u32 s62, s62, s61
    s_lshl_b32 s62, s62, 17
    buffer_load_dwordx4 v28, s[28:31], s62 offen offset:0 lds
    buffer_load_dwordx4 v29, s[28:31], s62 offen offset:1024 lds
    buffer_load_dwordx4 v30, s[28:31], s62 offen offset:2048 lds
    buffer_load_dwordx4 v31, s[28:31], s62 offen offset:3072 lds
    s_add_u32 s63, s63, 1
    s_cmp_eq_u32 s63, 8
    s_cselect_b32 s63, 0, s63
    s_lshl_b32 s61, s63, 12
    s_add_u32 s61, s61, s60
    s_add_u32 m0, s61, 0
    s_add_u32 s61, s63, 6
    s_cmp_ge_u32 s61, 14
    s_cselect_b32 s62, s17, s16
    s_add_u32 s62, s62, s61
    s_lshl_b32 s62, s62, 17
    buffer_load_dwordx4 v28, s[28:31], s62 offen offset:0 lds
    buffer_load_dwordx4 v29, s[28:31], s62 offen offset:1024 lds
    buffer_load_dwordx4 v30, s[28:31], s62 offen offset:2048 lds
    buffer_load_dwordx4 v31, s[28:31], s62 offen offset:3072 lds
    s_add_u32 s63, s63, 1
    s_cmp_eq_u32 s63, 8
    s_cselect_b32 s63, 0, s63
    s_lshl_b32 s61, s63, 12
    s_add_u32 s61, s61, s60
    s_add_u32 m0, s61, 0
    s_add_u32 s61, s63, 6
    s_cmp_ge_u32 s61, 14
    s_cselect_b32 s62, s17, s16
    s_add_u32 s62, s62, s61
    s_lshl_b32 s62, s62, 17
    buffer_load_dwordx4 v28, s[28:31], s62 offen offset:0 lds
    buffer_load_dwordx4 v29, s[28:31], s62 offen offset:1024 lds
    buffer_load_dwordx4 v30, s[28:31], s62 offen offset:2048 lds
    buffer_load_dwordx4 v31, s[28:31], s62 offen offset:3072 lds
    s_add_u32 s63, s63, 1
    s_cmp_eq_u32 s63, 8
    s_cselect_b32 s63, 0, s63
    s_lshl_b32 s61, s63, 12
    s_add_u32 s61, s61, s60
    s_add_u32 m0, s61, 0
    s_add_u32 s61, s63, 6
    s_cmp_ge_u32 s61, 14
    s_cselect_b32 s62, s17, s16
    s_add_u32 s62, s62, s61
    s_lshl_b32 s62, s62, 17
    buffer_load_dwordx4 v28, s[28:31], s62 offen offset:0 lds
    buffer_load_dwordx4 v29, s[28:31], s62 offen offset:1024 lds
    buffer_load_dwordx4 v30, s[28:31], s62 offen offset:2048 lds
    buffer_load_dwordx4 v31, s[28:31], s62 offen offset:3072 lds
    s_add_u32 s63, s63, 1
    s_cmp_eq_u32 s63, 8
    s_cselect_b32 s63, 0, s63
    s_lshl_b32 s61, s63, 12
    s_add_u32 s61, s61, s60
    s_add_u32 m0, s61, 0
    s_add_u32 s61, s63, 6
    s_cmp_ge_u32 s61, 14
    s_cselect_b32 s62, s17, s16
    s_add_u32 s62, s62, s61
    s_lshl_b32 s62, s62, 17
    buffer_load_dwordx4 v28, s[28:31], s62 offen offset:0 lds
    buffer_load_dwordx4 v29, s[28:31], s62 offen offset:1024 lds
    buffer_load_dwordx4 v30, s[28:31], s62 offen offset:2048 lds
    buffer_load_dwordx4 v31, s[28:31], s62 offen offset:3072 lds
    s_add_u32 s63, s63, 1
    s_cmp_eq_u32 s63, 8
    s_cselect_b32 s63, 0, s63
    s_lshl_b32 s61, s63, 12
    s_add_u32 s61, s61, s60
    s_add_u32 m0, s61, 0
    s_add_u32 s61, s63, 6
    s_cmp_ge_u32 s61, 14
    s_cselect_b32 s62, s17, s16
    s_add_u32 s62, s62, s61
    s_lshl_b32 s62, s62, 17
    buffer_load_dwordx4 v28, s[28:31], s62 offen offset:0 lds
    buffer_load_dwordx4 v29, s[28:31], s62 offen offset:1024 lds
    buffer_load_dwordx4 v30, s[28:31], s62 offen offset:2048 lds
    buffer_load_dwordx4 v31, s[28:31], s62 offen offset:3072 lds
    s_add_u32 s63, s63, 1
    s_cmp_eq_u32 s63, 8
    s_cselect_b32 s63, 0, s63
    s_lshl_b32 s61, s63, 12
    s_add_u32 s61, s61, s60
    s_add_u32 m0, s61, 0
    s_add_u32 s61, s63, 6
    s_cmp_ge_u32 s61, 14
    s_cselect_b32 s62, s17, s16
    s_add_u32 s62, s62, s61
    s_lshl_b32 s62, s62, 17
    buffer_load_dwordx4 v28, s[28:31], s62 offen offset:0 lds
    buffer_load_dwordx4 v29, s[28:31], s62 offen offset:1024 lds
    buffer_load_dwordx4 v30, s[28:31], s62 offen offset:2048 lds
    buffer_load_dwordx4 v31, s[28:31], s62 offen offset:3072 lds
    v_mul_u32_u24 v16, 7168, v0
    s_mov_b32 s58, 0x1000000
    s_sleep 16
poll_270:
    buffer_load_dword v17, v16, s[32:35], s58 offen sc1
    v_mov_b32 v18, 0
    v_mov_b32 v19, 0
    s_waitcnt vmcnt(0)
    v_max3_u32 v20, v17, v18, v19
    v_cmp_eq_u32 vcc, -1, v20
    s_cbranch_vccz pollok_271
    s_cmp_eq_u32 s55, 0
    s_cbranch_scc1 pollok_271
    s_sub_u32 s55, s55, 1
    s_mov_b64 exec, vcc
    s_sleep 2
    s_branch poll_270
pollok_271:
    s_mov_b64 exec, -1
    s_barrier
    s_cmp_lg_u32 s54, 0
    s_cbranch_scc1 b2skip_13
    s_xor_b32 s98, s49, 0
    s_mul_i32 s98, s98, 6144
    v_add_u32 v10, s98, v6
    s_xor_b32 s98, s49, 1
    s_mul_i32 s98, s98, 6144
    v_add_u32 v11, s98, v6
    s_xor_b32 s98, s49, 2
    s_mul_i32 s98, s98, 6144
    v_add_u32 v12, s98, v6
    s_xor_b32 s98, s49, 3
    s_mul_i32 s98, s98, 6144
    v_add_u32 v13, s98, v6
    s_sleep 32
poll_272:
    s_add_u32 s101, s57, 0
    buffer_load_dwordx4 v[32:35], v3, s[32:35], s101 offen offset:0 sc1
    s_add_u32 s101, s57, 14336
    buffer_load_dwordx4 v[36:39], v3, s[32:35], s101 offen offset:0 sc1
    s_waitcnt vmcnt(0)
    v_max3_u32 v8, v32, v33, v34
    v_max3_u32 v8, v8, v35, v36
    v_max3_u32 v8, v8, v37, v38
    v_max_u32 v8, v8, v39
    v_cmp_eq_u32 vcc, -1, v8
    s_cbranch_vccz pollok_273
    s_cmp_eq_u32 s55, 0
    s_cbranch_scc1 pollok_273
    s_sub_u32 s55, s55, 1
    s_mov_b64 exec, vcc
    s_sleep 8
    s_branch poll_272
pollok_273:
    s_mov_b64 exec, -1
    s_add_u32 s101, s57, 28672
    buffer_load_dwordx4 v[40:43], v3, s[32:35], s101 offen offset:0 sc1
    s_add_u32 s101, s57, 43008
    buffer_load_dwordx4 v[44:47], v3, s[32:35], s101 offen offset:0 sc1
    s_add_u32 s101, s57, 57344
    buffer_load_dwordx4 v[48:51], v3, s[32:35], s101 offen offset:0 sc1
    s_add_u32 s101, s57, 71680
    buffer_load_dwordx4 v[52:55], v3, s[32:35], s101 offen offset:0 sc1
    s_add_u32 s101, s57, 86016
    buffer_load_dwordx4 v[56:59], v3, s[32:35], s101 offen offset:0 sc1
    s_add_u32 s101, s57, 100352
    buffer_load_dwordx4 v[60:63], v3, s[32:35], s101 offen offset:0 sc1
    s_add_u32 s101, s57, 114688
    buffer_load_dwordx4 v[64:67], v3, s[32:35], s101 offen offset:0 sc1
    s_add_u32 s101, s57, 129024
    buffer_load_dwordx4 v[68:71], v3, s[32:35], s101 offen offset:0 sc1
    s_add_u32 s101, s57, 143360
    buffer_load_dwordx4 v[72:75], v3, s[32:35], s101 offen offset:0 sc1
    s_add_u32 s101, s57, 157696
    buffer_load_dwordx4 v[76:79], v3, s[32:35], s101 offen offset:0 sc1
    v_lshlrev_b32 v96, 16, v26
    v_mov_b32 v104, 0
    v_lshlrev_b32 v97, 16, v26
    v_mov_b32 v105, 0
    v_lshlrev_b32 v98, 16, v26
    v_mov_b32 v106, 0
    v_lshlrev_b32 v99, 16, v26
    v_mov_b32 v107, 0
    v_lshlrev_b32 v100, 16, v26
    v_mov_b32 v108, 0
    v_lshlrev_b32 v101, 16, v26
    v_mov_b32 v109, 0
    v_lshlrev_b32 v102, 16, v26
    v_mov_b32 v110, 0
    v_lshlrev_b32 v103, 16, v26
    v_mov_b32 v111, 0
    s_waitcnt vmcnt(0)
    s_branch b2e_14
b2skip_13:
    s_waitcnt vmcnt(0)
    v_lshlrev_b32 v32, 4, v0
    v_mov_b32 v34, -1
    v_mov_b32 v35, -1
    v_mov_b32 v36, -1
    v_mov_b32 v37, -1
    s_lshl_b32 s59, s2, 13
    s_add_u32 s59, s59, 0x600000
    buffer_store_dwordx4 v[34:37], v32, s[32:35], s59 offen sc1
    s_add_u32 s59, s59, 4096
    buffer_store_dwordx4 v[34:37], v32, s[32:35], s59 offen sc1
    s_lshl_b32 s59, s2, 13
    s_add_u32 s59, s59, 0x1200000
    buffer_store_dwordx4 v[34:37], v32, s[32:35], s59 offen sc1
    s_add_u32 s59, s59, 4096
    buffer_store_dwordx4 v[34:37], v32, s[32:35], s59 offen sc1
    s_lshl_b32 s59, s2, 13
    s_add_u32 s59, s59, 0x1600000
    buffer_store_dwordx4 v[34:37], v32, s[32:35], s59 offen sc1
    s_add_u32 s59, s59, 4096
    buffer_store_dwordx4 v[34:37], v32, s[32:35], s59 offen sc1
    s_lshl_b32 s59, s2, 13
    s_add_u32 s59, s59, 0xe00000
    buffer_store_dwordx4 v[34:37], v32, s[32:35], s59 offen sc1
    s_add_u32 s59, s59, 4096
    buffer_store_dwordx4 v[34:37], v32, s[32:35], s59 offen sc1
    s_branch bdone_137
rty_15:
    s_cmp_eq_u32 s55, 0
    s_cbranch_scc1 bk_16
    s_sub_u32 s55, s55, 1
    s_add_u32 s101, s56, 0
    buffer_load_dwordx4 v[32:35], v2, s[32:35], s101 offen offset:0 sc1
    s_add_u32 s101, s56, 14336
    buffer_load_dwordx4 v[36:39], v2, s[32:35], s101 offen offset:0 sc1
    s_add_u32 s101, s56, 28672
    buffer_load_dwordx4 v[40:43], v2, s[32:35], s101 offen offset:0 sc1
    s_add_u32 s101, s56, 43008
    buffer_load_dwordx4 v[44:47], v2, s[32:35], s101 offen offset:0 sc1
    s_add_u32 s101, s56, 57344
    buffer_load_dwordx4 v[48:51], v2, s[32:35], s101 offen offset:0 sc1
    s_add_u32 s101, s56, 71680
    buffer_load_dwordx4 v[52:55], v2, s[32:35], s101 offen offset:0 sc1
    s_add_u32 s101, s56, 86016
    buffer_load_dwordx4 v[56:59], v2, s[32:35], s101 offen offset:0 sc1
    s_add_u32 s101, s56, 100352
    buffer_load_dwordx4 v[60:63], v2, s[32:35], s101 offen offset:0 sc1
    s_add_u32 s101, s56, 114688
    buffer_load_dwordx4 v[64:67], v2, s[32:35], s101 offen offset:0 sc1
    s_add_u32 s101, s56, 129024
    buffer_load_dwordx4 v[68:71], v2, s[32:35], s101 offen offset:0 sc1
    s_add_u32 s101, s56, 143360
    buffer_load_dwordx4 v[72:75], v2, s[32:35], s101 offen offset:0 sc1
    s_add_u32 s101, s56, 157696
    buffer_load_dwordx4 v[76:79], v2, s[32:35], s101 offen offset:0 sc1
    s_waitcnt vmcnt(10)
    v_max3_u32 v8, v32, v33, v34
    v_max3_u32 v8, v8, v35, v36
    v_max3_u32 v8, v8, v37, v38
    v_max_u32 v8, v8, v39
    v_cmp_eq_u32 vcc, -1, v8
    s_cbranch_vccnz rty_15
    s_branch bk_16
rty_17:
    s_cmp_eq_u32 s55, 0
    s_cbranch_scc1 bk_18
    s_sub_u32 s55, s55, 1
    s_add_u32 s101, s56, 28672
    buffer_load_dwordx4 v[40:43], v2, s[32:35], s101 offen offset:0 sc1
    s_add_u32 s101, s56, 43008
    buffer_load_dwordx4 v[44:47], v2, s[32:35], s101 offen offset:0 sc1
    s_add_u32 s101, s56, 57344
    buffer_load_dwordx4 v[48:51], v2, s[32:35], s101 offen offset:0 sc1
    s_add_u32 s101, s56, 71680
    buffer_load_dwordx4 v[52:55], v2, s[32:35], s101 offen offset:0 sc1
    s_add_u32 s101, s56, 86016
    buffer_load_dwordx4 v[56:59], v2, s[32:35], s101 offen offset:0 sc1
    s_add_u32 s101, s56, 100352
    buffer_load_dwordx4 v[60:63], v2, s[32:35], s101 offen offset:0 sc1
    s_add_u32 s101, s56, 114688
    buffer_load_dwordx4 v[64:67], v2, s[32:35], s101 offen offset:0 sc1
    s_add_u32 s101, s56, 129024
    buffer_load_dwordx4 v[68:71], v2, s[32:35], s101 offen offset:0 sc1
    s_add_u32 s101, s56, 143360
    buffer_load_dwordx4 v[72:75], v2, s[32:35], s101 offen offset:0 sc1
    s_add_u32 s101, s56, 157696
    buffer_load_dwordx4 v[76:79], v2, s[32:35], s101 offen offset:0 sc1
    s_add_u32 s101, s56, 172032
    buffer_load_dwordx4 v[80:83], v2, s[32:35], s101 offen offset:0 sc1
    s_add_u32 s101, s56, 186368
    buffer_load_dwordx4 v[84:87], v2, s[32:35], s101 offen offset:0 sc1
    s_waitcnt vmcnt(10)
    v_max3_u32 v8, v40, v41, v42
    v_max3_u32 v8, v8, v43, v44
    v_max3_u32 v8, v8, v45, v46
    v_max_u32 v8, v8, v47
    v_cmp_eq_u32 vcc, -1, v8
    s_cbranch_vccnz rty_17
    s_branch bk_18
rty_19:
    s_cmp_eq_u32 s55, 0
    s_cbranch_scc1 bk_20
    s_sub_u32 s55, s55, 1
    s_sleep 2
    s_add_u32 s101, s56, 57344
    buffer_load_dwordx4 v[48:51], v2, s[32:35], s101 offen offset:0 sc1
    s_add_u32 s101, s56, 71680
    buffer_load_dwordx4 v[52:55], v2, s[32:35], s101 offen offset:0 sc1
    s_waitcnt vmcnt(0)
    v_max3_u32 v8, v48, v49, v50
    v_max3_u32 v8, v8, v51, v52
    v_max3_u32 v8, v8, v53, v54
    v_max_u32 v8, v8, v55
    v_cmp_eq_u32 vcc, -1, v8
    s_cbranch_vccnz rty_19
    s_branch bk_20
rty_21:
    s_cmp_eq_u32 s55, 0
    s_cbranch_scc1 bk_22
    s_sub_u32 s55, s55, 1
    s_sleep 2
    s_add_u32 s101, s56, 86016
    buffer_load_dwordx4 v[56:59], v2, s[32:35], s101 offen offset:0 sc1
    s_add_u32 s101, s56, 100352
    buffer_load_dwordx4 v[60:63], v2, s[32:35], s101 offen offset:0 sc1
    s_waitcnt vmcnt(0)
    v_max3_u32 v8, v56, v57, v58
    v_max3_u32 v8, v8, v59, v60
    v_max3_u32 v8, v8, v61, v62
    v_max_u32 v8, v8, v63
    v_cmp_eq_u32 vcc, -1, v8
    s_cbranch_vccnz rty_21
    s_branch bk_22
rty_23:
    s_cmp_eq_u32 s55, 0
    s_cbranch_scc1 bk_24
    s_sub_u32 s55, s55, 1
    s_sleep 2
    s_add_u32 s101, s56, 114688
    buffer_load_dwordx4 v[64:67], v2, s[32:35], s101 offen offset:0 sc1
    s_add_u32 s101, s56, 129024
    buffer_load_dwordx4 v[68:71], v2, s[32:35], s101 offen offset:0 sc1
    s_waitcnt vmcnt(0)
    v_max3_u32 v8, v64, v65, v66
    v_max3_u32 v8, v8, v67, v68
    v_max3_u32 v8, v8, v69, v70
    v_max_u32 v8, v8, v71
    v_cmp_eq_u32 vcc, -1, v8
    s_cbranch_vccnz rty_23
    s_branch bk_24
rty_25:
    s_cmp_eq_u32 s55, 0
    s_cbranch_scc1 bk_26
    s_sub_u32 s55, s55, 1
    s_sleep 2
    s_add_u32 s101, s56, 143360
    buffer_load_dwordx4 v[72:75], v2, s[32:35], s101 offen offset:0 sc1
    s_add_u32 s101, s56, 157696
    buffer_load_dwordx4 v[76:79], v2, s[32:35], s101 offen offset:0 sc1
    s_waitcnt vmcnt(0)
    v_max3_u32 v8, v72, v73, v74
    v_max3_u32 v8, v8, v75, v76
    v_max3_u32 v8, v8, v77, v78
    v_max_u32 v8, v8, v79
    v_cmp_eq_u32 vcc, -1, v8
    s_cbranch_vccnz rty_25
    s_branch bk_26
rty_27:
    s_cmp_eq_u32 s55, 0
    s_cbranch_scc1 bk_28
    s_sub_u32 s55, s55, 1
    s_sleep 2
    s_add_u32 s101, s56, 172032
    buffer_load_dwordx4 v[80:83], v2, s[32:35], s101 offen offset:0 sc1
    s_add_u32 s101, s56, 186368
    buffer_load_dwordx4 v[84:87], v2, s[32:35], s101 offen offset:0 sc1
    s_waitcnt vmcnt(0)
    v_max3_u32 v8, v80, v81, v82
    v_max3_u32 v8, v8, v83, v84
    v_max3_u32 v8, v8, v85, v86
    v_max_u32 v8, v8, v87
    v_cmp_eq_u32 vcc, -1, v8
    s_cbranch_vccnz rty_27
    s_branch bk_28
rty_29:
    s_cmp_eq_u32 s55, 0
    s_cbranch_scc1 bk_30
    s_sub_u32 s55, s55, 1
    s_sleep 2
    s_add_u32 s101, s56, 200704
    buffer_load_dwordx4 v[88:91], v2, s[32:35], s101 offen offset:0 sc1
    s_add_u32 s101, s56, 215040
    buffer_load_dwordx4 v[92:95], v2, s[32:35], s101 offen offset:0 sc1
    s_waitcnt vmcnt(0)
    v_max3_u32 v8, v88, v89, v90
    v_max3_u32 v8, v8, v91, v92
    v_max3_u32 v8, v8, v93, v94
    v_max_u32 v8, v8, v95
    v_cmp_eq_u32 vcc, -1, v8
    s_cbranch_vccnz rty_29
    s_branch bk_30
rty_31:
    s_cmp_eq_u32 s55, 0
    s_cbranch_scc1 bk_32
    s_sub_u32 s55, s55, 1
    s_sleep 2
    s_add_u32 s101, s56, 229376
    buffer_load_dwordx4 v[32:35], v2, s[32:35], s101 offen offset:0 sc1
    s_add_u32 s101, s56, 243712
    buffer_load_dwordx4 v[36:39], v2, s[32:35], s101 offen offset:0 sc1
    s_waitcnt vmcnt(0)
    v_max3_u32 v8, v32, v33, v34
    v_max3_u32 v8, v8, v35, v36
    v_max3_u32 v8, v8, v37, v38
    v_max_u32 v8, v8, v39
    v_cmp_eq_u32 vcc, -1, v8
    s_cbranch_vccnz rty_31
    s_branch bk_32
rty_33:
    s_cmp_eq_u32 s55, 0
    s_cbranch_scc1 bk_34
    s_sub_u32 s55, s55, 1
    s_sleep 2
    s_add_u32 s101, s56, 258048
    buffer_load_dwordx4 v[40:43], v2, s[32:35], s101 offen offset:0 sc1
    s_add_u32 s101, s56, 272384
    buffer_load_dwordx4 v[44:47], v2, s[32:35], s101 offen offset:0 sc1
    s_waitcnt vmcnt(0)
    v_max3_u32 v8, v40, v41, v42
    v_max3_u32 v8, v8, v43, v44
    v_max3_u32 v8, v8, v45, v46
    v_max_u32 v8, v8, v47
    v_cmp_eq_u32 vcc, -1, v8
    s_cbranch_vccnz rty_33
    s_branch bk_34
rty_35:
    s_cmp_eq_u32 s55, 0
    s_cbranch_scc1 bk_36
    s_sub_u32 s55, s55, 1
    s_sleep 2
    s_add_u32 s101, s56, 286720
    buffer_load_dwordx4 v[48:51], v2, s[32:35], s101 offen offset:0 sc1
    s_add_u32 s101, s56, 301056
    buffer_load_dwordx4 v[52:55], v2, s[32:35], s101 offen offset:0 sc1
    s_waitcnt vmcnt(0)
    v_max3_u32 v8, v48, v49, v50
    v_max3_u32 v8, v8, v51, v52
    v_max3_u32 v8, v8, v53, v54
    v_max_u32 v8, v8, v55
    v_cmp_eq_u32 vcc, -1, v8
    s_cbranch_vccnz rty_35
    s_branch bk_36
rty_37:
    s_cmp_eq_u32 s55, 0
    s_cbranch_scc1 bk_38
    s_sub_u32 s55, s55, 1
    s_sleep 2
    s_add_u32 s101, s56, 315392
    buffer_load_dwordx4 v[56:59], v2, s[32:35], s101 offen offset:0 sc1
    s_add_u32 s101, s56, 329728
    buffer_load_dwordx4 v[60:63], v2, s[32:35], s101 offen offset:0 sc1
    s_waitcnt vmcnt(0)
    v_max3_u32 v8, v56, v57, v58
    v_max3_u32 v8, v8, v59, v60
    v_max3_u32 v8, v8, v61, v62
    v_max_u32 v8, v8, v63
    v_cmp_eq_u32 vcc, -1, v8
    s_cbranch_vccnz rty_37
    s_branch bk_38
rty_39:
    s_cmp_eq_u32 s55, 0
    s_cbranch_scc1 bk_40
    s_sub_u32 s55, s55, 1
    s_sleep 2
    s_add_u32 s101, s56, 344064
    buffer_load_dwordx4 v[64:67], v2, s[32:35], s101 offen offset:0 sc1
    s_add_u32 s101, s56, 358400
    buffer_load_dwordx4 v[68:71], v2, s[32:35], s101 offen offset:0 sc1
    s_waitcnt vmcnt(0)
    v_max3_u32 v8, v64, v65, v66
    v_max3_u32 v8, v8, v67, v68
    v_max3_u32 v8, v8, v69, v70
    v_max_u32 v8, v8, v71
    v_cmp_eq_u32 vcc, -1, v8
    s_cbranch_vccnz rty_39
    s_branch bk_40
rty_41:
    s_cmp_eq_u32 s55, 0
    s_cbranch_scc1 bk_42
    s_sub_u32 s55, s55, 1
    s_sleep 2
    s_add_u32 s101, s56, 372736
    buffer_load_dwordx4 v[72:75], v2, s[32:35], s101 offen offset:0 sc1
    s_add_u32 s101, s56, 387072
    buffer_load_dwordx4 v[76:79], v2, s[32:35], s101 offen offset:0 sc1
    s_waitcnt vmcnt(0)
    v_max3_u32 v8, v72, v73, v74
    v_max3_u32 v8, v8, v75, v76
    v_max3_u32 v8, v8, v77, v78
    v_max_u32 v8, v8, v79
    v_cmp_eq_u32 vcc, -1, v8
    s_cbranch_vccnz rty_41
    s_branch bk_42
rty_43:
    s_cmp_eq_u32 s55, 0
    s_cbranch_scc1 bk_44
    s_sub_u32 s55, s55, 1
    s_sleep 2
    s_add_u32 s101, s56, 401408
    buffer_load_dwordx4 v[80:83], v2, s[32:35], s101 offen offset:0 sc1
    s_add_u32 s101, s56, 415744
    buffer_load_dwordx4 v[84:87], v2, s[32:35], s101 offen offset:0 sc1
    s_waitcnt vmcnt(0)
    v_max3_u32 v8, v80, v81, v82
    v_max3_u32 v8, v8, v83, v84
    v_max3_u32 v8, v8, v85, v86
    v_max_u32 v8, v8, v87
    v_cmp_eq_u32 vcc, -1, v8
    s_cbranch_vccnz rty_43
    s_branch bk_44
rty_45:
    s_cmp_eq_u32 s55, 0
    s_cbranch_scc1 bk_46
    s_sub_u32 s55, s55, 1
    s_sleep 2
    s_add_u32 s101, s56, 430080
    buffer_load_dwordx4 v[88:91], v2, s[32:35], s101 offen offset:0 sc1
    s_add_u32 s101, s56, 444416
    buffer_load_dwordx4 v[92:95], v2, s[32:35], s101 offen offset:0 sc1
    s_waitcnt vmcnt(0)
    v_max3_u32 v8, v88, v89, v90
    v_max3_u32 v8, v8, v91, v92
    v_max3_u32 v8, v8, v93, v94
    v_max_u32 v8, v8, v95
    v_cmp_eq_u32 vcc, -1, v8
    s_cbranch_vccnz rty_45
    s_branch bk_46
rty_47:
    s_cmp_eq_u32 s55, 0
    s_cbranch_scc1 bk_48
    s_sub_u32 s55, s55, 1
    s_sleep 2
    s_add_u32 s101, s56, 0
    buffer_load_dwordx4 v[32:35], v2, s[32:35], s101 offen offset:512 sc1
    s_add_u32 s101, s56, 14336
    buffer_load_dwordx4 v[36:39], v2, s[32:35], s101 offen offset:512 sc1
    s_waitcnt vmcnt(0)
    v_max3_u32 v8, v32, v33, v34
    v_max3_u32 v8, v8, v35, v36
    v_max3_u32 v8, v8, v37, v38
    v_max_u32 v8, v8, v39
    v_cmp_eq_u32 vcc, -1, v8
    s_cbranch_vccnz rty_47
    s_branch bk_48
rty_49:
    s_cmp_eq_u32 s55, 0
    s_cbranch_scc1 bk_50
    s_sub_u32 s55, s55, 1
    s_sleep 2
    s_add_u32 s101, s56, 28672
    buffer_load_dwordx4 v[40:43], v2, s[32:35], s101 offen offset:512 sc1
    s_add_u32 s101, s56, 43008
    buffer_load_dwordx4 v[44:47], v2, s[32:35], s101 offen offset:512 sc1
    s_waitcnt vmcnt(0)
    v_max3_u32 v8, v40, v41, v42
    v_max3_u32 v8, v8, v43, v44
    v_max3_u32 v8, v8, v45, v46
    v_max_u32 v8, v8, v47
    v_cmp_eq_u32 vcc, -1, v8
    s_cbranch_vccnz rty_49
    s_branch bk_50
rty_51:
    s_cmp_eq_u32 s55, 0
    s_cbranch_scc1 bk_52
    s_sub_u32 s55, s55, 1
    s_sleep 2
    s_add_u32 s101, s56, 57344
    buffer_load_dwordx4 v[48:51], v2, s[32:35], s101 offen offset:512 sc1
    s_add_u32 s101, s56, 71680
    buffer_load_dwordx4 v[52:55], v2, s[32:35], s101 offen offset:512 sc1
    s_waitcnt vmcnt(0)
    v_max3_u32 v8, v48, v49, v50
    v_max3_u32 v8, v8, v51, v52
    v_max3_u32 v8, v8, v53, v54
    v_max_u32 v8, v8, v55
    v_cmp_eq_u32 vcc, -1, v8
    s_cbranch_vccnz rty_51
    s_branch bk_52
rty_53:
    s_cmp_eq_u32 s55, 0
    s_cbranch_scc1 bk_54
    s_sub_u32 s55, s55, 1
    s_sleep 2
    s_add_u32 s101, s56, 86016
    buffer_load_dwordx4 v[56:59], v2, s[32:35], s101 offen offset:512 sc1
    s_add_u32 s101, s56, 100352
    buffer_load_dwordx4 v[60:63], v2, s[32:35], s101 offen offset:512 sc1
    s_waitcnt vmcnt(0)
    v_max3_u32 v8, v56, v57, v58
    v_max3_u32 v8, v8, v59, v60
    v_max3_u32 v8, v8, v61, v62
    v_max_u32 v8, v8, v63
    v_cmp_eq_u32 vcc, -1, v8
    s_cbranch_vccnz rty_53
    s_branch bk_54
rty_55:
    s_cmp_eq_u32 s55, 0
    s_cbranch_scc1 bk_56
    s_sub_u32 s55, s55, 1
    s_sleep 2
    s_add_u32 s101, s56, 114688
    buffer_load_dwordx4 v[64:67], v2, s[32:35], s101 offen offset:512 sc1
    s_add_u32 s101, s56, 129024
    buffer_load_dwordx4 v[68:71], v2, s[32:35], s101 offen offset:512 sc1
    s_waitcnt vmcnt(0)
    v_max3_u32 v8, v64, v65, v66
    v_max3_u32 v8, v8, v67, v68
    v_max3_u32 v8, v8, v69, v70
    v_max_u32 v8, v8, v71
    v_cmp_eq_u32 vcc, -1, v8
    s_cbranch_vccnz rty_55
    s_branch bk_56
rty_57:
    s_cmp_eq_u32 s55, 0
    s_cbranch_scc1 bk_58
    s_sub_u32 s55, s55, 1
    s_sleep 2
    s_add_u32 s101, s56, 143360
    buffer_load_dwordx4 v[72:75], v2, s[32:35], s101 offen offset:512 sc1
    s_add_u32 s101, s56, 157696
    buffer_load_dwordx4 v[76:79], v2, s[32:35], s101 offen offset:512 sc1
    s_waitcnt vmcnt(0)
    v_max3_u32 v8, v72, v73, v74
    v_max3_u32 v8, v8, v75, v76
    v_max3_u32 v8, v8, v77, v78
    v_max_u32 v8, v8, v79
    v_cmp_eq_u32 vcc, -1, v8
    s_cbranch_vccnz rty_57
    s_branch bk_58
rty_59:
    s_cmp_eq_u32 s55, 0
    s_cbranch_scc1 bk_60
    s_sub_u32 s55, s55, 1
    s_sleep 2
    s_add_u32 s101, s56, 172032
    buffer_load_dwordx4 v[80:83], v2, s[32:35], s101 offen offset:512 sc1
    s_add_u32 s101, s56, 186368
    buffer_load_dwordx4 v[84:87], v2, s[32:35], s101 offen offset:512 sc1
    s_waitcnt vmcnt(0)
    v_max3_u32 v8, v80, v81, v82
    v_max3_u32 v8, v8, v83, v84
    v_max3_u32 v8, v8, v85, v86
    v_max_u32 v8, v8, v87
    v_cmp_eq_u32 vcc, -1, v8
    s_cbranch_vccnz rty_59
    s_branch bk_60
rty_61:
    s_cmp_eq_u32 s55, 0
    s_cbranch_scc1 bk_62
    s_sub_u32 s55, s55, 1
    s_sleep 2
    s_add_u32 s101, s56, 200704
    buffer_load_dwordx4 v[88:91], v2, s[32:35], s101 offen offset:512 sc1
    s_add_u32 s101, s56, 215040
    buffer_load_dwordx4 v[92:95], v2, s[32:35], s101 offen offset:512 sc1
    s_waitcnt vmcnt(0)
    v_max3_u32 v8, v88, v89, v90
    v_max3_u32 v8, v8, v91, v92
    v_max3_u32 v8, v8, v93, v94
    v_max_u32 v8, v8, v95
    v_cmp_eq_u32 vcc, -1, v8
    s_cbranch_vccnz rty_61
    s_branch bk_62
rty_63:
    s_cmp_eq_u32 s55, 0
    s_cbranch_scc1 bk_64
    s_sub_u32 s55, s55, 1
    s_sleep 2
    s_add_u32 s101, s56, 229376
    buffer_load_dwordx4 v[32:35], v2, s[32:35], s101 offen offset:512 sc1
    s_add_u32 s101, s56, 243712
    buffer_load_dwordx4 v[36:39], v2, s[32:35], s101 offen offset:512 sc1
    s_waitcnt vmcnt(0)
    v_max3_u32 v8, v32, v33, v34
    v_max3_u32 v8, v8, v35, v36
    v_max3_u32 v8, v8, v37, v38
    v_max_u32 v8, v8, v39
    v_cmp_eq_u32 vcc, -1, v8
    s_cbranch_vccnz rty_63
    s_branch bk_64
rty_65:
    s_cmp_eq_u32 s55, 0
    s_cbranch_scc1 bk_66
    s_sub_u32 s55, s55, 1
    s_sleep 2
    s_add_u32 s101, s56, 258048
    buffer_load_dwordx4 v[40:43], v2, s[32:35], s101 offen offset:512 sc1
    s_add_u32 s101, s56, 272384
    buffer_load_dwordx4 v[44:47], v2, s[32:35], s101 offen offset:512 sc1
    s_waitcnt vmcnt(0)
    v_max3_u32 v8, v40, v41, v42
    v_max3_u32 v8, v8, v43, v44
    v_max3_u32 v8, v8, v45, v46
    v_max_u32 v8, v8, v47
    v_cmp_eq_u32 vcc, -1, v8
    s_cbranch_vccnz rty_65
    s_branch bk_66
rty_67:
    s_cmp_eq_u32 s55, 0
    s_cbranch_scc1 bk_68
    s_sub_u32 s55, s55, 1
    s_sleep 2
    s_add_u32 s101, s56, 286720
    buffer_load_dwordx4 v[48:51], v2, s[32:35], s101 offen offset:512 sc1
    s_add_u32 s101, s56, 301056
    buffer_load_dwordx4 v[52:55], v2, s[32:35], s101 offen offset:512 sc1
    s_waitcnt vmcnt(0)
    v_max3_u32 v8, v48, v49, v50
    v_max3_u32 v8, v8, v51, v52
    v_max3_u32 v8, v8, v53, v54
    v_max_u32 v8, v8, v55
    v_cmp_eq_u32 vcc, -1, v8
    s_cbranch_vccnz rty_67
    s_branch bk_68
rty_69:
    s_cmp_eq_u32 s55, 0
    s_cbranch_scc1 bk_70
    s_sub_u32 s55, s55, 1
    s_sleep 2
    s_add_u32 s101, s56, 315392
    buffer_load_dwordx4 v[56:59], v2, s[32:35], s101 offen offset:512 sc1
    s_add_u32 s101, s56, 329728
    buffer_load_dwordx4 v[60:63], v2, s[32:35], s101 offen offset:512 sc1
    s_waitcnt vmcnt(0)
    v_max3_u32 v8, v56, v57, v58
    v_max3_u32 v8, v8, v59, v60
    v_max3_u32 v8, v8, v61, v62
    v_max_u32 v8, v8, v63
    v_cmp_eq_u32 vcc, -1, v8
    s_cbranch_vccnz rty_69
    s_branch bk_70
rty_71:
    s_cmp_eq_u32 s55, 0
    s_cbranch_scc1 bk_72
    s_sub_u32 s55, s55, 1
    s_sleep 2
    s_add_u32 s101, s56, 344064
    buffer_load_dwordx4 v[64:67], v2, s[32:35], s101 offen offset:512 sc1
    s_add_u32 s101, s56, 358400
    buffer_load_dwordx4 v[68:71], v2, s[32:35], s101 offen offset:512 sc1
    s_waitcnt vmcnt(0)
    v_max3_u32 v8, v64, v65, v66
    v_max3_u32 v8, v8, v67, v68
    v_max3_u32 v8, v8, v69, v70
    v_max_u32 v8, v8, v71
    v_cmp_eq_u32 vcc, -1, v8
    s_cbranch_vccnz rty_71
    s_branch bk_72
rty_73:
    s_cmp_eq_u32 s55, 0
    s_cbranch_scc1 bk_74
    s_sub_u32 s55, s55, 1
    s_sleep 2
    s_add_u32 s101, s56, 372736
    buffer_load_dwordx4 v[72:75], v2, s[32:35], s101 offen offset:512 sc1
    s_add_u32 s101, s56, 387072
    buffer_load_dwordx4 v[76:79], v2, s[32:35], s101 offen offset:512 sc1
    s_waitcnt vmcnt(0)
    v_max3_u32 v8, v72, v73, v74
    v_max3_u32 v8, v8, v75, v76
    v_max3_u32 v8, v8, v77, v78
    v_max_u32 v8, v8, v79
    v_cmp_eq_u32 vcc, -1, v8
    s_cbranch_vccnz rty_73
    s_branch bk_74
rty_75:
    s_cmp_eq_u32 s55, 0
    s_cbranch_scc1 bk_76
    s_sub_u32 s55, s55, 1
    s_sleep 2
    s_add_u32 s101, s56, 401408
    buffer_load_dwordx4 v[80:83], v2, s[32:35], s101 offen offset:512 sc1
    s_add_u32 s101, s56, 415744
    buffer_load_dwordx4 v[84:87], v2, s[32:35], s101 offen offset:512 sc1
    s_waitcnt vmcnt(0)
    v_max3_u32 v8, v80, v81, v82
    v_max3_u32 v8, v8, v83, v84
    v_max3_u32 v8, v8, v85, v86
    v_max_u32 v8, v8, v87
    v_cmp_eq_u32 vcc, -1, v8
    s_cbranch_vccnz rty_75
    s_branch bk_76
rty_77:
    s_cmp_eq_u32 s55, 0
    s_cbranch_scc1 bk_78
    s_sub_u32 s55, s55, 1
    s_sleep 2
    s_add_u32 s101, s56, 430080
    buffer_load_dwordx4 v[88:91], v2, s[32:35], s101 offen offset:512 sc1
    s_add_u32 s101, s56, 444416
    buffer_load_dwordx4 v[92:95], v2, s[32:35], s101 offen offset:512 sc1
    s_waitcnt vmcnt(0)
    v_max3_u32 v8, v88, v89, v90
    v_max3_u32 v8, v8, v91, v92
    v_max3_u32 v8, v8, v93, v94
    v_max_u32 v8, v8, v95
    v_cmp_eq_u32 vcc, -1, v8
    s_cbranch_vccnz rty_77
    s_branch bk_78
rty_79:
    s_cmp_eq_u32 s55, 0
    s_cbranch_scc1 bk_80
    s_sub_u32 s55, s55, 1
    s_sleep 2
    s_add_u32 s101, s57, 0
    buffer_load_dwordx4 v[32:35], v3, s[32:35], s101 offen offset:0 sc1
    s_add_u32 s101, s57, 14336
    buffer_load_dwordx4 v[36:39], v3, s[32:35], s101 offen offset:0 sc1
    s_add_u32 s101, s57, 28672
    buffer_load_dwordx4 v[40:43], v3, s[32:35], s101 offen offset:0 sc1
    s_add_u32 s101, s57, 43008
    buffer_load_dwordx4 v[44:47], v3, s[32:35], s101 offen offset:0 sc1
    s_add_u32 s101, s57, 57344
    buffer_load_dwordx4 v[48:51], v3, s[32:35], s101 offen offset:0 sc1
    s_add_u32 s101, s57, 71680
    buffer_load_dwordx4 v[52:55], v3, s[32:35], s101 offen offset:0 sc1
    s_add_u32 s101, s57, 86016
    buffer_load_dwordx4 v[56:59], v3, s[32:35], s101 offen offset:0 sc1
    s_add_u32 s101, s57, 100352
    buffer_load_dwordx4 v[60:63], v3, s[32:35], s101 offen offset:0 sc1
    s_add_u32 s101, s57, 114688
    buffer_load_dwordx4 v[64:67], v3, s[32:35], s101 offen offset:0 sc1
    s_add_u32 s101, s57, 129024
    buffer_load_dwordx4 v[68:71], v3, s[32:35], s101 offen offset:0 sc1
    s_add_u32 s101, s57, 143360
    buffer_load_dwordx4 v[72:75], v3, s[32:35], s101 offen offset:0 sc1
    s_add_u32 s101, s57, 157696
    buffer_load_dwordx4 v[76:79], v3, s[32:35], s101 offen offset:0 sc1
    s_waitcnt vmcnt(0)
    v_max3_u32 v8, v32, v33, v34
    v_max3_u32 v8, v8, v35, v36
    v_max3_u32 v8, v8, v37, v38
    v_max_u32 v8, v8, v39
    v_cmp_eq_u32 vcc, -1, v8
    s_cbranch_vccnz rty_79
    s_branch bk_80
rty_81:
    s_cmp_eq_u32 s55, 0
    s_cbranch_scc1 bk_82
    s_sub_u32 s55, s55, 1
    s_sleep 2
    s_add_u32 s101, s57, 28672
    buffer_load_dwordx4 v[40:43], v3, s[32:35], s101 offen offset:0 sc1
    s_add_u32 s101, s57, 43008
    buffer_load_dwordx4 v[44:47], v3, s[32:35], s101 offen offset:0 sc1
    s_add_u32 s101, s57, 57344
    buffer_load_dwordx4 v[48:51], v3, s[32:35], s101 offen offset:0 sc1
    s_add_u32 s101, s57, 71680
    buffer_load_dwordx4 v[52:55], v3, s[32:35], s101 offen offset:0 sc1
    s_add_u32 s101, s57, 86016
    buffer_load_dwordx4 v[56:59], v3, s[32:35], s101 offen offset:0 sc1
    s_add_u32 s101, s57, 100352
    buffer_load_dwordx4 v[60:63], v3, s[32:35], s101 offen offset:0 sc1
    s_add_u32 s101, s57, 114688
    buffer_load_dwordx4 v[64:67], v3, s[32:35], s101 offen offset:0 sc1
    s_add_u32 s101, s57, 129024
    buffer_load_dwordx4 v[68:71], v3, s[32:35], s101 offen offset:0 sc1
    s_add_u32 s101, s57, 143360
    buffer_load_dwordx4 v[72:75], v3, s[32:35], s101 offen offset:0 sc1
    s_add_u32 s101, s57, 157696
    buffer_load_dwordx4 v[76:79], v3, s[32:35], s101 offen offset:0 sc1
    s_add_u32 s101, s57, 172032
    buffer_load_dwordx4 v[80:83], v3, s[32:35], s101 offen offset:0 sc1
    s_add_u32 s101, s57, 186368
    buffer_load_dwordx4 v[84:87], v3, s[32:35], s101 offen offset:0 sc1
    s_waitcnt vmcnt(0)
    v_max3_u32 v8, v40, v41, v42
    v_max3_u32 v8, v8, v43, v44
    v_max3_u32 v8, v8, v45, v46
    v_max_u32 v8, v8, v47
    v_cmp_eq_u32 vcc, -1, v8
    s_cbranch_vccnz rty_81
    s_branch bk_82
rty_83:
    s_cmp_eq_u32 s55, 0
    s_cbranch_scc1 bk_84
    s_sub_u32 s55, s55, 1
    s_sleep 2
    s_add_u32 s101, s57, 57344
    buffer_load_dwordx4 v[48:51], v3, s[32:35], s101 offen offset:0 sc1
    s_add_u32 s101, s57, 71680
    buffer_load_dwordx4 v[52:55], v3, s[32:35], s101 offen offset:0 sc1
    s_waitcnt vmcnt(0)
    v_max3_u32 v8, v48, v49, v50
    v_max3_u32 v8, v8, v51, v52
    v_max3_u32 v8, v8, v53, v54
    v_max_u32 v8, v8, v55
    v_cmp_eq_u32 vcc, -1, v8
    s_cbranch_vccnz rty_83
    s_branch bk_84
rty_85:
    s_cmp_eq_u32 s55, 0
    s_cbranch_scc1 bk_86
    s_sub_u32 s55, s55, 1
    s_sleep 2
    s_add_u32 s101, s57, 86016
    buffer_load_dwordx4 v[56:59], v3, s[32:35], s101 offen offset:0 sc1
    s_add_u32 s101, s57, 100352
    buffer_load_dwordx4 v[60:63], v3, s[32:35], s101 offen offset:0 sc1
    s_waitcnt vmcnt(0)
    v_max3_u32 v8, v56, v57, v58
    v_max3_u32 v8, v8, v59, v60
    v_max3_u32 v8, v8, v61, v62
    v_max_u32 v8, v8, v63
    v_cmp_eq_u32 vcc, -1, v8
    s_cbranch_vccnz rty_85
    s_branch bk_86
rty_87:
    s_cmp_eq_u32 s55, 0
    s_cbranch_scc1 bk_88
    s_sub_u32 s55, s55, 1
    s_sleep 2
    s_add_u32 s101, s57, 114688
    buffer_load_dwordx4 v[64:67], v3, s[32:35], s101 offen offset:0 sc1
    s_add_u32 s101, s57, 129024
    buffer_load_dwordx4 v[68:71], v3, s[32:35], s101 offen offset:0 sc1
    s_waitcnt vmcnt(0)
    v_max3_u32 v8, v64, v65, v66
    v_max3_u32 v8, v8, v67, v68
    v_max3_u32 v8, v8, v69, v70
    v_max_u32 v8, v8, v71
    v_cmp_eq_u32 vcc, -1, v8
    s_cbranch_vccnz rty_87
    s_branch bk_88
rty_89:
    s_cmp_eq_u32 s55, 0
    s_cbranch_scc1 bk_90
    s_sub_u32 s55, s55, 1
    s_sleep 2
    s_add_u32 s101, s57, 143360
    buffer_load_dwordx4 v[72:75], v3, s[32:35], s101 offen offset:0 sc1
    s_add_u32 s101, s57, 157696
    buffer_load_dwordx4 v[76:79], v3, s[32:35], s101 offen offset:0 sc1
    s_waitcnt vmcnt(0)
    v_max3_u32 v8, v72, v73, v74
    v_max3_u32 v8, v8, v75, v76
    v_max3_u32 v8, v8, v77, v78
    v_max_u32 v8, v8, v79
    v_cmp_eq_u32 vcc, -1, v8
    s_cbranch_vccnz rty_89
    s_branch bk_90
rty_91:
    s_cmp_eq_u32 s55, 0
    s_cbranch_scc1 bk_92
    s_sub_u32 s55, s55, 1
    s_sleep 2
    s_add_u32 s101, s57, 172032
    buffer_load_dwordx4 v[80:83], v3, s[32:35], s101 offen offset:0 sc1
    s_add_u32 s101, s57, 186368
    buffer_load_dwordx4 v[84:87], v3, s[32:35], s101 offen offset:0 sc1
    s_waitcnt vmcnt(0)
    v_max3_u32 v8, v80, v81, v82
    v_max3_u32 v8, v8, v83, v84
    v_max3_u32 v8, v8, v85, v86
    v_max_u32 v8, v8, v87
    v_cmp_eq_u32 vcc, -1, v8
    s_cbranch_vccnz rty_91
    s_branch bk_92
rty_93:
    s_cmp_eq_u32 s55, 0
    s_cbranch_scc1 bk_94
    s_sub_u32 s55, s55, 1
    s_sleep 2
    s_add_u32 s101, s57, 200704
    buffer_load_dwordx4 v[88:91], v3, s[32:35], s101 offen offset:0 sc1
    s_add_u32 s101, s57, 215040
    buffer_load_dwordx4 v[92:95], v3, s[32:35], s101 offen offset:0 sc1
    s_waitcnt vmcnt(0)
    v_max3_u32 v8, v88, v89, v90
    v_max3_u32 v8, v8, v91, v92
    v_max3_u32 v8, v8, v93, v94
    v_max_u32 v8, v8, v95
    v_cmp_eq_u32 vcc, -1, v8
    s_cbranch_vccnz rty_93
    s_branch bk_94
rty_95:
    s_cmp_eq_u32 s55, 0
    s_cbranch_scc1 bk_96
    s_sub_u32 s55, s55, 1
    s_sleep 2
    s_add_u32 s101, s57, 229376
    buffer_load_dwordx4 v[32:35], v3, s[32:35], s101 offen offset:0 sc1
    s_add_u32 s101, s57, 243712
    buffer_load_dwordx4 v[36:39], v3, s[32:35], s101 offen offset:0 sc1
    s_waitcnt vmcnt(0)
    v_max3_u32 v8, v32, v33, v34
    v_max3_u32 v8, v8, v35, v36
    v_max3_u32 v8, v8, v37, v38
    v_max_u32 v8, v8, v39
    v_cmp_eq_u32 vcc, -1, v8
    s_cbranch_vccnz rty_95
    s_branch bk_96
rty_97:
    s_cmp_eq_u32 s55, 0
    s_cbranch_scc1 bk_98
    s_sub_u32 s55, s55, 1
    s_sleep 2
    s_add_u32 s101, s57, 258048
    buffer_load_dwordx4 v[40:43], v3, s[32:35], s101 offen offset:0 sc1
    s_add_u32 s101, s57, 272384
    buffer_load_dwordx4 v[44:47], v3, s[32:35], s101 offen offset:0 sc1
    s_waitcnt vmcnt(0)
    v_max3_u32 v8, v40, v41, v42
    v_max3_u32 v8, v8, v43, v44
    v_max3_u32 v8, v8, v45, v46
    v_max_u32 v8, v8, v47
    v_cmp_eq_u32 vcc, -1, v8
    s_cbranch_vccnz rty_97
    s_branch bk_98
rty_99:
    s_cmp_eq_u32 s55, 0
    s_cbranch_scc1 bk_100
    s_sub_u32 s55, s55, 1
    s_sleep 2
    s_add_u32 s101, s57, 286720
    buffer_load_dwordx4 v[48:51], v3, s[32:35], s101 offen offset:0 sc1
    s_add_u32 s101, s57, 301056
    buffer_load_dwordx4 v[52:55], v3, s[32:35], s101 offen offset:0 sc1
    s_waitcnt vmcnt(0)
    v_max3_u32 v8, v48, v49, v50
    v_max3_u32 v8, v8, v51, v52
    v_max3_u32 v8, v8, v53, v54
    v_max_u32 v8, v8, v55
    v_cmp_eq_u32 vcc, -1, v8
    s_cbranch_vccnz rty_99
    s_branch bk_100
rty_101:
    s_cmp_eq_u32 s55, 0
    s_cbranch_scc1 bk_102
    s_sub_u32 s55, s55, 1
    s_sleep 2
    s_add_u32 s101, s57, 315392
    buffer_load_dwordx4 v[56:59], v3, s[32:35], s101 offen offset:0 sc1
    s_add_u32 s101, s57, 329728
    buffer_load_dwordx4 v[60:63], v3, s[32:35], s101 offen offset:0 sc1
    s_waitcnt vmcnt(0)
    v_max3_u32 v8, v56, v57, v58
    v_max3_u32 v8, v8, v59, v60
    v_max3_u32 v8, v8, v61, v62
    v_max_u32 v8, v8, v63
    v_cmp_eq_u32 vcc, -1, v8
    s_cbranch_vccnz rty_101
    s_branch bk_102
rty_103:
    s_cmp_eq_u32 s55, 0
    s_cbranch_scc1 bk_104
    s_sub_u32 s55, s55, 1
    s_sleep 2
    s_add_u32 s101, s57, 344064
    buffer_load_dwordx4 v[64:67], v3, s[32:35], s101 offen offset:0 sc1
    s_add_u32 s101, s57, 358400
    buffer_load_dwordx4 v[68:71], v3, s[32:35], s101 offen offset:0 sc1
    s_waitcnt vmcnt(0)
    v_max3_u32 v8, v64, v65, v66
    v_max3_u32 v8, v8, v67, v68
    v_max3_u32 v8, v8, v69, v70
    v_max_u32 v8, v8, v71
    v_cmp_eq_u32 vcc, -1, v8
    s_cbranch_vccnz rty_103
    s_branch bk_104
rty_105:
    s_cmp_eq_u32 s55, 0
    s_cbranch_scc1 bk_106
    s_sub_u32 s55, s55, 1
    s_sleep 2
    s_add_u32 s101, s57, 372736
    buffer_load_dwordx4 v[72:75], v3, s[32:35], s101 offen offset:0 sc1
    s_add_u32 s101, s57, 387072
    buffer_load_dwordx4 v[76:79], v3, s[32:35], s101 offen offset:0 sc1
    s_waitcnt vmcnt(0)
    v_max3_u32 v8, v72, v73, v74
    v_max3_u32 v8, v8, v75, v76
    v_max3_u32 v8, v8, v77, v78
    v_max_u32 v8, v8, v79
    v_cmp_eq_u32 vcc, -1, v8
    s_cbranch_vccnz rty_105
    s_branch bk_106
rty_107:
    s_cmp_eq_u32 s55, 0
    s_cbranch_scc1 bk_108
    s_sub_u32 s55, s55, 1
    s_sleep 2
    s_add_u32 s101, s57, 0
    buffer_load_dwordx4 v[80:83], v3, s[32:35], s101 offen offset:512 sc1
    s_add_u32 s101, s57, 14336
    buffer_load_dwordx4 v[84:87], v3, s[32:35], s101 offen offset:512 sc1
    s_add_u32 s101, s57, 28672
    buffer_load_dwordx4 v[88:91], v3, s[32:35], s101 offen offset:512 sc1
    s_add_u32 s101, s57, 43008
    buffer_load_dwordx4 v[92:95], v3, s[32:35], s101 offen offset:512 sc1
    s_add_u32 s101, s57, 57344
    buffer_load_dwordx4 v[32:35], v3, s[32:35], s101 offen offset:512 sc1
    s_add_u32 s101, s57, 71680
    buffer_load_dwordx4 v[36:39], v3, s[32:35], s101 offen offset:512 sc1
    s_add_u32 s101, s57, 86016
    buffer_load_dwordx4 v[40:43], v3, s[32:35], s101 offen offset:512 sc1
    s_add_u32 s101, s57, 100352
    buffer_load_dwordx4 v[44:47], v3, s[32:35], s101 offen offset:512 sc1
    s_add_u32 s101, s57, 114688
    buffer_load_dwordx4 v[48:51], v3, s[32:35], s101 offen offset:512 sc1
    s_add_u32 s101, s57, 129024
    buffer_load_dwordx4 v[52:55], v3, s[32:35], s101 offen offset:512 sc1
    s_add_u32 s101, s57, 143360
    buffer_load_dwordx4 v[56:59], v3, s[32:35], s101 offen offset:512 sc1
    s_add_u32 s101, s57, 157696
    buffer_load_dwordx4 v[60:63], v3, s[32:35], s101 offen offset:512 sc1
    s_waitcnt vmcnt(0)
    v_max3_u32 v8, v80, v81, v82
    v_max3_u32 v8, v8, v83, v84
    v_max3_u32 v8, v8, v85, v86
    v_max_u32 v8, v8, v87
    v_cmp_eq_u32 vcc, -1, v8
    s_cbranch_vccnz rty_107
    s_branch bk_108
rty_109:
    s_cmp_eq_u32 s55, 0
    s_cbranch_scc1 bk_110
    s_sub_u32 s55, s55, 1
    s_sleep 2
    s_add_u32 s101, s57, 28672
    buffer_load_dwordx4 v[88:91], v3, s[32:35], s101 offen offset:512 sc1
    s_add_u32 s101, s57, 43008
    buffer_load_dwordx4 v[92:95], v3, s[32:35], s101 offen offset:512 sc1
    s_add_u32 s101, s57, 57344
    buffer_load_dwordx4 v[32:35], v3, s[32:35], s101 offen offset:512 sc1
    s_add_u32 s101, s57, 71680
    buffer_load_dwordx4 v[36:39], v3, s[32:35], s101 offen offset:512 sc1
    s_add_u32 s101, s57, 86016
    buffer_load_dwordx4 v[40:43], v3, s[32:35], s101 offen offset:512 sc1
    s_add_u32 s101, s57, 100352
    buffer_load_dwordx4 v[44:47], v3, s[32:35], s101 offen offset:512 sc1
    s_add_u32 s101, s57, 114688
    buffer_load_dwordx4 v[48:51], v3, s[32:35], s101 offen offset:512 sc1
    s_add_u32 s101, s57, 129024
    buffer_load_dwordx4 v[52:55], v3, s[32:35], s101 offen offset:512 sc1
    s_add_u32 s101, s57, 143360
    buffer_load_dwordx4 v[56:59], v3, s[32:35], s101 offen offset:512 sc1
    s_add_u32 s101, s57, 157696
    buffer_load_dwordx4 v[60:63], v3, s[32:35], s101 offen offset:512 sc1
    s_add_u32 s101, s57, 172032
    buffer_load_dwordx4 v[64:67], v3, s[32:35], s101 offen offset:512 sc1
    s_add_u32 s101, s57, 186368
    buffer_load_dwordx4 v[68:71], v3, s[32:35], s101 offen offset:512 sc1
    s_waitcnt vmcnt(0)
    v_max3_u32 v8, v88, v89, v90
    v_max3_u32 v8, v8, v91, v92
    v_max3_u32 v8, v8, v93, v94
    v_max_u32 v8, v8, v95
    v_cmp_eq_u32 vcc, -1, v8
    s_cbranch_vccnz rty_109
    s_branch bk_110
rty_111:
    s_cmp_eq_u32 s55, 0
    s_cbranch_scc1 bk_112
    s_sub_u32 s55, s55, 1
    s_sleep 2
    s_add_u32 s101, s57, 57344
    buffer_load_dwordx4 v[32:35], v3, s[32:35], s101 offen offset:512 sc1
    s_add_u32 s101, s57, 71680
    buffer_load_dwordx4 v[36:39], v3, s[32:35], s101 offen offset:512 sc1
    s_waitcnt vmcnt(0)
    v_max3_u32 v8, v32, v33, v34
    v_max3_u32 v8, v8, v35, v36
    v_max3_u32 v8, v8, v37, v38
    v_max_u32 v8, v8, v39
    v_cmp_eq_u32 vcc, -1, v8
    s_cbranch_vccnz rty_111
    s_branch bk_112
rty_113:
    s_cmp_eq_u32 s55, 0
    s_cbranch_scc1 bk_114
    s_sub_u32 s55, s55, 1
    s_sleep 2
    s_add_u32 s101, s57, 86016
    buffer_load_dwordx4 v[40:43], v3, s[32:35], s101 offen offset:512 sc1
    s_add_u32 s101, s57, 100352
    buffer_load_dwordx4 v[44:47], v3, s[32:35], s101 offen offset:512 sc1
    s_waitcnt vmcnt(0)
    v_max3_u32 v8, v40, v41, v42
    v_max3_u32 v8, v8, v43, v44
    v_max3_u32 v8, v8, v45, v46
    v_max_u32 v8, v8, v47
    v_cmp_eq_u32 vcc, -1, v8
    s_cbranch_vccnz rty_113
    s_branch bk_114
rty_115:
    s_cmp_eq_u32 s55, 0
    s_cbranch_scc1 bk_116
    s_sub_u32 s55, s55, 1
    s_sleep 2
    s_add_u32 s101, s57, 114688
    buffer_load_dwordx4 v[48:51], v3, s[32:35], s101 offen offset:512 sc1
    s_add_u32 s101, s57, 129024
    buffer_load_dwordx4 v[52:55], v3, s[32:35], s101 offen offset:512 sc1
    s_waitcnt vmcnt(0)
    v_max3_u32 v8, v48, v49, v50
    v_max3_u32 v8, v8, v51, v52
    v_max3_u32 v8, v8, v53, v54
    v_max_u32 v8, v8, v55
    v_cmp_eq_u32 vcc, -1, v8
    s_cbranch_vccnz rty_115
    s_branch bk_116
rty_117:
    s_cmp_eq_u32 s55, 0
    s_cbranch_scc1 bk_118
    s_sub_u32 s55, s55, 1
    s_sleep 2
    s_add_u32 s101, s57, 143360
    buffer_load_dwordx4 v[56:59], v3, s[32:35], s101 offen offset:512 sc1
    s_add_u32 s101, s57, 157696
    buffer_load_dwordx4 v[60:63], v3, s[32:35], s101 offen offset:512 sc1
    s_waitcnt vmcnt(0)
    v_max3_u32 v8, v56, v57, v58
    v_max3_u32 v8, v8, v59, v60
    v_max3_u32 v8, v8, v61, v62
    v_max_u32 v8, v8, v63
    v_cmp_eq_u32 vcc, -1, v8
    s_cbranch_vccnz rty_117
    s_branch bk_118
rty_119:
    s_cmp_eq_u32 s55, 0
    s_cbranch_scc1 bk_120
    s_sub_u32 s55, s55, 1
    s_sleep 2
    s_add_u32 s101, s57, 172032
    buffer_load_dwordx4 v[64:67], v3, s[32:35], s101 offen offset:512 sc1
    s_add_u32 s101, s57, 186368
    buffer_load_dwordx4 v[68:71], v3, s[32:35], s101 offen offset:512 sc1
    s_waitcnt vmcnt(0)
    v_max3_u32 v8, v64, v65, v66
    v_max3_u32 v8, v8, v67, v68
    v_max3_u32 v8, v8, v69, v70
    v_max_u32 v8, v8, v71
    v_cmp_eq_u32 vcc, -1, v8
    s_cbranch_vccnz rty_119
    s_branch bk_120
rty_121:
    s_cmp_eq_u32 s55, 0
    s_cbranch_scc1 bk_122
    s_sub_u32 s55, s55, 1
    s_sleep 2
    s_add_u32 s101, s57, 200704
    buffer_load_dwordx4 v[72:75], v3, s[32:35], s101 offen offset:512 sc1
    s_add_u32 s101, s57, 215040
    buffer_load_dwordx4 v[76:79], v3, s[32:35], s101 offen offset:512 sc1
    s_waitcnt vmcnt(0)
    v_max3_u32 v8, v72, v73, v74
    v_max3_u32 v8, v8, v75, v76
    v_max3_u32 v8, v8, v77, v78
    v_max_u32 v8, v8, v79
    v_cmp_eq_u32 vcc, -1, v8
    s_cbranch_vccnz rty_121
    s_branch bk_122
rty_123:
    s_cmp_eq_u32 s55, 0
    s_cbranch_scc1 bk_124
    s_sub_u32 s55, s55, 1
    s_sleep 2
    s_add_u32 s101, s57, 229376
    buffer_load_dwordx4 v[80:83], v3, s[32:35], s101 offen offset:512 sc1
    s_add_u32 s101, s57, 243712
    buffer_load_dwordx4 v[84:87], v3, s[32:35], s101 offen offset:512 sc1
    s_waitcnt vmcnt(0)
    v_max3_u32 v8, v80, v81, v82
    v_max3_u32 v8, v8, v83, v84
    v_max3_u32 v8, v8, v85, v86
    v_max_u32 v8, v8, v87
    v_cmp_eq_u32 vcc, -1, v8
    s_cbranch_vccnz rty_123
    s_branch bk_124
rty_125:
    s_cmp_eq_u32 s55, 0
    s_cbranch_scc1 bk_126
    s_sub_u32 s55, s55, 1
    s_sleep 2
    s_add_u32 s101, s57, 258048
    buffer_load_dwordx4 v[88:91], v3, s[32:35], s101 offen offset:512 sc1
    s_add_u32 s101, s57, 272384
    buffer_load_dwordx4 v[92:95], v3, s[32:35], s101 offen offset:512 sc1
    s_waitcnt vmcnt(0)
    v_max3_u32 v8, v88, v89, v90
    v_max3_u32 v8, v8, v91, v92
    v_max3_u32 v8, v8, v93, v94
    v_max_u32 v8, v8, v95
    v_cmp_eq_u32 vcc, -1, v8
    s_cbranch_vccnz rty_125
    s_branch bk_126
rty_127:
    s_cmp_eq_u32 s55, 0
    s_cbranch_scc1 bk_128
    s_sub_u32 s55, s55, 1
    s_sleep 2
    s_add_u32 s101, s57, 286720
    buffer_load_dwordx4 v[32:35], v3, s[32:35], s101 offen offset:512 sc1
    s_add_u32 s101, s57, 301056
    buffer_load_dwordx4 v[36:39], v3, s[32:35], s101 offen offset:512 sc1
    s_waitcnt vmcnt(0)
    v_max3_u32 v8, v32, v33, v34
    v_max3_u32 v8, v8, v35, v36
    v_max3_u32 v8, v8, v37, v38
    v_max_u32 v8, v8, v39
    v_cmp_eq_u32 vcc, -1, v8
    s_cbranch_vccnz rty_127
    s_branch bk_128
rty_129:
    s_cmp_eq_u32 s55, 0
    s_cbranch_scc1 bk_130
    s_sub_u32 s55, s55, 1
    s_sleep 2
    s_add_u32 s101, s57, 315392
    buffer_load_dwordx4 v[40:43], v3, s[32:35], s101 offen offset:512 sc1
    s_add_u32 s101, s57, 329728
    buffer_load_dwordx4 v[44:47], v3, s[32:35], s101 offen offset:512 sc1
    s_waitcnt vmcnt(0)
    v_max3_u32 v8, v40, v41, v42
    v_max3_u32 v8, v8, v43, v44
    v_max3_u32 v8, v8, v45, v46
    v_max_u32 v8, v8, v47
    v_cmp_eq_u32 vcc, -1, v8
    s_cbranch_vccnz rty_129
    s_branch bk_130
rty_131:
    s_cmp_eq_u32 s55, 0
    s_cbranch_scc1 bk_132
    s_sub_u32 s55, s55, 1
    s_sleep 2
    s_add_u32 s101, s57, 344064
    buffer_load_dwordx4 v[48:51], v3, s[32:35], s101 offen offset:512 sc1
    s_add_u32 s101, s57, 358400
    buffer_load_dwordx4 v[52:55], v3, s[32:35], s101 offen offset:512 sc1
    s_waitcnt vmcnt(0)
    v_max3_u32 v8, v48, v49, v50
    v_max3_u32 v8, v8, v51, v52
    v_max3_u32 v8, v8, v53, v54
    v_max_u32 v8, v8, v55
    v_cmp_eq_u32 vcc, -1, v8
    s_cbranch_vccnz rty_131
    s_branch bk_132
rty_133:
    s_cmp_eq_u32 s55, 0
    s_cbranch_scc1 bk_134
    s_sub_u32 s55, s55, 1
    s_sleep 2
    s_add_u32 s101, s57, 372736
    buffer_load_dwordx4 v[56:59], v3, s[32:35], s101 offen offset:512 sc1
    s_add_u32 s101, s57, 387072
    buffer_load_dwordx4 v[60:63], v3, s[32:35], s101 offen offset:512 sc1
    s_waitcnt vmcnt(0)
    v_max3_u32 v8, v56, v57, v58
    v_max3_u32 v8, v8, v59, v60
    v_max3_u32 v8, v8, v61, v62
    v_max_u32 v8, v8, v63
    v_cmp_eq_u32 vcc, -1, v8
    s_cbranch_vccnz rty_133
    s_branch bk_134
b1skip_144:
    s_waitcnt vmcnt(0)
    s_cmp_lg_u32 s54, 0
    s_cbranch_scc1 b2skip_145
    s_xor_b32 s98, s49, 0
    s_mul_i32 s98, s98, 6144
    v_add_u32 v10, s98, v6
    s_xor_b32 s98, s49, 1
    s_mul_i32 s98, s98, 6144
    v_add_u32 v11, s98, v6
    s_xor_b32 s98, s49, 2
    s_mul_i32 s98, s98, 6144
    v_add_u32 v12, s98, v6
    s_xor_b32 s98, s49, 3
    s_mul_i32 s98, s98, 6144
    v_add_u32 v13, s98, v6
    s_sleep 32
poll_274:
    s_add_u32 s101, s57, 0
    buffer_load_dwordx4 v[32:35], v3, s[32:35], s101 offen offset:0 sc1
    s_add_u32 s101, s57, 14336
    buffer_load_dwordx4 v[36:39], v3, s[32:35], s101 offen offset:0 sc1
    s_waitcnt vmcnt(0)
    v_max3_u32 v8, v32, v33, v34
    v_max3_u32 v8, v8, v35, v36
    v_max3_u32 v8, v8, v37, v38
    v_max_u32 v8, v8, v39
    v_cmp_eq_u32 vcc, -1, v8
    s_cbranch_vccz pollok_275
    s_cmp_eq_u32 s55, 0
    s_cbranch_scc1 pollok_275
    s_sub_u32 s55, s55, 1
    s_mov_b64 exec, vcc
    s_sleep 8
    s_branch poll_274
pollok_275:
    s_mov_b64 exec, -1
    s_add_u32 s101, s57, 28672
    buffer_load_dwordx4 v[40:43], v3, s[32:35], s101 offen offset:0 sc1
    s_add_u32 s101, s57, 43008
    buffer_load_dwordx4 v[44:47], v3, s[32:35], s101 offen offset:0 sc1
    s_add_u32 s101, s57, 57344
    buffer_load_dwordx4 v[48:51], v3, s[32:35], s101 offen offset:0 sc1
    s_add_u32 s101, s57, 71680
    buffer_load_dwordx4 v[52:55], v3, s[32:35], s101 offen offset:0 sc1
    s_add_u32 s101, s57, 86016
    buffer_load_dwordx4 v[56:59], v3, s[32:35], s101 offen offset:0 sc1
    s_add_u32 s101, s57, 100352
    buffer_load_dwordx4 v[60:63], v3, s[32:35], s101 offen offset:0 sc1
    s_add_u32 s101, s57, 114688
    buffer_load_dwordx4 v[64:67], v3, s[32:35], s101 offen offset:0 sc1
    s_add_u32 s101, s57, 129024
    buffer_load_dwordx4 v[68:71], v3, s[32:35], s101 offen offset:0 sc1
    s_add_u32 s101, s57, 143360
    buffer_load_dwordx4 v[72:75], v3, s[32:35], s101 offen offset:0 sc1
    s_add_u32 s101, s57, 157696
    buffer_load_dwordx4 v[76:79], v3, s[32:35], s101 offen offset:0 sc1
    v_lshlrev_b32 v96, 16, v26
    v_mov_b32 v104, 0
    v_lshlrev_b32 v97, 16, v26
    v_mov_b32 v105, 0
    v_lshlrev_b32 v98, 16, v26
    v_mov_b32 v106, 0
    v_lshlrev_b32 v99, 16, v26
    v_mov_b32 v107, 0
    v_lshlrev_b32 v100, 16, v26
    v_mov_b32 v108, 0
    v_lshlrev_b32 v101, 16, v26
    v_mov_b32 v109, 0
    v_lshlrev_b32 v102, 16, v26
    v_mov_b32 v110, 0
    v_lshlrev_b32 v103, 16, v26
    v_mov_b32 v111, 0
    s_waitcnt vmcnt(0)
    s_branch b2e_146
b2skip_145:
    s_waitcnt vmcnt(0)
    s_branch bdone_269
rty_147:
    s_cmp_eq_u32 s55, 0
    s_cbranch_scc1 bk_148
    s_sub_u32 s55, s55, 1
    s_add_u32 s101, s56, 0
    buffer_load_dwordx4 v[32:35], v2, s[32:35], s101 offen offset:0 sc1
    s_add_u32 s101, s56, 14336
    buffer_load_dwordx4 v[36:39], v2, s[32:35], s101 offen offset:0 sc1
    s_add_u32 s101, s56, 28672
    buffer_load_dwordx4 v[40:43], v2, s[32:35], s101 offen offset:0 sc1
    s_add_u32 s101, s56, 43008
    buffer_load_dwordx4 v[44:47], v2, s[32:35], s101 offen offset:0 sc1
    s_add_u32 s101, s56, 57344
    buffer_load_dwordx4 v[48:51], v2, s[32:35], s101 offen offset:0 sc1
    s_add_u32 s101, s56, 71680
    buffer_load_dwordx4 v[52:55], v2, s[32:35], s101 offen offset:0 sc1
    s_add_u32 s101, s56, 86016
    buffer_load_dwordx4 v[56:59], v2, s[32:35], s101 offen offset:0 sc1
    s_add_u32 s101, s56, 100352
    buffer_load_dwordx4 v[60:63], v2, s[32:35], s101 offen offset:0 sc1
    s_add_u32 s101, s56, 114688
    buffer_load_dwordx4 v[64:67], v2, s[32:35], s101 offen offset:0 sc1
    s_add_u32 s101, s56, 129024
    buffer_load_dwordx4 v[68:71], v2, s[32:35], s101 offen offset:0 sc1
    s_add_u32 s101, s56, 143360
    buffer_load_dwordx4 v[72:75], v2, s[32:35], s101 offen offset:0 sc1
    s_add_u32 s101, s56, 157696
    buffer_load_dwordx4 v[76:79], v2, s[32:35], s101 offen offset:0 sc1
    s_waitcnt vmcnt(10)
    v_max3_u32 v8, v32, v33, v34
    v_max3_u32 v8, v8, v35, v36
    v_max3_u32 v8, v8, v37, v38
    v_max_u32 v8, v8, v39
    v_cmp_eq_u32 vcc, -1, v8
    s_cbranch_vccnz rty_147
    s_branch bk_148
rty_149:
    s_cmp_eq_u32 s55, 0
    s_cbranch_scc1 bk_150
    s_sub_u32 s55, s55, 1
    s_add_u32 s101, s56, 28672
    buffer_load_dwordx4 v[40:43], v2, s[32:35], s101 offen offset:0 sc1
    s_add_u32 s101, s56, 43008
    buffer_load_dwordx4 v[44:47], v2, s[32:35], s101 offen offset:0 sc1
    s_add_u32 s101, s56, 57344
    buffer_load_dwordx4 v[48:51], v2, s[32:35], s101 offen offset:0 sc1
    s_add_u32 s101, s56, 71680
    buffer_load_dwordx4 v[52:55], v2, s[32:35], s101 offen offset:0 sc1
    s_add_u32 s101, s56, 86016
    buffer_load_dwordx4 v[56:59], v2, s[32:35], s101 offen offset:0 sc1
    s_add_u32 s101, s56, 100352
    buffer_load_dwordx4 v[60:63], v2, s[32:35], s101 offen offset:0 sc1
    s_add_u32 s101, s56, 114688
    buffer_load_dwordx4 v[64:67], v2, s[32:35], s101 offen offset:0 sc1
    s_add_u32 s101, s56, 129024
    buffer_load_dwordx4 v[68:71], v2, s[32:35], s101 offen offset:0 sc1
    s_add_u32 s101, s56, 143360
    buffer_load_dwordx4 v[72:75], v2, s[32:35], s101 offen offset:0 sc1
    s_add_u32 s101, s56, 157696
    buffer_load_dwordx4 v[76:79], v2, s[32:35], s101 offen offset:0 sc1
    s_add_u32 s101, s56, 172032
    buffer_load_dwordx4 v[80:83], v2, s[32:35], s101 offen offset:0 sc1
    s_add_u32 s101, s56, 186368
    buffer_load_dwordx4 v[84:87], v2, s[32:35], s101 offen offset:0 sc1
    s_waitcnt vmcnt(10)
    v_max3_u32 v8, v40, v41, v42
    v_max3_u32 v8, v8, v43, v44
    v_max3_u32 v8, v8, v45, v46
    v_max_u32 v8, v8, v47
    v_cmp_eq_u32 vcc, -1, v8
    s_cbranch_vccnz rty_149
    s_branch bk_150
rty_151:
    s_cmp_eq_u32 s55, 0
    s_cbranch_scc1 bk_152
    s_sub_u32 s55, s55, 1
    s_sleep 2
    s_add_u32 s101, s56, 57344
    buffer_load_dwordx4 v[48:51], v2, s[32:35], s101 offen offset:0 sc1
    s_add_u32 s101, s56, 71680
    buffer_load_dwordx4 v[52:55], v2, s[32:35], s101 offen offset:0 sc1
    s_waitcnt vmcnt(0)
    v_max3_u32 v8, v48, v49, v50
    v_max3_u32 v8, v8, v51, v52
    v_max3_u32 v8, v8, v53, v54
    v_max_u32 v8, v8, v55
    v_cmp_eq_u32 vcc, -1, v8
    s_cbranch_vccnz rty_151
    s_branch bk_152
rty_153:
    s_cmp_eq_u32 s55, 0
    s_cbranch_scc1 bk_154
    s_sub_u32 s55, s55, 1
    s_sleep 2
    s_add_u32 s101, s56, 86016
    buffer_load_dwordx4 v[56:59], v2, s[32:35], s101 offen offset:0 sc1
    s_add_u32 s101, s56, 100352
    buffer_load_dwordx4 v[60:63], v2, s[32:35], s101 offen offset:0 sc1
    s_waitcnt vmcnt(0)
    v_max3_u32 v8, v56, v57, v58
    v_max3_u32 v8, v8, v59, v60
    v_max3_u32 v8, v8, v61, v62
    v_max_u32 v8, v8, v63
    v_cmp_eq_u32 vcc, -1, v8
    s_cbranch_vccnz rty_153
    s_branch bk_154
rty_155:
    s_cmp_eq_u32 s55, 0
    s_cbranch_scc1 bk_156
    s_sub_u32 s55, s55, 1
    s_sleep 2
    s_add_u32 s101, s56, 114688
    buffer_load_dwordx4 v[64:67], v2, s[32:35], s101 offen offset:0 sc1
    s_add_u32 s101, s56, 129024
    buffer_load_dwordx4 v[68:71], v2, s[32:35], s101 offen offset:0 sc1
    s_waitcnt vmcnt(0)
    v_max3_u32 v8, v64, v65, v66
    v_max3_u32 v8, v8, v67, v68
    v_max3_u32 v8, v8, v69, v70
    v_max_u32 v8, v8, v71
    v_cmp_eq_u32 vcc, -1, v8
    s_cbranch_vccnz rty_155
    s_branch bk_156
rty_157:
    s_cmp_eq_u32 s55, 0
    s_cbranch_scc1 bk_158
    s_sub_u32 s55, s55, 1
    s_sleep 2
    s_add_u32 s101, s56, 143360
    buffer_load_dwordx4 v[72:75], v2, s[32:35], s101 offen offset:0 sc1
    s_add_u32 s101, s56, 157696
    buffer_load_dwordx4 v[76:79], v2, s[32:35], s101 offen offset:0 sc1
    s_waitcnt vmcnt(0)
    v_max3_u32 v8, v72, v73, v74
    v_max3_u32 v8, v8, v75, v76
    v_max3_u32 v8, v8, v77, v78
    v_max_u32 v8, v8, v79
    v_cmp_eq_u32 vcc, -1, v8
    s_cbranch_vccnz rty_157
    s_branch bk_158
rty_159:
    s_cmp_eq_u32 s55, 0
    s_cbranch_scc1 bk_160
    s_sub_u32 s55, s55, 1
    s_sleep 2
    s_add_u32 s101, s56, 172032
    buffer_load_dwordx4 v[80:83], v2, s[32:35], s101 offen offset:0 sc1
    s_add_u32 s101, s56, 186368
    buffer_load_dwordx4 v[84:87], v2, s[32:35], s101 offen offset:0 sc1
    s_waitcnt vmcnt(0)
    v_max3_u32 v8, v80, v81, v82
    v_max3_u32 v8, v8, v83, v84
    v_max3_u32 v8, v8, v85, v86
    v_max_u32 v8, v8, v87
    v_cmp_eq_u32 vcc, -1, v8
    s_cbranch_vccnz rty_159
    s_branch bk_160
rty_161:
    s_cmp_eq_u32 s55, 0
    s_cbranch_scc1 bk_162
    s_sub_u32 s55, s55, 1
    s_sleep 2
    s_add_u32 s101, s56, 200704
    buffer_load_dwordx4 v[88:91], v2, s[32:35], s101 offen offset:0 sc1
    s_add_u32 s101, s56, 215040
    buffer_load_dwordx4 v[92:95], v2, s[32:35], s101 offen offset:0 sc1
    s_waitcnt vmcnt(0)
    v_max3_u32 v8, v88, v89, v90
    v_max3_u32 v8, v8, v91, v92
    v_max3_u32 v8, v8, v93, v94
    v_max_u32 v8, v8, v95
    v_cmp_eq_u32 vcc, -1, v8
    s_cbranch_vccnz rty_161
    s_branch bk_162
rty_163:
    s_cmp_eq_u32 s55, 0
    s_cbranch_scc1 bk_164
    s_sub_u32 s55, s55, 1
    s_sleep 2
    s_add_u32 s101, s56, 229376
    buffer_load_dwordx4 v[32:35], v2, s[32:35], s101 offen offset:0 sc1
    s_add_u32 s101, s56, 243712
    buffer_load_dwordx4 v[36:39], v2, s[32:35], s101 offen offset:0 sc1
    s_waitcnt vmcnt(0)
    v_max3_u32 v8, v32, v33, v34
    v_max3_u32 v8, v8, v35, v36
    v_max3_u32 v8, v8, v37, v38
    v_max_u32 v8, v8, v39
    v_cmp_eq_u32 vcc, -1, v8
    s_cbranch_vccnz rty_163
    s_branch bk_164
rty_165:
    s_cmp_eq_u32 s55, 0
    s_cbranch_scc1 bk_166
    s_sub_u32 s55, s55, 1
    s_sleep 2
    s_add_u32 s101, s56, 258048
    buffer_load_dwordx4 v[40:43], v2, s[32:35], s101 offen offset:0 sc1
    s_add_u32 s101, s56, 272384
    buffer_load_dwordx4 v[44:47], v2, s[32:35], s101 offen offset:0 sc1
    s_waitcnt vmcnt(0)
    v_max3_u32 v8, v40, v41, v42
    v_max3_u32 v8, v8, v43, v44
    v_max3_u32 v8, v8, v45, v46
    v_max_u32 v8, v8, v47
    v_cmp_eq_u32 vcc, -1, v8
    s_cbranch_vccnz rty_165
    s_branch bk_166
rty_167:
    s_cmp_eq_u32 s55, 0
    s_cbranch_scc1 bk_168
    s_sub_u32 s55, s55, 1
    s_sleep 2
    s_add_u32 s101, s56, 286720
    buffer_load_dwordx4 v[48:51], v2, s[32:35], s101 offen offset:0 sc1
    s_add_u32 s101, s56, 301056
    buffer_load_dwordx4 v[52:55], v2, s[32:35], s101 offen offset:0 sc1
    s_waitcnt vmcnt(0)
    v_max3_u32 v8, v48, v49, v50
    v_max3_u32 v8, v8, v51, v52
    v_max3_u32 v8, v8, v53, v54
    v_max_u32 v8, v8, v55
    v_cmp_eq_u32 vcc, -1, v8
    s_cbranch_vccnz rty_167
    s_branch bk_168
rty_169:
    s_cmp_eq_u32 s55, 0
    s_cbranch_scc1 bk_170
    s_sub_u32 s55, s55, 1
    s_sleep 2
    s_add_u32 s101, s56, 315392
    buffer_load_dwordx4 v[56:59], v2, s[32:35], s101 offen offset:0 sc1
    s_add_u32 s101, s56, 329728
    buffer_load_dwordx4 v[60:63], v2, s[32:35], s101 offen offset:0 sc1
    s_waitcnt vmcnt(0)
    v_max3_u32 v8, v56, v57, v58
    v_max3_u32 v8, v8, v59, v60
    v_max3_u32 v8, v8, v61, v62
    v_max_u32 v8, v8, v63
    v_cmp_eq_u32 vcc, -1, v8
    s_cbranch_vccnz rty_169
    s_branch bk_170
rty_171:
    s_cmp_eq_u32 s55, 0
    s_cbranch_scc1 bk_172
    s_sub_u32 s55, s55, 1
    s_sleep 2
    s_add_u32 s101, s56, 344064
    buffer_load_dwordx4 v[64:67], v2, s[32:35], s101 offen offset:0 sc1
    s_add_u32 s101, s56, 358400
    buffer_load_dwordx4 v[68:71], v2, s[32:35], s101 offen offset:0 sc1
    s_waitcnt vmcnt(0)
    v_max3_u32 v8, v64, v65, v66
    v_max3_u32 v8, v8, v67, v68
    v_max3_u32 v8, v8, v69, v70
    v_max_u32 v8, v8, v71
    v_cmp_eq_u32 vcc, -1, v8
    s_cbranch_vccnz rty_171
    s_branch bk_172
rty_173:
    s_cmp_eq_u32 s55, 0
    s_cbranch_scc1 bk_174
    s_sub_u32 s55, s55, 1
    s_sleep 2
    s_add_u32 s101, s56, 372736
    buffer_load_dwordx4 v[72:75], v2, s[32:35], s101 offen offset:0 sc1
    s_add_u32 s101, s56, 387072
    buffer_load_dwordx4 v[76:79], v2, s[32:35], s101 offen offset:0 sc1
    s_waitcnt vmcnt(0)
    v_max3_u32 v8, v72, v73, v74
    v_max3_u32 v8, v8, v75, v76
    v_max3_u32 v8, v8, v77, v78
    v_max_u32 v8, v8, v79
    v_cmp_eq_u32 vcc, -1, v8
    s_cbranch_vccnz rty_173
    s_branch bk_174
rty_175:
    s_cmp_eq_u32 s55, 0
    s_cbranch_scc1 bk_176
    s_sub_u32 s55, s55, 1
    s_sleep 2
    s_add_u32 s101, s56, 401408
    buffer_load_dwordx4 v[80:83], v2, s[32:35], s101 offen offset:0 sc1
    s_add_u32 s101, s56, 415744
    buffer_load_dwordx4 v[84:87], v2, s[32:35], s101 offen offset:0 sc1
    s_waitcnt vmcnt(0)
    v_max3_u32 v8, v80, v81, v82
    v_max3_u32 v8, v8, v83, v84
    v_max3_u32 v8, v8, v85, v86
    v_max_u32 v8, v8, v87
    v_cmp_eq_u32 vcc, -1, v8
    s_cbranch_vccnz rty_175
    s_branch bk_176
rty_177:
    s_cmp_eq_u32 s55, 0
    s_cbranch_scc1 bk_178
    s_sub_u32 s55, s55, 1
    s_sleep 2
    s_add_u32 s101, s56, 430080
    buffer_load_dwordx4 v[88:91], v2, s[32:35], s101 offen offset:0 sc1
    s_add_u32 s101, s56, 444416
    buffer_load_dwordx4 v[92:95], v2, s[32:35], s101 offen offset:0 sc1
    s_waitcnt vmcnt(0)
    v_max3_u32 v8, v88, v89, v90
    v_max3_u32 v8, v8, v91, v92
    v_max3_u32 v8, v8, v93, v94
    v_max_u32 v8, v8, v95
    v_cmp_eq_u32 vcc, -1, v8
    s_cbranch_vccnz rty_177
    s_branch bk_178
rty_179:
    s_cmp_eq_u32 s55, 0
    s_cbranch_scc1 bk_180
    s_sub_u32 s55, s55, 1
    s_sleep 2
    s_add_u32 s101, s56, 0
    buffer_load_dwordx4 v[32:35], v2, s[32:35], s101 offen offset:512 sc1
    s_add_u32 s101, s56, 14336
    buffer_load_dwordx4 v[36:39], v2, s[32:35], s101 offen offset:512 sc1
    s_waitcnt vmcnt(0)
    v_max3_u32 v8, v32, v33, v34
    v_max3_u32 v8, v8, v35, v36
    v_max3_u32 v8, v8, v37, v38
    v_max_u32 v8, v8, v39
    v_cmp_eq_u32 vcc, -1, v8
    s_cbranch_vccnz rty_179
    s_branch bk_180
rty_181:
    s_cmp_eq_u32 s55, 0
    s_cbranch_scc1 bk_182
    s_sub_u32 s55, s55, 1
    s_sleep 2
    s_add_u32 s101, s56, 28672
    buffer_load_dwordx4 v[40:43], v2, s[32:35], s101 offen offset:512 sc1
    s_add_u32 s101, s56, 43008
    buffer_load_dwordx4 v[44:47], v2, s[32:35], s101 offen offset:512 sc1
    s_waitcnt vmcnt(0)
    v_max3_u32 v8, v40, v41, v42
    v_max3_u32 v8, v8, v43, v44
    v_max3_u32 v8, v8, v45, v46
    v_max_u32 v8, v8, v47
    v_cmp_eq_u32 vcc, -1, v8
    s_cbranch_vccnz rty_181
    s_branch bk_182
rty_183:
    s_cmp_eq_u32 s55, 0
    s_cbranch_scc1 bk_184
    s_sub_u32 s55, s55, 1
    s_sleep 2
    s_add_u32 s101, s56, 57344
    buffer_load_dwordx4 v[48:51], v2, s[32:35], s101 offen offset:512 sc1
    s_add_u32 s101, s56, 71680
    buffer_load_dwordx4 v[52:55], v2, s[32:35], s101 offen offset:512 sc1
    s_waitcnt vmcnt(0)
    v_max3_u32 v8, v48, v49, v50
    v_max3_u32 v8, v8, v51, v52
    v_max3_u32 v8, v8, v53, v54
    v_max_u32 v8, v8, v55
    v_cmp_eq_u32 vcc, -1, v8
    s_cbranch_vccnz rty_183
    s_branch bk_184
rty_185:
    s_cmp_eq_u32 s55, 0
    s_cbranch_scc1 bk_186
    s_sub_u32 s55, s55, 1
    s_sleep 2
    s_add_u32 s101, s56, 86016
    buffer_load_dwordx4 v[56:59], v2, s[32:35], s101 offen offset:512 sc1
    s_add_u32 s101, s56, 100352
    buffer_load_dwordx4 v[60:63], v2, s[32:35], s101 offen offset:512 sc1
    s_waitcnt vmcnt(0)
    v_max3_u32 v8, v56, v57, v58
    v_max3_u32 v8, v8, v59, v60
    v_max3_u32 v8, v8, v61, v62
    v_max_u32 v8, v8, v63
    v_cmp_eq_u32 vcc, -1, v8
    s_cbranch_vccnz rty_185
    s_branch bk_186
rty_187:
    s_cmp_eq_u32 s55, 0
    s_cbranch_scc1 bk_188
    s_sub_u32 s55, s55, 1
    s_sleep 2
    s_add_u32 s101, s56, 114688
    buffer_load_dwordx4 v[64:67], v2, s[32:35], s101 offen offset:512 sc1
    s_add_u32 s101, s56, 129024
    buffer_load_dwordx4 v[68:71], v2, s[32:35], s101 offen offset:512 sc1
    s_waitcnt vmcnt(0)
    v_max3_u32 v8, v64, v65, v66
    v_max3_u32 v8, v8, v67, v68
    v_max3_u32 v8, v8, v69, v70
    v_max_u32 v8, v8, v71
    v_cmp_eq_u32 vcc, -1, v8
    s_cbranch_vccnz rty_187
    s_branch bk_188
rty_189:
    s_cmp_eq_u32 s55, 0
    s_cbranch_scc1 bk_190
    s_sub_u32 s55, s55, 1
    s_sleep 2
    s_add_u32 s101, s56, 143360
    buffer_load_dwordx4 v[72:75], v2, s[32:35], s101 offen offset:512 sc1
    s_add_u32 s101, s56, 157696
    buffer_load_dwordx4 v[76:79], v2, s[32:35], s101 offen offset:512 sc1
    s_waitcnt vmcnt(0)
    v_max3_u32 v8, v72, v73, v74
    v_max3_u32 v8, v8, v75, v76
    v_max3_u32 v8, v8, v77, v78
    v_max_u32 v8, v8, v79
    v_cmp_eq_u32 vcc, -1, v8
    s_cbranch_vccnz rty_189
    s_branch bk_190
rty_191:
    s_cmp_eq_u32 s55, 0
    s_cbranch_scc1 bk_192
    s_sub_u32 s55, s55, 1
    s_sleep 2
    s_add_u32 s101, s56, 172032
    buffer_load_dwordx4 v[80:83], v2, s[32:35], s101 offen offset:512 sc1
    s_add_u32 s101, s56, 186368
    buffer_load_dwordx4 v[84:87], v2, s[32:35], s101 offen offset:512 sc1
    s_waitcnt vmcnt(0)
    v_max3_u32 v8, v80, v81, v82
    v_max3_u32 v8, v8, v83, v84
    v_max3_u32 v8, v8, v85, v86
    v_max_u32 v8, v8, v87
    v_cmp_eq_u32 vcc, -1, v8
    s_cbranch_vccnz rty_191
    s_branch bk_192
rty_193:
    s_cmp_eq_u32 s55, 0
    s_cbranch_scc1 bk_194
    s_sub_u32 s55, s55, 1
    s_sleep 2
    s_add_u32 s101, s56, 200704
    buffer_load_dwordx4 v[88:91], v2, s[32:35], s101 offen offset:512 sc1
    s_add_u32 s101, s56, 215040
    buffer_load_dwordx4 v[92:95], v2, s[32:35], s101 offen offset:512 sc1
    s_waitcnt vmcnt(0)
    v_max3_u32 v8, v88, v89, v90
    v_max3_u32 v8, v8, v91, v92
    v_max3_u32 v8, v8, v93, v94
    v_max_u32 v8, v8, v95
    v_cmp_eq_u32 vcc, -1, v8
    s_cbranch_vccnz rty_193
    s_branch bk_194
rty_195:
    s_cmp_eq_u32 s55, 0
    s_cbranch_scc1 bk_196
    s_sub_u32 s55, s55, 1
    s_sleep 2
    s_add_u32 s101, s56, 229376
    buffer_load_dwordx4 v[32:35], v2, s[32:35], s101 offen offset:512 sc1
    s_add_u32 s101, s56, 243712
    buffer_load_dwordx4 v[36:39], v2, s[32:35], s101 offen offset:512 sc1
    s_waitcnt vmcnt(0)
    v_max3_u32 v8, v32, v33, v34
    v_max3_u32 v8, v8, v35, v36
    v_max3_u32 v8, v8, v37, v38
    v_max_u32 v8, v8, v39
    v_cmp_eq_u32 vcc, -1, v8
    s_cbranch_vccnz rty_195
    s_branch bk_196
rty_197:
    s_cmp_eq_u32 s55, 0
    s_cbranch_scc1 bk_198
    s_sub_u32 s55, s55, 1
    s_sleep 2
    s_add_u32 s101, s56, 258048
    buffer_load_dwordx4 v[40:43], v2, s[32:35], s101 offen offset:512 sc1
    s_add_u32 s101, s56, 272384
    buffer_load_dwordx4 v[44:47], v2, s[32:35], s101 offen offset:512 sc1
    s_waitcnt vmcnt(0)
    v_max3_u32 v8, v40, v41, v42
    v_max3_u32 v8, v8, v43, v44
    v_max3_u32 v8, v8, v45, v46
    v_max_u32 v8, v8, v47
    v_cmp_eq_u32 vcc, -1, v8
    s_cbranch_vccnz rty_197
    s_branch bk_198
rty_199:
    s_cmp_eq_u32 s55, 0
    s_cbranch_scc1 bk_200
    s_sub_u32 s55, s55, 1
    s_sleep 2
    s_add_u32 s101, s56, 286720
    buffer_load_dwordx4 v[48:51], v2, s[32:35], s101 offen offset:512 sc1
    s_add_u32 s101, s56, 301056
    buffer_load_dwordx4 v[52:55], v2, s[32:35], s101 offen offset:512 sc1
    s_waitcnt vmcnt(0)
    v_max3_u32 v8, v48, v49, v50
    v_max3_u32 v8, v8, v51, v52
    v_max3_u32 v8, v8, v53, v54
    v_max_u32 v8, v8, v55
    v_cmp_eq_u32 vcc, -1, v8
    s_cbranch_vccnz rty_199
    s_branch bk_200
rty_201:
    s_cmp_eq_u32 s55, 0
    s_cbranch_scc1 bk_202
    s_sub_u32 s55, s55, 1
    s_sleep 2
    s_add_u32 s101, s56, 315392
    buffer_load_dwordx4 v[56:59], v2, s[32:35], s101 offen offset:512 sc1
    s_add_u32 s101, s56, 329728
    buffer_load_dwordx4 v[60:63], v2, s[32:35], s101 offen offset:512 sc1
    s_waitcnt vmcnt(0)
    v_max3_u32 v8, v56, v57, v58
    v_max3_u32 v8, v8, v59, v60
    v_max3_u32 v8, v8, v61, v62
    v_max_u32 v8, v8, v63
    v_cmp_eq_u32 vcc, -1, v8
    s_cbranch_vccnz rty_201
    s_branch bk_202
rty_203:
    s_cmp_eq_u32 s55, 0
    s_cbranch_scc1 bk_204
    s_sub_u32 s55, s55, 1
    s_sleep 2
    s_add_u32 s101, s56, 344064
    buffer_load_dwordx4 v[64:67], v2, s[32:35], s101 offen offset:512 sc1
    s_add_u32 s101, s56, 358400
    buffer_load_dwordx4 v[68:71], v2, s[32:35], s101 offen offset:512 sc1
    s_waitcnt vmcnt(0)
    v_max3_u32 v8, v64, v65, v66
    v_max3_u32 v8, v8, v67, v68
    v_max3_u32 v8, v8, v69, v70
    v_max_u32 v8, v8, v71
    v_cmp_eq_u32 vcc, -1, v8
    s_cbranch_vccnz rty_203
    s_branch bk_204
rty_205:
    s_cmp_eq_u32 s55, 0
    s_cbranch_scc1 bk_206
    s_sub_u32 s55, s55, 1
    s_sleep 2
    s_add_u32 s101, s56, 372736
    buffer_load_dwordx4 v[72:75], v2, s[32:35], s101 offen offset:512 sc1
    s_add_u32 s101, s56, 387072
    buffer_load_dwordx4 v[76:79], v2, s[32:35], s101 offen offset:512 sc1
    s_waitcnt vmcnt(0)
    v_max3_u32 v8, v72, v73, v74
    v_max3_u32 v8, v8, v75, v76
    v_max3_u32 v8, v8, v77, v78
    v_max_u32 v8, v8, v79
    v_cmp_eq_u32 vcc, -1, v8
    s_cbranch_vccnz rty_205
    s_branch bk_206
rty_207:
    s_cmp_eq_u32 s55, 0
    s_cbranch_scc1 bk_208
    s_sub_u32 s55, s55, 1
    s_sleep 2
    s_add_u32 s101, s56, 401408
    buffer_load_dwordx4 v[80:83], v2, s[32:35], s101 offen offset:512 sc1
    s_add_u32 s101, s56, 415744
    buffer_load_dwordx4 v[84:87], v2, s[32:35], s101 offen offset:512 sc1
    s_waitcnt vmcnt(0)
    v_max3_u32 v8, v80, v81, v82
    v_max3_u32 v8, v8, v83, v84
    v_max3_u32 v8, v8, v85, v86
    v_max_u32 v8, v8, v87
    v_cmp_eq_u32 vcc, -1, v8
    s_cbranch_vccnz rty_207
    s_branch bk_208
rty_209:
    s_cmp_eq_u32 s55, 0
    s_cbranch_scc1 bk_210
    s_sub_u32 s55, s55, 1
    s_sleep 2
    s_add_u32 s101, s56, 430080
    buffer_load_dwordx4 v[88:91], v2, s[32:35], s101 offen offset:512 sc1
    s_add_u32 s101, s56, 444416
    buffer_load_dwordx4 v[92:95], v2, s[32:35], s101 offen offset:512 sc1
    s_waitcnt vmcnt(0)
    v_max3_u32 v8, v88, v89, v90
    v_max3_u32 v8, v8, v91, v92
    v_max3_u32 v8, v8, v93, v94
    v_max_u32 v8, v8, v95
    v_cmp_eq_u32 vcc, -1, v8
    s_cbranch_vccnz rty_209
    s_branch bk_210
rty_211:
    s_cmp_eq_u32 s55, 0
    s_cbranch_scc1 bk_212
    s_sub_u32 s55, s55, 1
    s_sleep 2
    s_add_u32 s101, s57, 0
    buffer_load_dwordx4 v[32:35], v3, s[32:35], s101 offen offset:0 sc1
    s_add_u32 s101, s57, 14336
    buffer_load_dwordx4 v[36:39], v3, s[32:35], s101 offen offset:0 sc1
    s_add_u32 s101, s57, 28672
    buffer_load_dwordx4 v[40:43], v3, s[32:35], s101 offen offset:0 sc1
    s_add_u32 s101, s57, 43008
    buffer_load_dwordx4 v[44:47], v3, s[32:35], s101 offen offset:0 sc1
    s_add_u32 s101, s57, 57344
    buffer_load_dwordx4 v[48:51], v3, s[32:35], s101 offen offset:0 sc1
    s_add_u32 s101, s57, 71680
    buffer_load_dwordx4 v[52:55], v3, s[32:35], s101 offen offset:0 sc1
    s_add_u32 s101, s57, 86016
    buffer_load_dwordx4 v[56:59], v3, s[32:35], s101 offen offset:0 sc1
    s_add_u32 s101, s57, 100352
    buffer_load_dwordx4 v[60:63], v3, s[32:35], s101 offen offset:0 sc1
    s_add_u32 s101, s57, 114688
    buffer_load_dwordx4 v[64:67], v3, s[32:35], s101 offen offset:0 sc1
    s_add_u32 s101, s57, 129024
    buffer_load_dwordx4 v[68:71], v3, s[32:35], s101 offen offset:0 sc1
    s_add_u32 s101, s57, 143360
    buffer_load_dwordx4 v[72:75], v3, s[32:35], s101 offen offset:0 sc1
    s_add_u32 s101, s57, 157696
    buffer_load_dwordx4 v[76:79], v3, s[32:35], s101 offen offset:0 sc1
    s_waitcnt vmcnt(0)
    v_max3_u32 v8, v32, v33, v34
    v_max3_u32 v8, v8, v35, v36
    v_max3_u32 v8, v8, v37, v38
    v_max_u32 v8, v8, v39
    v_cmp_eq_u32 vcc, -1, v8
    s_cbranch_vccnz rty_211
    s_branch bk_212
rty_213:
    s_cmp_eq_u32 s55, 0
    s_cbranch_scc1 bk_214
    s_sub_u32 s55, s55, 1
    s_sleep 2
    s_add_u32 s101, s57, 28672
    buffer_load_dwordx4 v[40:43], v3, s[32:35], s101 offen offset:0 sc1
    s_add_u32 s101, s57, 43008
    buffer_load_dwordx4 v[44:47], v3, s[32:35], s101 offen offset:0 sc1
    s_add_u32 s101, s57, 57344
    buffer_load_dwordx4 v[48:51], v3, s[32:35], s101 offen offset:0 sc1
    s_add_u32 s101, s57, 71680
    buffer_load_dwordx4 v[52:55], v3, s[32:35], s101 offen offset:0 sc1
    s_add_u32 s101, s57, 86016
    buffer_load_dwordx4 v[56:59], v3, s[32:35], s101 offen offset:0 sc1
    s_add_u32 s101, s57, 100352
    buffer_load_dwordx4 v[60:63], v3, s[32:35], s101 offen offset:0 sc1
    s_add_u32 s101, s57, 114688
    buffer_load_dwordx4 v[64:67], v3, s[32:35], s101 offen offset:0 sc1
    s_add_u32 s101, s57, 129024
    buffer_load_dwordx4 v[68:71], v3, s[32:35], s101 offen offset:0 sc1
    s_add_u32 s101, s57, 143360
    buffer_load_dwordx4 v[72:75], v3, s[32:35], s101 offen offset:0 sc1
    s_add_u32 s101, s57, 157696
    buffer_load_dwordx4 v[76:79], v3, s[32:35], s101 offen offset:0 sc1
    s_add_u32 s101, s57, 172032
    buffer_load_dwordx4 v[80:83], v3, s[32:35], s101 offen offset:0 sc1
    s_add_u32 s101, s57, 186368
    buffer_load_dwordx4 v[84:87], v3, s[32:35], s101 offen offset:0 sc1
    s_waitcnt vmcnt(0)
    v_max3_u32 v8, v40, v41, v42
    v_max3_u32 v8, v8, v43, v44
    v_max3_u32 v8, v8, v45, v46
    v_max_u32 v8, v8, v47
    v_cmp_eq_u32 vcc, -1, v8
    s_cbranch_vccnz rty_213
    s_branch bk_214
rty_215:
    s_cmp_eq_u32 s55, 0
    s_cbranch_scc1 bk_216
    s_sub_u32 s55, s55, 1
    s_sleep 2
    s_add_u32 s101, s57, 57344
    buffer_load_dwordx4 v[48:51], v3, s[32:35], s101 offen offset:0 sc1
    s_add_u32 s101, s57, 71680
    buffer_load_dwordx4 v[52:55], v3, s[32:35], s101 offen offset:0 sc1
    s_waitcnt vmcnt(0)
    v_max3_u32 v8, v48, v49, v50
    v_max3_u32 v8, v8, v51, v52
    v_max3_u32 v8, v8, v53, v54
    v_max_u32 v8, v8, v55
    v_cmp_eq_u32 vcc, -1, v8
    s_cbranch_vccnz rty_215
    s_branch bk_216
rty_217:
    s_cmp_eq_u32 s55, 0
    s_cbranch_scc1 bk_218
    s_sub_u32 s55, s55, 1
    s_sleep 2
    s_add_u32 s101, s57, 86016
    buffer_load_dwordx4 v[56:59], v3, s[32:35], s101 offen offset:0 sc1
    s_add_u32 s101, s57, 100352
    buffer_load_dwordx4 v[60:63], v3, s[32:35], s101 offen offset:0 sc1
    s_waitcnt vmcnt(0)
    v_max3_u32 v8, v56, v57, v58
    v_max3_u32 v8, v8, v59, v60
    v_max3_u32 v8, v8, v61, v62
    v_max_u32 v8, v8, v63
    v_cmp_eq_u32 vcc, -1, v8
    s_cbranch_vccnz rty_217
    s_branch bk_218
rty_219:
    s_cmp_eq_u32 s55, 0
    s_cbranch_scc1 bk_220
    s_sub_u32 s55, s55, 1
    s_sleep 2
    s_add_u32 s101, s57, 114688
    buffer_load_dwordx4 v[64:67], v3, s[32:35], s101 offen offset:0 sc1
    s_add_u32 s101, s57, 129024
    buffer_load_dwordx4 v[68:71], v3, s[32:35], s101 offen offset:0 sc1
    s_waitcnt vmcnt(0)
    v_max3_u32 v8, v64, v65, v66
    v_max3_u32 v8, v8, v67, v68
    v_max3_u32 v8, v8, v69, v70
    v_max_u32 v8, v8, v71
    v_cmp_eq_u32 vcc, -1, v8
    s_cbranch_vccnz rty_219
    s_branch bk_220
rty_221:
    s_cmp_eq_u32 s55, 0
    s_cbranch_scc1 bk_222
    s_sub_u32 s55, s55, 1
    s_sleep 2
    s_add_u32 s101, s57, 143360
    buffer_load_dwordx4 v[72:75], v3, s[32:35], s101 offen offset:0 sc1
    s_add_u32 s101, s57, 157696
    buffer_load_dwordx4 v[76:79], v3, s[32:35], s101 offen offset:0 sc1
    s_waitcnt vmcnt(0)
    v_max3_u32 v8, v72, v73, v74
    v_max3_u32 v8, v8, v75, v76
    v_max3_u32 v8, v8, v77, v78
    v_max_u32 v8, v8, v79
    v_cmp_eq_u32 vcc, -1, v8
    s_cbranch_vccnz rty_221
    s_branch bk_222
rty_223:
    s_cmp_eq_u32 s55, 0
    s_cbranch_scc1 bk_224
    s_sub_u32 s55, s55, 1
    s_sleep 2
    s_add_u32 s101, s57, 172032
    buffer_load_dwordx4 v[80:83], v3, s[32:35], s101 offen offset:0 sc1
    s_add_u32 s101, s57, 186368
    buffer_load_dwordx4 v[84:87], v3, s[32:35], s101 offen offset:0 sc1
    s_waitcnt vmcnt(0)
    v_max3_u32 v8, v80, v81, v82
    v_max3_u32 v8, v8, v83, v84
    v_max3_u32 v8, v8, v85, v86
    v_max_u32 v8, v8, v87
    v_cmp_eq_u32 vcc, -1, v8
    s_cbranch_vccnz rty_223
    s_branch bk_224
rty_225:
    s_cmp_eq_u32 s55, 0
    s_cbranch_scc1 bk_226
    s_sub_u32 s55, s55, 1
    s_sleep 2
    s_add_u32 s101, s57, 200704
    buffer_load_dwordx4 v[88:91], v3, s[32:35], s101 offen offset:0 sc1
    s_add_u32 s101, s57, 215040
    buffer_load_dwordx4 v[92:95], v3, s[32:35], s101 offen offset:0 sc1
    s_waitcnt vmcnt(0)
    v_max3_u32 v8, v88, v89, v90
    v_max3_u32 v8, v8, v91, v92
    v_max3_u32 v8, v8, v93, v94
    v_max_u32 v8, v8, v95
    v_cmp_eq_u32 vcc, -1, v8
    s_cbranch_vccnz rty_225
    s_branch bk_226
rty_227:
    s_cmp_eq_u32 s55, 0
    s_cbranch_scc1 bk_228
    s_sub_u32 s55, s55, 1
    s_sleep 2
    s_add_u32 s101, s57, 229376
    buffer_load_dwordx4 v[32:35], v3, s[32:35], s101 offen offset:0 sc1
    s_add_u32 s101, s57, 243712
    buffer_load_dwordx4 v[36:39], v3, s[32:35], s101 offen offset:0 sc1
    s_waitcnt vmcnt(0)
    v_max3_u32 v8, v32, v33, v34
    v_max3_u32 v8, v8, v35, v36
    v_max3_u32 v8, v8, v37, v38
    v_max_u32 v8, v8, v39
    v_cmp_eq_u32 vcc, -1, v8
    s_cbranch_vccnz rty_227
    s_branch bk_228
rty_229:
    s_cmp_eq_u32 s55, 0
    s_cbranch_scc1 bk_230
    s_sub_u32 s55, s55, 1
    s_sleep 2
    s_add_u32 s101, s57, 258048
    buffer_load_dwordx4 v[40:43], v3, s[32:35], s101 offen offset:0 sc1
    s_add_u32 s101, s57, 272384
    buffer_load_dwordx4 v[44:47], v3, s[32:35], s101 offen offset:0 sc1
    s_waitcnt vmcnt(0)
    v_max3_u32 v8, v40, v41, v42
    v_max3_u32 v8, v8, v43, v44
    v_max3_u32 v8, v8, v45, v46
    v_max_u32 v8, v8, v47
    v_cmp_eq_u32 vcc, -1, v8
    s_cbranch_vccnz rty_229
    s_branch bk_230
rty_231:
    s_cmp_eq_u32 s55, 0
    s_cbranch_scc1 bk_232
    s_sub_u32 s55, s55, 1
    s_sleep 2
    s_add_u32 s101, s57, 286720
    buffer_load_dwordx4 v[48:51], v3, s[32:35], s101 offen offset:0 sc1
    s_add_u32 s101, s57, 301056
    buffer_load_dwordx4 v[52:55], v3, s[32:35], s101 offen offset:0 sc1
    s_waitcnt vmcnt(0)
    v_max3_u32 v8, v48, v49, v50
    v_max3_u32 v8, v8, v51, v52
    v_max3_u32 v8, v8, v53, v54
    v_max_u32 v8, v8, v55
    v_cmp_eq_u32 vcc, -1, v8
    s_cbranch_vccnz rty_231
    s_branch bk_232
rty_233:
    s_cmp_eq_u32 s55, 0
    s_cbranch_scc1 bk_234
    s_sub_u32 s55, s55, 1
    s_sleep 2
    s_add_u32 s101, s57, 315392
    buffer_load_dwordx4 v[56:59], v3, s[32:35], s101 offen offset:0 sc1
    s_add_u32 s101, s57, 329728
    buffer_load_dwordx4 v[60:63], v3, s[32:35], s101 offen offset:0 sc1
    s_waitcnt vmcnt(0)
    v_max3_u32 v8, v56, v57, v58
    v_max3_u32 v8, v8, v59, v60
    v_max3_u32 v8, v8, v61, v62
    v_max_u32 v8, v8, v63
    v_cmp_eq_u32 vcc, -1, v8
    s_cbranch_vccnz rty_233
    s_branch bk_234
rty_235:
    s_cmp_eq_u32 s55, 0
    s_cbranch_scc1 bk_236
    s_sub_u32 s55, s55, 1
    s_sleep 2
    s_add_u32 s101, s57, 344064
    buffer_load_dwordx4 v[64:67], v3, s[32:35], s101 offen offset:0 sc1
    s_add_u32 s101, s57, 358400
    buffer_load_dwordx4 v[68:71], v3, s[32:35], s101 offen offset:0 sc1
    s_waitcnt vmcnt(0)
    v_max3_u32 v8, v64, v65, v66
    v_max3_u32 v8, v8, v67, v68
    v_max3_u32 v8, v8, v69, v70
    v_max_u32 v8, v8, v71
    v_cmp_eq_u32 vcc, -1, v8
    s_cbranch_vccnz rty_235
    s_branch bk_236
rty_237:
    s_cmp_eq_u32 s55, 0
    s_cbranch_scc1 bk_238
    s_sub_u32 s55, s55, 1
    s_sleep 2
    s_add_u32 s101, s57, 372736
    buffer_load_dwordx4 v[72:75], v3, s[32:35], s101 offen offset:0 sc1
    s_add_u32 s101, s57, 387072
    buffer_load_dwordx4 v[76:79], v3, s[32:35], s101 offen offset:0 sc1
    s_waitcnt vmcnt(0)
    v_max3_u32 v8, v72, v73, v74
    v_max3_u32 v8, v8, v75, v76
    v_max3_u32 v8, v8, v77, v78
    v_max_u32 v8, v8, v79
    v_cmp_eq_u32 vcc, -1, v8
    s_cbranch_vccnz rty_237
    s_branch bk_238
rty_239:
    s_cmp_eq_u32 s55, 0
    s_cbranch_scc1 bk_240
    s_sub_u32 s55, s55, 1
    s_sleep 2
    s_add_u32 s101, s57, 0
    buffer_load_dwordx4 v[80:83], v3, s[32:35], s101 offen offset:512 sc1
    s_add_u32 s101, s57, 14336
    buffer_load_dwordx4 v[84:87], v3, s[32:35], s101 offen offset:512 sc1
    s_add_u32 s101, s57, 28672
    buffer_load_dwordx4 v[88:91], v3, s[32:35], s101 offen offset:512 sc1
    s_add_u32 s101, s57, 43008
    buffer_load_dwordx4 v[92:95], v3, s[32:35], s101 offen offset:512 sc1
    s_add_u32 s101, s57, 57344
    buffer_load_dwordx4 v[32:35], v3, s[32:35], s101 offen offset:512 sc1
    s_add_u32 s101, s57, 71680
    buffer_load_dwordx4 v[36:39], v3, s[32:35], s101 offen offset:512 sc1
    s_add_u32 s101, s57, 86016
    buffer_load_dwordx4 v[40:43], v3, s[32:35], s101 offen offset:512 sc1
    s_add_u32 s101, s57, 100352
    buffer_load_dwordx4 v[44:47], v3, s[32:35], s101 offen offset:512 sc1
    s_add_u32 s101, s57, 114688
    buffer_load_dwordx4 v[48:51], v3, s[32:35], s101 offen offset:512 sc1
    s_add_u32 s101, s57, 129024
    buffer_load_dwordx4 v[52:55], v3, s[32:35], s101 offen offset:512 sc1
    s_add_u32 s101, s57, 143360
    buffer_load_dwordx4 v[56:59], v3, s[32:35], s101 offen offset:512 sc1
    s_add_u32 s101, s57, 157696
    buffer_load_dwordx4 v[60:63], v3, s[32:35], s101 offen offset:512 sc1
    s_waitcnt vmcnt(0)
    v_max3_u32 v8, v80, v81, v82
    v_max3_u32 v8, v8, v83, v84
    v_max3_u32 v8, v8, v85, v86
    v_max_u32 v8, v8, v87
    v_cmp_eq_u32 vcc, -1, v8
    s_cbranch_vccnz rty_239
    s_branch bk_240
rty_241:
    s_cmp_eq_u32 s55, 0
    s_cbranch_scc1 bk_242
    s_sub_u32 s55, s55, 1
    s_sleep 2
    s_add_u32 s101, s57, 28672
    buffer_load_dwordx4 v[88:91], v3, s[32:35], s101 offen offset:512 sc1
    s_add_u32 s101, s57, 43008
    buffer_load_dwordx4 v[92:95], v3, s[32:35], s101 offen offset:512 sc1
    s_add_u32 s101, s57, 57344
    buffer_load_dwordx4 v[32:35], v3, s[32:35], s101 offen offset:512 sc1
    s_add_u32 s101, s57, 71680
    buffer_load_dwordx4 v[36:39], v3, s[32:35], s101 offen offset:512 sc1
    s_add_u32 s101, s57, 86016
    buffer_load_dwordx4 v[40:43], v3, s[32:35], s101 offen offset:512 sc1
    s_add_u32 s101, s57, 100352
    buffer_load_dwordx4 v[44:47], v3, s[32:35], s101 offen offset:512 sc1
    s_add_u32 s101, s57, 114688
    buffer_load_dwordx4 v[48:51], v3, s[32:35], s101 offen offset:512 sc1
    s_add_u32 s101, s57, 129024
    buffer_load_dwordx4 v[52:55], v3, s[32:35], s101 offen offset:512 sc1
    s_add_u32 s101, s57, 143360
    buffer_load_dwordx4 v[56:59], v3, s[32:35], s101 offen offset:512 sc1
    s_add_u32 s101, s57, 157696
    buffer_load_dwordx4 v[60:63], v3, s[32:35], s101 offen offset:512 sc1
    s_add_u32 s101, s57, 172032
    buffer_load_dwordx4 v[64:67], v3, s[32:35], s101 offen offset:512 sc1
    s_add_u32 s101, s57, 186368
    buffer_load_dwordx4 v[68:71], v3, s[32:35], s101 offen offset:512 sc1
    s_waitcnt vmcnt(0)
    v_max3_u32 v8, v88, v89, v90
    v_max3_u32 v8, v8, v91, v92
    v_max3_u32 v8, v8, v93, v94
    v_max_u32 v8, v8, v95
    v_cmp_eq_u32 vcc, -1, v8
    s_cbranch_vccnz rty_241
    s_branch bk_242
rty_243:
    s_cmp_eq_u32 s55, 0
    s_cbranch_scc1 bk_244
    s_sub_u32 s55, s55, 1
    s_sleep 2
    s_add_u32 s101, s57, 57344
    buffer_load_dwordx4 v[32:35], v3, s[32:35], s101 offen offset:512 sc1
    s_add_u32 s101, s57, 71680
    buffer_load_dwordx4 v[36:39], v3, s[32:35], s101 offen offset:512 sc1
    s_waitcnt vmcnt(0)
    v_max3_u32 v8, v32, v33, v34
    v_max3_u32 v8, v8, v35, v36
    v_max3_u32 v8, v8, v37, v38
    v_max_u32 v8, v8, v39
    v_cmp_eq_u32 vcc, -1, v8
    s_cbranch_vccnz rty_243
    s_branch bk_244
rty_245:
    s_cmp_eq_u32 s55, 0
    s_cbranch_scc1 bk_246
    s_sub_u32 s55, s55, 1
    s_sleep 2
    s_add_u32 s101, s57, 86016
    buffer_load_dwordx4 v[40:43], v3, s[32:35], s101 offen offset:512 sc1
    s_add_u32 s101, s57, 100352
    buffer_load_dwordx4 v[44:47], v3, s[32:35], s101 offen offset:512 sc1
    s_waitcnt vmcnt(0)
    v_max3_u32 v8, v40, v41, v42
    v_max3_u32 v8, v8, v43, v44
    v_max3_u32 v8, v8, v45, v46
    v_max_u32 v8, v8, v47
    v_cmp_eq_u32 vcc, -1, v8
    s_cbranch_vccnz rty_245
    s_branch bk_246
rty_247:
    s_cmp_eq_u32 s55, 0
    s_cbranch_scc1 bk_248
    s_sub_u32 s55, s55, 1
    s_sleep 2
    s_add_u32 s101, s57, 114688
    buffer_load_dwordx4 v[48:51], v3, s[32:35], s101 offen offset:512 sc1
    s_add_u32 s101, s57, 129024
    buffer_load_dwordx4 v[52:55], v3, s[32:35], s101 offen offset:512 sc1
    s_waitcnt vmcnt(0)
    v_max3_u32 v8, v48, v49, v50
    v_max3_u32 v8, v8, v51, v52
    v_max3_u32 v8, v8, v53, v54
    v_max_u32 v8, v8, v55
    v_cmp_eq_u32 vcc, -1, v8
    s_cbranch_vccnz rty_247
    s_branch bk_248
rty_249:
    s_cmp_eq_u32 s55, 0
    s_cbranch_scc1 bk_250
    s_sub_u32 s55, s55, 1
    s_sleep 2
    s_add_u32 s101, s57, 143360
    buffer_load_dwordx4 v[56:59], v3, s[32:35], s101 offen offset:512 sc1
    s_add_u32 s101, s57, 157696
    buffer_load_dwordx4 v[60:63], v3, s[32:35], s101 offen offset:512 sc1
    s_waitcnt vmcnt(0)
    v_max3_u32 v8, v56, v57, v58
    v_max3_u32 v8, v8, v59, v60
    v_max3_u32 v8, v8, v61, v62
    v_max_u32 v8, v8, v63
    v_cmp_eq_u32 vcc, -1, v8
    s_cbranch_vccnz rty_249
    s_branch bk_250
rty_251:
    s_cmp_eq_u32 s55, 0
    s_cbranch_scc1 bk_252
    s_sub_u32 s55, s55, 1
    s_sleep 2
    s_add_u32 s101, s57, 172032
    buffer_load_dwordx4 v[64:67], v3, s[32:35], s101 offen offset:512 sc1
    s_add_u32 s101, s57, 186368
    buffer_load_dwordx4 v[68:71], v3, s[32:35], s101 offen offset:512 sc1
    s_waitcnt vmcnt(0)
    v_max3_u32 v8, v64, v65, v66
    v_max3_u32 v8, v8, v67, v68
    v_max3_u32 v8, v8, v69, v70
    v_max_u32 v8, v8, v71
    v_cmp_eq_u32 vcc, -1, v8
    s_cbranch_vccnz rty_251
    s_branch bk_252
rty_253:
    s_cmp_eq_u32 s55, 0
    s_cbranch_scc1 bk_254
    s_sub_u32 s55, s55, 1
    s_sleep 2
    s_add_u32 s101, s57, 200704
    buffer_load_dwordx4 v[72:75], v3, s[32:35], s101 offen offset:512 sc1
    s_add_u32 s101, s57, 215040
    buffer_load_dwordx4 v[76:79], v3, s[32:35], s101 offen offset:512 sc1
    s_waitcnt vmcnt(0)
    v_max3_u32 v8, v72, v73, v74
    v_max3_u32 v8, v8, v75, v76
    v_max3_u32 v8, v8, v77, v78
    v_max_u32 v8, v8, v79
    v_cmp_eq_u32 vcc, -1, v8
    s_cbranch_vccnz rty_253
    s_branch bk_254
rty_255:
    s_cmp_eq_u32 s55, 0
    s_cbranch_scc1 bk_256
    s_sub_u32 s55, s55, 1
    s_sleep 2
    s_add_u32 s101, s57, 229376
    buffer_load_dwordx4 v[80:83], v3, s[32:35], s101 offen offset:512 sc1
    s_add_u32 s101, s57, 243712
    buffer_load_dwordx4 v[84:87], v3, s[32:35], s101 offen offset:512 sc1
    s_waitcnt vmcnt(0)
    v_max3_u32 v8, v80, v81, v82
    v_max3_u32 v8, v8, v83, v84
    v_max3_u32 v8, v8, v85, v86
    v_max_u32 v8, v8, v87
    v_cmp_eq_u32 vcc, -1, v8
    s_cbranch_vccnz rty_255
    s_branch bk_256
rty_257:
    s_cmp_eq_u32 s55, 0
    s_cbranch_scc1 bk_258
    s_sub_u32 s55, s55, 1
    s_sleep 2
    s_add_u32 s101, s57, 258048
    buffer_load_dwordx4 v[88:91], v3, s[32:35], s101 offen offset:512 sc1
    s_add_u32 s101, s57, 272384
    buffer_load_dwordx4 v[92:95], v3, s[32:35], s101 offen offset:512 sc1
    s_waitcnt vmcnt(0)
    v_max3_u32 v8, v88, v89, v90
    v_max3_u32 v8, v8, v91, v92
    v_max3_u32 v8, v8, v93, v94
    v_max_u32 v8, v8, v95
    v_cmp_eq_u32 vcc, -1, v8
    s_cbranch_vccnz rty_257
    s_branch bk_258
rty_259:
    s_cmp_eq_u32 s55, 0
    s_cbranch_scc1 bk_260
    s_sub_u32 s55, s55, 1
    s_sleep 2
    s_add_u32 s101, s57, 286720
    buffer_load_dwordx4 v[32:35], v3, s[32:35], s101 offen offset:512 sc1
    s_add_u32 s101, s57, 301056
    buffer_load_dwordx4 v[36:39], v3, s[32:35], s101 offen offset:512 sc1
    s_waitcnt vmcnt(0)
    v_max3_u32 v8, v32, v33, v34
    v_max3_u32 v8, v8, v35, v36
    v_max3_u32 v8, v8, v37, v38
    v_max_u32 v8, v8, v39
    v_cmp_eq_u32 vcc, -1, v8
    s_cbranch_vccnz rty_259
    s_branch bk_260
rty_261:
    s_cmp_eq_u32 s55, 0
    s_cbranch_scc1 bk_262
    s_sub_u32 s55, s55, 1
    s_sleep 2
    s_add_u32 s101, s57, 315392
    buffer_load_dwordx4 v[40:43], v3, s[32:35], s101 offen offset:512 sc1
    s_add_u32 s101, s57, 329728
    buffer_load_dwordx4 v[44:47], v3, s[32:35], s101 offen offset:512 sc1
    s_waitcnt vmcnt(0)
    v_max3_u32 v8, v40, v41, v42
    v_max3_u32 v8, v8, v43, v44
    v_max3_u32 v8, v8, v45, v46
    v_max_u32 v8, v8, v47
    v_cmp_eq_u32 vcc, -1, v8
    s_cbranch_vccnz rty_261
    s_branch bk_262
rty_263:
    s_cmp_eq_u32 s55, 0
    s_cbranch_scc1 bk_264
    s_sub_u32 s55, s55, 1
    s_sleep 2
    s_add_u32 s101, s57, 344064
    buffer_load_dwordx4 v[48:51], v3, s[32:35], s101 offen offset:512 sc1
    s_add_u32 s101, s57, 358400
    buffer_load_dwordx4 v[52:55], v3, s[32:35], s101 offen offset:512 sc1
    s_waitcnt vmcnt(0)
    v_max3_u32 v8, v48, v49, v50
    v_max3_u32 v8, v8, v51, v52
    v_max3_u32 v8, v8, v53, v54
    v_max_u32 v8, v8, v55
    v_cmp_eq_u32 vcc, -1, v8
    s_cbranch_vccnz rty_263
    s_branch bk_264
rty_265:
    s_cmp_eq_u32 s55, 0
    s_cbranch_scc1 bk_266
    s_sub_u32 s55, s55, 1
    s_sleep 2
    s_add_u32 s101, s57, 372736
    buffer_load_dwordx4 v[56:59], v3, s[32:35], s101 offen offset:512 sc1
    s_add_u32 s101, s57, 387072
    buffer_load_dwordx4 v[60:63], v3, s[32:35], s101 offen offset:512 sc1
    s_waitcnt vmcnt(0)
    v_max3_u32 v8, v56, v57, v58
    v_max3_u32 v8, v8, v59, v60
    v_max3_u32 v8, v8, v61, v62
    v_max_u32 v8, v8, v63
    v_cmp_eq_u32 vcc, -1, v8
    s_cbranch_vccnz rty_265
    s_branch bk_266
L_exit:
    s_endpgm
L_code_end:
.section .rodata,"a"
.p2align 6
.amdhsa_kernel interleave_layers__spectral_gfnet__mixer_token_mlp__prompt_kernel
  .amdhsa_next_free_vgpr 512
  .amdhsa_next_free_sgpr 102
  .amdhsa_accum_offset 256
  .amdhsa_group_segment_fixed_size 0
  .amdhsa_kernarg_size 88
  .amdhsa_user_sgpr_count 2
  .amdhsa_user_sgpr_kernarg_segment_ptr 1
  .amdhsa_system_sgpr_workgroup_id_x 1
.end_amdhsa_kernel
```
